```python
import torch

def _softmax(x, axis=-1):
    return torch.softmax(x, dim=axis)
def _gelu(x):
    return torch.nn.functional.gelu(x, approximate="tanh")
def _silu(x):
    return torch.nn.functional.silu(x)
def _sigmoid(x):
    return torch.sigmoid(x)
def _layernorm(x, axis=-1, eps=1e-5):
    m = x.mean(dim=axis, keepdim=True)
    v = x.var(dim=axis, keepdim=True, unbiased=False)
    return (x - m) / torch.sqrt(v + eps)
def _scatter_add(tgt, idx, src, axis=0):
    return tgt.clone().index_add_(axis, idx, src)
def _segment_sum(src, seg, n):
    out = torch.zeros((n,) + src.shape[1:], dtype=src.dtype)
    return out.index_add_(0, seg, src)
def _pad(x, pw):
    flat = tuple(v for pair in reversed(pw) for v in pair)
    return torch.nn.functional.pad(x, flat)

kernel_name = 'standalone__window_attn_swin_v2__vision'

def setup_inputs():

    _w = (lambda a: (lambda t: t.to(torch.bfloat16) if t.is_floating_point() else t)(torch.as_tensor(a)))
    win = 7
    H = W = (384 // win) * win
    C = 96
    nh = 4
    shift = win // 2
    coords = torch.stack(torch.meshgrid(torch.arange(win), torch.arange(win), indexing="ij"), -1).reshape(-1, 2)
    rel = coords[:, None, :] - coords[None, :, :]
    rel_idx = ((rel[..., 0] + win - 1) * (2 * win - 1) + (rel[..., 1] + win - 1)).to(torch.int64)
    tab = torch.stack(torch.meshgrid(torch.arange(1 - win, win), torch.arange(1 - win, win), indexing="ij"), -1).reshape(-1, 2).to(float)
    tab = (lambda _x: torch.sign(torch.as_tensor(_x)))(tab) * (lambda _x: torch.log1p(torch.as_tensor(_x)))(torch.abs(tab))
    img = torch.zeros((H, W), dtype=torch.int64)
    cnt = 0
    for hs in (slice(0, H - win), slice(H - win, H - shift), slice(H - shift, H)):
        for ws in (slice(0, W - win), slice(W - win, W - shift), slice(W - shift, W)):
            img[hs, ws] = cnt; cnt += 1
    mw = img.reshape(H // win, win, W // win, win).permute(0, 2, 1, 3).reshape(-1, win * win)
    mask = (mw[:, :, None] != mw[:, None, :]).to(float) * (-100.0)
    return {
        "x": _w((lambda *s: torch.randn(*s, dtype=torch.bfloat16) * 0.05)(1, H, W, C)),
        "wqkv": _w((lambda *s: torch.randn(*s, dtype=torch.bfloat16) * 0.8)(C, 3 * C)),
        "wo": _w((lambda *s: torch.randn(*s, dtype=torch.bfloat16) * 0.05)(C, C)),
        "logit_scale": _w((lambda *s: torch.randn(*s, dtype=torch.bfloat16) * 0.8)(nh)),
        "cpb_w1": _w((lambda *s: torch.randn(*s, dtype=torch.bfloat16) * 0.8)(2, 4 * nh)),
        "cpb_w2": _w((lambda *s: torch.randn(*s, dtype=torch.bfloat16) * 0.8)(4 * nh, nh)),
        "rel_coords": _w(tab),
        "rel_idx": _w(rel_idx),
        "attn_mask": _w(mask),
    }

def reference(x, wqkv, wo, logit_scale, cpb_w1, cpb_w2, rel_coords, rel_idx, attn_mask):
    B, H, W, C = x.shape
    win = 7
    nh = 4
    hd = C // nh
    shift = win // 2
    ww = win * win
    nH, nW = H // win, W // win
    xs = torch.roll(x, (-shift, -shift), (1, 2))
    xw = (lambda x, *d: x.permute(*d))(xs.reshape(B, nH, win, nW, win, C), 0, 1, 3, 2, 4, 5).reshape(B * nH * nW, ww, C)
    qkv = (lambda x, *d: x.permute(*d))((xw @ wqkv).reshape(B * nH * nW, ww, 3, nh, hd), 2, 0, 3, 1, 4)
    q, k, v = qkv[0], qkv[1], qkv[2]
    qn = q * (torch.einsum("bhqd,bhqd->bhq", q, q)[..., None] + 1e-12) ** -0.5
    kn = k * (torch.einsum("bhkd,bhkd->bhk", k, k)[..., None] + 1e-12) ** -0.5
    logits = torch.einsum("bhqd,bhkd->bhqk", qn, kn)
    tau = torch.exp(torch.clip(logit_scale, -100.0, 4.6052))
    logits = logits * tau[None, :, None, None]
    hcpb = rel_coords @ cpb_w1
    hcpb = torch.where(hcpb > 0, hcpb, hcpb * 0)
    bias_tab = 16.0 * _sigmoid(hcpb @ cpb_w2)
    bias = (lambda x, *d: x.permute(*d))(bias_tab[rel_idx], 2, 0, 1)
    logits = logits.reshape(B, nH * nW, nh, ww, ww) + bias[None, None, :, :, :] + attn_mask[None, :, None, :, :]
    p = _softmax(logits.reshape(B * nH * nW, nh, ww, ww), axis=-1)
    o = (lambda x, *d: x.permute(*d))(torch.einsum("bhqk,bhkd->bhqd", p, v), 0, 2, 1, 3).reshape(B * nH * nW, ww, C) @ wo
    o = (lambda x, *d: x.permute(*d))(o.reshape(B, nH, nW, win, win, C), 0, 1, 3, 2, 4, 5).reshape(B, H, W, C)
    o = torch.roll(o, (shift, shift), (1, 2))
    return _layernorm(o, axis=-1)
```

```asm
; @launch grid=(252,1,1) block=(768,1,1) lds=158080
.amdgcn_target "amdgcn-amd-amdhsa--gfx950"
.text
.globl standalone__window_attn_swin_v2__vision_kernel
.p2align 8
.type standalone__window_attn_swin_v2__vision_kernel,@function
standalone__window_attn_swin_v2__vision_kernel:
    s_cmp_ge_u32 s2, 252
    s_cbranch_scc1 L_end
    s_add_u32 s2, s2, 27
    s_sub_u32 s3, s2, 252
    s_min_u32 s2, s2, s3
    s_load_dwordx2 s[12:13], s[0:1], 8
    s_load_dwordx2 s[16:17], s[0:1], 16
    s_load_dwordx2 s[28:29], s[0:1], 48
    s_load_dwordx2 s[24:25], s[0:1], 56
    s_load_dwordx2 s[4:5], s[0:1], 0
    s_load_dwordx2 s[20:21], s[0:1], 64
    s_load_dwordx2 s[8:9], s[0:1], 72
    s_load_dwordx2 s[32:33], s[0:1], 24
    s_load_dwordx4 s[36:39], s[0:1], 32
    v_lshrrev_b32 v48, 6, v0
    v_and_b32 v44, 63, v0
    v_readfirstlane_b32 s3, v48
    s_getpc_b64 s[72:73]
    s_add_u32 s72, s72, wtab@rel32@lo+4
    s_addc_u32 s73, s73, wtab@rel32@hi+12
    s_min_u32 s74, s3, 8
    s_lshl_b32 s74, s74, 6
    v_add_u32 v48, s74, v44
    v_lshlrev_b32 v49, 3, v48
    global_load_dwordx2 v[58:59], v49, s[72:73]
    v_lshlrev_b32 v52, 4, v48
    s_add_u32 s74, s3, 5
    s_min_u32 s74, s74, 14
    s_lshl_b32 s74, s74, 9
    v_lshl_add_u32 v51, v44, 3, s74
    global_load_dwordx2 v[154:155], v51, s[72:73]
    v_lshlrev_b32 v50, 5, v44
    v_add_u32 v50, 7680, v50
    global_load_dwordx4 v[140:143], v50, s[72:73]
    global_load_dwordx2 v[144:145], v50, s[72:73] offset:16
    s_mov_b32 s14, 55296
    s_mov_b32 s15, 0x00020000
    s_mov_b32 s18, 18432
    s_mov_b32 s19, 0x00020000
    s_mov_b32 s30, 676
    s_mov_b32 s31, 0x00020000
    s_mov_b32 s26, 9604
    s_mov_b32 s27, 0x00020000
    s_mov_b32 s6, 27433728
    s_mov_b32 s7, 0x00020000
    s_mov_b32 s22, 14002632
    s_mov_b32 s23, 0x00020000
    s_mov_b32 s10, 27433728
    s_mov_b32 s11, 0x00020000
    s_mov_b32 s76, 0
    s_mov_b32 s77, 9216
    s_mov_b32 s78, 18432
    s_mov_b32 s79, 27648
    s_mov_b32 s80, 36864
    s_mov_b32 s81, 46080
    s_sub_u32 s74, s3, 9
    s_lshl_b32 s74, s74, 8
    v_lshl_add_u32 v84, v44, 2, s74
    s_cmp_gt_u32 s3, 8
    s_waitcnt lgkmcnt(0)
    s_cbranch_scc1 L_c9
    buffer_load_dwordx4 v[60:63], v52, s[12:15], s76 offen
    buffer_load_dwordx4 v[64:67], v52, s[12:15], s77 offen
    buffer_load_dwordx4 v[68:71], v52, s[12:15], s78 offen
    buffer_load_dwordx4 v[72:75], v52, s[12:15], s79 offen
    buffer_load_dwordx4 v[76:79], v52, s[12:15], s80 offen
    buffer_load_dwordx4 v[80:83], v52, s[12:15], s81 offen
    s_load_dwordx2 s[96:97], s[32:33], 0
    s_branch L_c10
L_c9:
    buffer_load_dword v90, v84, s[28:31], 0 offen offset:0
    s_load_dwordx16 s[48:63], s[36:37], 0
    s_load_dwordx16 s[64:79], s[38:39], 0
    s_load_dwordx16 s[80:95], s[38:39], 64
L_c10:
    s_mov_b64 exec, 0
    s_cmp_ge_u32 s3, 6
    s_cbranch_scc1 L_tad0_12
    s_cmp_ge_u32 s3, 3
    s_cbranch_scc1 L_tad0_6
    s_cmp_ge_u32 s3, 1
    s_cbranch_scc1 L_tad0_3
    s_branch L_ta0
L_tad0_3:
    s_cmp_ge_u32 s3, 2
    s_cbranch_scc1 L_tad1_3
    s_branch L_ta6
L_tad1_3:
    s_branch L_ta12
L_tad0_6:
    s_cmp_ge_u32 s3, 4
    s_cbranch_scc1 L_tad3_6
    s_branch L_ta18
L_tad3_6:
    s_cmp_ge_u32 s3, 5
    s_cbranch_scc1 L_tad4_6
    s_branch L_ta24
L_tad4_6:
    s_branch L_ta30
L_tad0_12:
    s_cmp_ge_u32 s3, 9
    s_cbranch_scc1 L_tad6_12
    s_cmp_ge_u32 s3, 7
    s_cbranch_scc1 L_tad6_9
    s_branch L_ta36
L_tad6_9:
    s_cmp_ge_u32 s3, 8
    s_cbranch_scc1 L_tad7_9
    s_branch L_ta42
L_tad7_9:
    s_branch L_ta48
L_tad6_12:
    s_cmp_ge_u32 s3, 10
    s_cbranch_scc1 L_tad9_12
    s_branch L_ta54
L_tad9_12:
    s_cmp_ge_u32 s3, 11
    s_cbranch_scc1 L_tad10_12
    s_branch L_ta60
L_tad10_12:
    s_branch L_ta66
L_taret:
    s_mov_b64 exec, -1
L_ta0:
    s_cbranch_execz L_ta1
    v_and_b32 v46, 15, v44
    v_and_b32 v45, 48, v44
    v_lshlrev_b32 v47, 4, v44
    s_cmp_lt_u32 s3, 4
    s_cbranch_scc1 L_pathO
    s_sub_u32 s99, s3, 4
    s_cmp_lt_u32 s3, 8
    s_cbranch_scc1 L_rg
    v_lshlrev_b32 v86, 2, v44
    v_add_u32 v86, 9408, v86
    buffer_load_dword v116, v86, s[24:27], 0 offen offset:0
    s_cmp_lg_u32 s3, 8
    s_cbranch_scc1 L_re
    s_lshl_b32 s47, s2, 2
    s_mul_i32 s34, s2, 12
    s_sub_u32 s34, s34, 324
    s_add_u32 s35, s47, 2696
    s_cmp_lt_u32 s2, 27
    s_cselect_b32 s34, s35, s34
    s_cselect_b32 s35, 8, 12
    s_cselect_b32 s46, 4, 0
    v_cmp_gt_u32 s[40:41], s46, v46
    v_add_u32 v48, s34, v46
L_ta1:
    s_cbranch_execz L_ta2
    v_mov_b32 v49, 0xaf8
    v_cndmask_b32 v48, v48, v49, s[40:41]
    v_mul_u32_u24 v49, 0x4d49, v48
    v_lshrrev_b32 v49, 20, v49
    v_mul_u32_u24 v50, 53, v49
    v_sub_u32 v50, v48, v50
    v_add_u32 v51, s47, v46
    v_mov_b32 v48, 0x6b
    v_cmp_lt_u32 s[42:43], v51, v48
    v_cmp_gt_u32 s[44:45], 54, v51
    s_nop 0
    s_and_b64 s[40:41], s[40:41], s[42:43]
    v_subrev_u32 v48, 54, v51
    v_cndmask_b32 v48, v48, 53, s[44:45]
    v_cndmask_b32 v51, 53, v51, s[44:45]
    v_cndmask_b32 v49, v49, v48, s[40:41]
    v_cndmask_b32 v50, v50, v51, s[40:41]
    s_movk_i32 s34, 378
L_ta2:
    s_cbranch_execz L_ta3
    v_mad_u32_u24 v49, v49, 7, 9
    v_subrev_u32 v48, s34, v49
    v_min_u32 v49, v49, v48
    v_mad_u32_u24 v50, v50, 7, 9
    v_subrev_u32 v48, s34, v50
    v_min_u32 v50, v50, v48
    v_mad_u32_u24 v48, v49, s34, v50
    v_mul_u32_u24 v48, 0xc0, v48
    v_add_u32 v48, v48, v45
    v_cmp_gt_u32 s[40:41], s35, v46
    v_bfrev_b32 v49, 1
    s_nop 0
    v_cndmask_b32 v91, v49, v48, s[40:41]
    buffer_load_dwordx4 v[8:11], v91, s[4:7], 0 offen offset:0
    buffer_load_dwordx4 v[12:15], v91, s[4:7], 0 offen offset:64
    buffer_load_dwordx4 v[16:19], v91, s[4:7], 0 offen offset:128
    s_branch L_re
L_rg:
    v_mul_u32_u24 v48, 0xc4, v46
    s_lshl_b32 s98, s99, 6
L_ta3:
    s_cbranch_execz L_ta4
    v_add3_u32 v85, v48, v45, s98
    v_add_u32 v153, 6272, v85
    buffer_load_dwordx4 v[92:95], v85, s[24:27], 0 offen offset:0
    buffer_load_dwordx4 v[96:99], v85, s[24:27], 0 offen offset:3136
    buffer_load_dwordx4 v[148:151], v153, s[24:27], 0 offen offset:0
L_re:
    s_barrier
    s_mul_i32 s98, s99, 3072
    v_mul_u32_u24 v48, 48, v44
    v_add_u32 v152, s98, v48
    s_lshl_b32 s98, s99, 10
    v_add_u32 v87, 79872, v47
    v_add_u32 v87, s98, v87
    s_cmp_lt_u32 s3, 9
    s_cbranch_scc1 L_notab
    s_setprio 3
    s_waitcnt vmcnt(1) lgkmcnt(0)
    s_pack_ll_b32_b16 s96, s48, s56
    s_pack_hh_b32_b16 s56, s48, s56
    s_pack_ll_b32_b16 s97, s49, s57
    s_pack_hh_b32_b16 s57, s49, s57
    s_pack_ll_b32_b16 s98, s50, s58
    s_pack_hh_b32_b16 s58, s50, s58
L_ta4:
    s_cbranch_execz L_ta5
    s_pack_ll_b32_b16 s99, s51, s59
    s_pack_hh_b32_b16 s59, s51, s59
    v_dot2_f32_bf16 v100, v90, s96, 0
    v_dot2_f32_bf16 v101, v90, s56, 0
    s_pack_ll_b32_b16 s100, s52, s60
    s_pack_hh_b32_b16 s60, s52, s60
    v_dot2_f32_bf16 v102, v90, s97, 0
    v_dot2_f32_bf16 v103, v90, s57, 0
    s_pack_ll_b32_b16 s101, s53, s61
    s_pack_hh_b32_b16 s61, s53, s61
    v_dot2_f32_bf16 v104, v90, s98, 0
    v_dot2_f32_bf16 v105, v90, s58, 0
    s_pack_ll_b32_b16 s96, s54, s62
    s_pack_hh_b32_b16 s62, s54, s62
    v_dot2_f32_bf16 v106, v90, s99, 0
    v_dot2_f32_bf16 v107, v90, s59, 0
    s_pack_ll_b32_b16 s97, s55, s63
    s_pack_hh_b32_b16 s63, s55, s63
    v_dot2_f32_bf16 v108, v90, s100, 0
L_ta5:
    s_cbranch_execz L_taret
    v_dot2_f32_bf16 v109, v90, s60, 0
    v_dot2_f32_bf16 v110, v90, s101, 0
    v_dot2_f32_bf16 v111, v90, s61, 0
    v_dot2_f32_bf16 v112, v90, s96, 0
    v_dot2_f32_bf16 v113, v90, s62, 0
    v_dot2_f32_bf16 v114, v90, s97, 0
    v_dot2_f32_bf16 v115, v90, s63, 0
    v_cvt_pk_bf16_f32 v100, v100, v101
    s_pack_ll_b32_b16 s48, s64, s66
    s_pack_hh_b32_b16 s49, s64, s66
    s_pack_ll_b32_b16 s50, s65, s67
    s_pack_hh_b32_b16 s51, s65, s67
    v_cvt_pk_bf16_f32 v101, v102, v103
    s_pack_ll_b32_b16 s52, s68, s70
    s_pack_hh_b32_b16 s53, s68, s70
    s_pack_ll_b32_b16 s54, s69, s71
    s_pack_hh_b32_b16 s55, s69, s71
    v_cvt_pk_bf16_f32 v102, v104, v105
    s_pack_ll_b32_b16 s56, s72, s74
L_ta6:
    s_cbranch_execz L_ta7
    s_pack_hh_b32_b16 s57, s72, s74
    s_pack_ll_b32_b16 s58, s73, s75
    s_pack_hh_b32_b16 s59, s73, s75
    v_cvt_pk_bf16_f32 v103, v106, v107
    v_cvt_pk_bf16_f32 v104, v108, v109
    v_cvt_pk_bf16_f32 v105, v110, v111
    v_cvt_pk_bf16_f32 v106, v112, v113
    v_cvt_pk_bf16_f32 v107, v114, v115
    v_pk_max_i16 v100, v100, 0
    v_pk_max_i16 v101, v101, 0
    v_pk_max_i16 v102, v102, 0
    v_pk_max_i16 v103, v103, 0
    v_pk_max_i16 v104, v104, 0
    v_pk_max_i16 v105, v105, 0
    v_pk_max_i16 v106, v106, 0
    v_pk_max_i16 v107, v107, 0
L_ta7:
    s_cbranch_execz L_ta8
    v_dot2_f32_bf16 v108, v100, s48, 0
    v_dot2_f32_bf16 v109, v100, s49, 0
    v_dot2_f32_bf16 v110, v100, s50, 0
    v_dot2_f32_bf16 v111, v100, s51, 0
    s_pack_ll_b32_b16 s60, s76, s78
    s_pack_hh_b32_b16 s61, s76, s78
    s_pack_ll_b32_b16 s62, s77, s79
    s_pack_hh_b32_b16 s63, s77, s79
    v_dot2_f32_bf16 v108, v101, s52, v108
    v_dot2_f32_bf16 v109, v101, s53, v109
    v_dot2_f32_bf16 v110, v101, s54, v110
    v_dot2_f32_bf16 v111, v101, s55, v111
    s_pack_ll_b32_b16 s48, s80, s82
    s_pack_hh_b32_b16 s49, s80, s82
    s_pack_ll_b32_b16 s50, s81, s83
    s_pack_hh_b32_b16 s51, s81, s83
    v_dot2_f32_bf16 v108, v102, s56, v108
    v_dot2_f32_bf16 v109, v102, s57, v109
L_ta8:
    s_cbranch_execz L_ta9
    v_dot2_f32_bf16 v110, v102, s58, v110
    v_dot2_f32_bf16 v111, v102, s59, v111
    s_pack_ll_b32_b16 s52, s84, s86
    s_pack_hh_b32_b16 s53, s84, s86
    s_pack_ll_b32_b16 s54, s85, s87
    s_pack_hh_b32_b16 s55, s85, s87
    v_dot2_f32_bf16 v108, v103, s60, v108
    v_dot2_f32_bf16 v109, v103, s61, v109
    v_dot2_f32_bf16 v110, v103, s62, v110
    v_dot2_f32_bf16 v111, v103, s63, v111
    s_pack_ll_b32_b16 s56, s88, s90
    s_pack_hh_b32_b16 s57, s88, s90
    s_pack_ll_b32_b16 s58, s89, s91
    s_pack_hh_b32_b16 s59, s89, s91
    v_dot2_f32_bf16 v108, v104, s48, v108
    v_dot2_f32_bf16 v109, v104, s49, v109
    v_dot2_f32_bf16 v110, v104, s50, v110
    v_dot2_f32_bf16 v111, v104, s51, v111
    s_pack_ll_b32_b16 s60, s92, s94
L_ta9:
    s_cbranch_execz L_ta10
    s_pack_hh_b32_b16 s61, s92, s94
    s_pack_ll_b32_b16 s62, s93, s95
    s_pack_hh_b32_b16 s63, s93, s95
    v_dot2_f32_bf16 v108, v105, s52, v108
    v_dot2_f32_bf16 v109, v105, s53, v109
    v_dot2_f32_bf16 v110, v105, s54, v110
    v_dot2_f32_bf16 v111, v105, s55, v111
    v_dot2_f32_bf16 v108, v106, s56, v108
    v_dot2_f32_bf16 v109, v106, s57, v109
    v_dot2_f32_bf16 v110, v106, s58, v110
    v_dot2_f32_bf16 v111, v106, s59, v111
    v_dot2_f32_bf16 v108, v107, s60, v108
    v_dot2_f32_bf16 v109, v107, s61, v109
    v_dot2_f32_bf16 v110, v107, s62, v110
    v_dot2_f32_bf16 v111, v107, s63, v111
    v_mov_b32 v48, 0x41b8aa3b
L_ta10:
    s_cbranch_execz L_ta11
    v_lshlrev_b32 v84, 2, v84
    v_add_u32 v84, 133120, v84
    v_cvt_pk_bf16_f32 v108, v108, v108
    v_cvt_pk_bf16_f32 v109, v109, v109
    v_cvt_pk_bf16_f32 v110, v110, v110
    v_cvt_pk_bf16_f32 v111, v111, v111
    v_and_b32 v108, 0xffff0000, v108
    v_and_b32 v109, 0xffff0000, v109
    v_and_b32 v110, 0xffff0000, v110
    v_and_b32 v111, 0xffff0000, v111
    v_mul_f32 v108, 0xbfb8aa3b, v108
    v_mul_f32 v109, 0xbfb8aa3b, v109
    v_mul_f32 v110, 0xbfb8aa3b, v110
    v_mul_f32 v111, 0xbfb8aa3b, v111
    v_exp_f32 v108, v108
    v_exp_f32 v109, v109
L_ta11:
    s_cbranch_execz L_taret
    v_exp_f32 v110, v110
    v_exp_f32 v111, v111
    v_add_f32 v108, 1.0, v108
    v_add_f32 v109, 1.0, v109
    v_add_f32 v110, 1.0, v110
    v_add_f32 v111, 1.0, v111
    v_rcp_f32 v108, v108
    v_rcp_f32 v109, v109
    v_rcp_f32 v110, v110
    v_rcp_f32 v111, v111
    v_cvt_pk_bf16_f32 v108, v108, v108
    v_cvt_pk_bf16_f32 v109, v109, v109
    v_cvt_pk_bf16_f32 v110, v110, v110
    v_cvt_pk_bf16_f32 v111, v111, v111
    v_and_b32 v108, 0xffff0000, v108
    v_and_b32 v109, 0xffff0000, v109
    v_and_b32 v110, 0xffff0000, v110
    v_and_b32 v111, 0xffff0000, v111
    v_fmaak_f32 v108, v108, v48, 0xc138aa3b
L_ta12:
    s_cbranch_execz L_ta13
    v_fmaak_f32 v109, v109, v48, 0xc138aa3b
    v_fmaak_f32 v110, v110, v48, 0xc138aa3b
    v_fmaak_f32 v111, v111, v48, 0xc138aa3b
    ds_write_b128 v84, v[108:111] offset:0
    s_setprio 0
L_notab:
    s_waitcnt vmcnt(2)
    v_add_u32 v4, 79872, v47
    v_mov_b32 v3, v143
    s_mul_i32 s99, s3, 1536
    s_add_u32 s99, s99, 136576
    v_add_u32 v5, s99, v45
    v_lshl_add_u32 v6, v46, 1, s99
    v_add_u32 v7, s99, v144
    v_mov_b32 v88, 136192
    s_cmp_lg_u32 s3, 4
    s_cbranch_scc1 L_notau
    s_waitcnt lgkmcnt(0)
    s_lshl_b32 s48, s96, 16
    v_mov_b32 v100, s48
L_ta13:
    s_cbranch_execz L_ta14
    s_and_b32 s49, s96, 0xffff0000
    v_mov_b32 v101, s49
    s_lshl_b32 s50, s97, 16
    v_mov_b32 v102, s50
    s_and_b32 s51, s97, 0xffff0000
    v_mov_b32 v103, s51
    v_min_f32 v100, 0x40930000, v100
    v_max_f32 v100, 0xc2c80000, v100
    v_mul_f32 v100, 0x3fb8aa3b, v100
    v_exp_f32 v100, v100
    v_min_f32 v101, 0x40930000, v101
    v_max_f32 v101, 0xc2c80000, v101
    v_mul_f32 v101, 0x3fb8aa3b, v101
    v_exp_f32 v101, v101
    v_min_f32 v102, 0x40930000, v102
    v_max_f32 v102, 0xc2c80000, v102
    v_mul_f32 v102, 0x3fb8aa3b, v102
    v_exp_f32 v102, v102
L_ta14:
    s_cbranch_execz L_ta15
    v_min_f32 v103, 0x40930000, v103
    v_max_f32 v103, 0xc2c80000, v103
    v_mul_f32 v103, 0x3fb8aa3b, v103
    v_exp_f32 v103, v103
    v_cvt_pk_bf16_f32 v100, v100, v100
    v_and_b32 v100, 0xffff0000, v100
    v_mul_f32 v100, 0x3fb8aa3b, v100
    v_cvt_pk_bf16_f32 v101, v101, v101
    v_and_b32 v101, 0xffff0000, v101
    v_mul_f32 v101, 0x3fb8aa3b, v101
    v_cvt_pk_bf16_f32 v102, v102, v102
    v_and_b32 v102, 0xffff0000, v102
    v_mul_f32 v102, 0x3fb8aa3b, v102
    v_cvt_pk_bf16_f32 v103, v103, v103
    v_and_b32 v103, 0xffff0000, v103
L_ta15:
    s_cbranch_execz L_ta16
    v_mul_f32 v103, 0x3fb8aa3b, v103
    ds_write_b128 v88, v[100:103] offset:0
    v_mov_b32 v104, 0
    v_mov_b32 v105, 0
    v_mov_b32 v106, 0
    v_mov_b32 v107, 0
    ds_write_b128 v88, v[104:107] offset:32
    v_min_u32 v50, 11, v46
    v_mul_u32_u24 v50, 1536, v50
    v_add_u32 v50, v50, v45
    v_add_u32 v50, 137472, v50
    ds_write_b32 v50, v104 offset:0
    v_mov_b32 v108, 0x3f803f80
    v_mov_b32 v109, 0x3f803f80
    v_mov_b32 v110, 0x3f803f80
    v_mov_b32 v111, 0x3f803f80
    ds_write_b128 v4, v[108:111] offset:52224
    v_and_b32 v48, 1, v44
L_ta16:
    s_cbranch_execz L_ta17
    v_lshlrev_b32 v48, 4, v48
    v_mov_b32 v49, 0x3f80
    v_lshlrev_b32 v48, v48, v49
    s_mov_b32 s50, 0x33333333
    s_mov_b32 s51, 0x33333333
    s_waitcnt lgkmcnt(0)
    v_mov_b32 v110, 0
    v_mov_b32 v111, 0
    v_mov_b32 v114, 0
    v_mov_b32 v115, 0
    v_cndmask_b32 v112, 0, v48, s[50:51]
    v_cndmask_b32 v113, v48, 0, s[50:51]
    ds_write_b128 v4, v[112:115] offset:50176
    ds_write_b128 v4, v[110:113] offset:51200
L_notau:
    s_cmp_gt_u32 s3, 8
    s_cbranch_scc1 L_nosc
    v_and_b32 v53, 0xffff, v58
    v_lshrrev_b32 v54, 16, v58
    v_and_b32 v55, 0xffff, v59
    v_lshrrev_b32 v56, 16, v59
L_ta17:
    s_cbranch_execz L_taret
    s_waitcnt vmcnt(0)
    ds_write2st64_b32 v53, v60, v64 offset0:0 offset1:19
    ds_write2st64_b32 v54, v61, v65 offset0:0 offset1:19
    ds_write2st64_b32 v55, v62, v66 offset0:0 offset1:19
    ds_write2st64_b32 v56, v63, v67 offset0:0 offset1:19
    ds_write2st64_b32 v53, v68, v72 offset0:76 offset1:95
    ds_write2st64_b32 v54, v69, v73 offset0:76 offset1:95
    ds_write2st64_b32 v55, v70, v74 offset0:76 offset1:95
    ds_write2st64_b32 v56, v71, v75 offset0:76 offset1:95
    ds_write2st64_b32 v53, v76, v80 offset0:152 offset1:171
    ds_write2st64_b32 v54, v77, v81 offset0:152 offset1:171
    ds_write2st64_b32 v55, v78, v82 offset0:152 offset1:171
    ds_write2st64_b32 v56, v79, v83 offset0:152 offset1:171
L_nosc:
    s_waitcnt lgkmcnt(0)
    s_cmp_lt_u32 s2, 27
    s_cbranch_scc1 L_wmS2
    s_mul_i32 s52, s2, 12
L_ta18:
    s_cbranch_execz L_ta19
    s_add_u32 s52, s52, s3
    s_sub_u32 s52, s52, 324
    s_mul_i32 s46, s52, 19785
    s_lshr_b32 s46, s46, 20
    s_add_u32 s43, s52, s46
    s_mul_i32 s48, s46, 436800
    s_mul_i32 s49, s52, 1344
    s_add_u32 s48, s48, s49
    s_add_u32 s48, s48, 218304
    s_mov_b32 s45, 0
    s_mov_b32 s59, 0
    v_add_u32 v0, s48, v140
    v_add_u32 v1, s48, v141
    v_add_u32 v2, s48, v142
    s_branch L_wmE2
L_wmS2:
    s_mul_i32 s48, s2, 12
    s_add_u32 s48, s48, s3
    s_sub_u32 s48, s48, 324
    s_lshl_b32 s49, s2, 2
    s_add_u32 s49, s49, s3
    s_add_u32 s50, s49, 2696
    s_cmp_lt_u32 s3, 4
L_ta19:
    s_cbranch_execz L_ta20
    s_cselect_b32 s50, 2808, s50
    s_cselect_b32 s51, s49, 999
    s_cmp_ge_u32 s3, 8
    s_cselect_b32 s59, 0x80000000, 0
    s_cselect_b32 s50, 0, s50
    s_cmp_lt_u32 s2, 27
    s_cselect_b32 s52, s50, s48
    s_cselect_b32 s51, s51, 999
    s_cselect_b32 s59, s59, 0
    s_mul_i32 s46, s52, 19785
    s_lshr_b32 s46, s46, 20
    s_mul_i32 s47, s46, 53
    s_sub_u32 s47, s52, s47
    s_sub_u32 s48, s51, 54
    s_cmp_lt_u32 s51, 54
    s_cselect_b32 s48, 53, s48
    s_cselect_b32 s49, s51, 53
    s_cmp_lt_u32 s51, 107
    s_cselect_b32 s46, s48, s46
    s_cselect_b32 s47, s49, s47
    s_cselect_b32 s45, 1, 0
    s_mul_i32 s43, s46, 54
    s_add_u32 s43, s43, s47
L_ta20:
    s_cbranch_execz L_ta21
    s_mul_i32 s44, s43, 4802
    s_mul_i32 s46, s46, 7
    s_add_u32 s46, s46, 3
    s_mul_i32 s47, s47, 7
    s_add_u32 s47, s47, 3
    s_movk_i32 s101, 378
    v_or_b32 v48, s59, v45
    v_mul_u32_u24 v49, 37, v46
    v_lshrrev_b32 v49, 8, v49
    v_mad_i32_i24 v50, v49, -7, v46
    v_add_u32 v49, s46, v49
    v_add_u32 v50, s47, v50
    v_subrev_u32 v51, s101, v49
    v_min_u32 v49, v49, v51
    v_subrev_u32 v51, s101, v50
    v_min_u32 v50, v50, v51
    v_mad_u32_u24 v51, v49, s101, v50
    v_mul_u32_u24 v51, 0xc0, v51
    v_add_u32 v0, v51, v48
    v_add_u32 v1, 16, v46
    v_mul_u32_u24 v49, 37, v1
    v_lshrrev_b32 v49, 8, v49
    v_mad_i32_i24 v50, v49, -7, v1
    v_add_u32 v49, s46, v49
L_ta21:
    s_cbranch_execz L_ta22
    v_add_u32 v50, s47, v50
    v_subrev_u32 v51, s101, v49
    v_min_u32 v49, v49, v51
    v_subrev_u32 v51, s101, v50
    v_min_u32 v50, v50, v51
    v_mad_u32_u24 v51, v49, s101, v50
    v_mul_u32_u24 v51, 0xc0, v51
    v_add_u32 v1, v51, v48
    v_add_u32 v2, 32, v46
    v_mul_u32_u24 v49, 37, v2
    v_lshrrev_b32 v49, 8, v49
    v_mad_i32_i24 v50, v49, -7, v2
    v_add_u32 v49, s46, v49
    v_add_u32 v50, s47, v50
    v_subrev_u32 v51, s101, v49
    v_min_u32 v49, v49, v51
    v_subrev_u32 v51, s101, v50
    v_min_u32 v50, v50, v51
    v_mad_u32_u24 v51, v49, s101, v50
    v_mul_u32_u24 v51, 0xc0, v51
    v_add_u32 v2, v51, v48
L_wmE2:
    s_mul_i32 s44, s43, 4802
L_ta22:
    s_cbranch_execz L_ta23
    s_mov_b32 s98, 133120
    v_mov_b32 v57, 0xc6ea6000
    v_mov_b32 v89, 1
    s_cmp_ge_u32 s3, 8
    s_cbranch_scc1 L_tp
    s_waitcnt vmcnt(0)
    v_min_u32 v92, 0xa8, v92
    v_lshl_add_u32 v92, v92, 4, s98
    v_min_u32 v93, 0xa8, v93
    v_lshl_add_u32 v93, v93, 4, s98
    v_min_u32 v94, 0xa8, v94
    v_lshl_add_u32 v94, v94, 4, s98
    v_min_u32 v95, 0xa8, v95
    v_lshl_add_u32 v95, v95, 4, s98
    v_min_u32 v96, 0xa8, v96
    v_lshl_add_u32 v96, v96, 4, s98
L_ta23:
    s_cbranch_execz L_taret
    v_min_u32 v97, 0xa8, v97
    v_lshl_add_u32 v97, v97, 4, s98
    v_min_u32 v98, 0xa8, v98
    v_lshl_add_u32 v98, v98, 4, s98
    v_min_u32 v99, 0xa8, v99
    v_lshl_add_u32 v99, v99, 4, s98
    v_min_u32 v148, 0xa8, v148
    v_lshl_add_u32 v148, v148, 4, s98
    v_min_u32 v149, 0xa8, v149
    v_lshl_add_u32 v149, v149, 4, s98
    v_min_u32 v150, 0xa8, v150
    v_lshl_add_u32 v150, v150, 4, s98
    v_min_u32 v151, 0xa8, v151
    v_lshl_add_u32 v151, v151, 4, s98
    s_and_b32 s98, s3, 3
L_ta24:
    s_cbranch_execz L_ta25
    s_cmp_eq_u32 s98, 3
    s_cselect_b32 s60, 0xffff0000, 0
    s_cselect_b32 s61, -1, 0
    s_branch L_tq
L_tp:
    s_waitcnt vmcnt(0)
    v_min_u32 v117, 0xa8, v116
    v_lshl_add_u32 v90, v117, 4, s98
    s_sub_u32 s53, s3, 8
    s_mul_i32 s98, s53, 96
    v_add_u32 v60, s98, v3
    s_lshr_b32 s54, s53, 1
    s_and_b32 s55, s53, 1
    s_mul_i32 s99, s54, 96
    v_add_u32 v84, s99, v3
    s_lshl_b32 s100, s55, 6
    v_add_u32 v108, s100, v84
    v_mul_u32_u24 v61, 1536, v46
    s_lshl_b32 s98, s53, 7
    s_add_u32 s98, s98, 136576
    v_add3_u32 v63, v61, v45, s98
    s_lshl_b32 s101, s53, 2
L_ta25:
    s_cbranch_execz L_ta26
    v_add_u32 v62, s101, v88
    s_lshl_b32 s56, s54, 7
    s_add_u32 s56, s56, 137088
    v_lshrrev_b32 v109, 1, v45
    v_add3_u32 v61, v61, v109, s56
    s_mul_i32 s56, s55, 96
    v_add_u32 v109, s56, v61
    v_mov_b32 v105, 0
    v_mov_b32 v106, 0
    v_mov_b32 v107, 0
    v_mov_b32 v85, 0x3f803f80
    v_mov_b32 v86, 0x3f803f80
    v_add_u32 v118, 155008, v47
    s_cmp_lg_u32 s3, 8
    s_cbranch_scc1 L_tp2
    v_lshlrev_b32 v153, 2, v44
    v_add_u32 v153, 136256, v153
    ds_write_b32 v153, v91 offset:0
    ds_write_b128 v118, v[8:11] offset:0
L_ta26:
    s_cbranch_execz L_ta27
    ds_write_b128 v118, v[12:15] offset:1024
    ds_write_b128 v118, v[16:19] offset:2048
    s_waitcnt lgkmcnt(0)
L_tp2:
    v_cmp_lt_u32 s[56:57], 48, v44
L_tq:
    s_mov_b32 s36, 0x2a8cbccc
    s_mov_b32 s37, 0x397ba882
    s_mov_b32 s38, 0x33333333
    s_mov_b32 s39, 0x33333333
    s_mov_b32 s40, 0xcccccccc
    s_mov_b32 s41, 0xcccccccc
    s_cmp_lt_u32 s2, 27
    s_cselect_b32 s64, 8, 12
    s_mov_b32 s62, 0x0fff0fff
    s_mov_b32 s63, 0x0fff0fff
    s_barrier
    s_setprio 3
    ds_read_b128 v[156:159], v88 offset:0
L_ta27:
    s_cbranch_execz L_ta28
    s_waitcnt vmcnt(0)
    s_cmp_ge_u32 s3, 8
    s_cbranch_scc1 L_thin
    ds_read_b128 v[100:103], v92 offset:0
    ds_read_b128 v[104:107], v93 offset:0
    ds_read_b128 v[108:111], v94 offset:0
    ds_read_b128 v[112:115], v95 offset:0
    ds_read_b128 v[60:63], v96 offset:0
    ds_read_b128 v[64:67], v97 offset:0
    ds_read_b128 v[68:71], v98 offset:0
    ds_read_b128 v[72:75], v99 offset:0
    ds_read_b128 v[128:131], v148 offset:0
    ds_read_b128 v[132:135], v149 offset:0
    ds_read_b128 v[136:139], v150 offset:0
    ds_read_b128 v[140:143], v151 offset:0
    buffer_load_dwordx4 v[116:119], v152, s[16:19], 0 offen offset:0
L_ta28:
    s_cbranch_execz L_ta29
    buffer_load_dwordx4 v[120:123], v152, s[16:19], 0 offen offset:16
    buffer_load_dwordx4 v[124:127], v152, s[16:19], 0 offen offset:32
    buffer_load_dwordx4 v[8:11], v0, s[4:7], 0 offen offset:0
    buffer_load_dwordx4 v[12:15], v0, s[4:7], 0 offen offset:64
    buffer_load_dwordx4 v[16:19], v0, s[4:7], 0 offen offset:128
    s_waitcnt lgkmcnt(11)
    v_cndmask_b32 v100, v100, v57, s[60:61]
    v_cndmask_b32 v101, v101, v57, s[60:61]
    v_cndmask_b32 v102, v102, v57, s[60:61]
    v_cndmask_b32 v103, v103, v57, s[60:61]
    s_waitcnt lgkmcnt(10)
    v_swap_b32 v101, v104
    s_waitcnt lgkmcnt(9)
    v_swap_b32 v102, v108
    s_waitcnt lgkmcnt(8)
    v_swap_b32 v103, v112
    v_swap_b32 v106, v109
    v_swap_b32 v107, v113
    v_swap_b32 v111, v114
L_ta29:
    s_cbranch_execz L_taret
    ds_write_b128 v87, v[100:103] offset:0
    ds_write_b128 v87, v[104:107] offset:12288
    ds_write_b128 v87, v[108:111] offset:24576
    ds_write_b128 v87, v[112:115] offset:36864
    buffer_load_dwordx4 v[20:23], v1, s[4:7], 0 offen offset:0
    buffer_load_dwordx4 v[24:27], v1, s[4:7], 0 offen offset:64
    buffer_load_dwordx4 v[28:31], v1, s[4:7], 0 offen offset:128
    s_waitcnt lgkmcnt(11)
    v_cndmask_b32 v60, v60, v57, s[60:61]
    v_cndmask_b32 v61, v61, v57, s[60:61]
    v_cndmask_b32 v62, v62, v57, s[60:61]
    v_cndmask_b32 v63, v63, v57, s[60:61]
    s_waitcnt lgkmcnt(10)
    v_swap_b32 v61, v64
    s_waitcnt lgkmcnt(9)
    v_swap_b32 v62, v68
    s_waitcnt lgkmcnt(8)
    v_swap_b32 v63, v72
L_ta30:
    s_cbranch_execz L_ta31
    v_swap_b32 v66, v69
    v_swap_b32 v67, v73
    v_swap_b32 v71, v74
    ds_write_b128 v87, v[60:63] offset:4096
    ds_write_b128 v87, v[64:67] offset:16384
    ds_write_b128 v87, v[68:71] offset:28672
    ds_write_b128 v87, v[72:75] offset:40960
    s_waitcnt lgkmcnt(11)
    v_cndmask_b32 v128, v128, v57, s[60:61]
    v_cndmask_b32 v129, v129, v57, s[60:61]
    v_cndmask_b32 v130, v130, v57, s[60:61]
    v_cndmask_b32 v131, v131, v57, s[60:61]
    s_waitcnt lgkmcnt(10)
    v_swap_b32 v129, v132
    s_waitcnt lgkmcnt(9)
    v_swap_b32 v130, v136
    s_waitcnt lgkmcnt(8)
    v_swap_b32 v131, v140
    v_swap_b32 v134, v137
    v_swap_b32 v135, v141
    v_swap_b32 v139, v142
L_ta31:
    s_cbranch_execz L_ta32
    ds_write_b128 v87, v[128:131] offset:8192
    ds_write_b128 v87, v[132:135] offset:20480
    ds_write_b128 v87, v[136:139] offset:32768
    ds_write_b128 v87, v[140:143] offset:45056
    s_mov_b64 exec, 1
    ds_add_u32 v88, v89 offset:32
    s_mov_b64 exec, -1
    buffer_load_dwordx4 v[32:35], v2, s[4:7], 0 offen offset:0
    buffer_load_dwordx4 v[36:39], v2, s[4:7], 0 offen offset:64
    buffer_load_dwordx4 v[40:43], v2, s[4:7], 0 offen offset:128
    s_branch L_xdone
L_thin:
    s_waitcnt vmcnt(0)
    ds_read_b128 v[8:11], v118 offset:0
    ds_read_b64_tr_b16 v[128:129], v60 offset:0
    ds_read_b64_tr_b16 v[130:131], v60 offset:9728
    ds_read_b64_tr_b16 v[140:141], v60 offset:32
L_ta32:
    s_cbranch_execz L_ta33
    ds_read_b64_tr_b16 v[142:143], v60 offset:9760
    ds_read_b64_tr_b16 v[24:25], v60 offset:64
    ds_read_b64_tr_b16 v[26:27], v60 offset:9792
    ds_read_b128 v[12:15], v118 offset:1024
    ds_read_b64_tr_b16 v[132:133], v60 offset:19456
    ds_read_b64_tr_b16 v[134:135], v60 offset:29184
    ds_read_b64_tr_b16 v[144:145], v60 offset:19488
    ds_read_b64_tr_b16 v[146:147], v60 offset:29216
    ds_read_b64_tr_b16 v[28:29], v60 offset:19520
    ds_read_b64_tr_b16 v[30:31], v60 offset:29248
    s_waitcnt lgkmcnt(11)
    v_mfma_f32_16x16x32_bf16 v[64:67], v[128:131], v[8:11], 0
    ds_read_b128 v[16:19], v118 offset:2048
    ds_read_b64_tr_b16 v[136:137], v60 offset:38912
    s_waitcnt lgkmcnt(11)
L_ta33:
    s_cbranch_execz L_ta34
    v_mfma_f32_16x16x32_bf16 v[68:71], v[140:143], v[8:11], 0
    ds_read_b64_tr_b16 v[138:139], v60 offset:48640
    ds_read_b64_tr_b16 v[20:21], v60 offset:38944
    s_waitcnt lgkmcnt(11)
    v_mfma_f32_16x16x32_bf16 v[72:75], v[24:27], v[8:11], 0
    ds_read_b64_tr_b16 v[22:23], v60 offset:48672
    ds_read_b64_tr_b16 v[32:33], v60 offset:38976
    s_waitcnt lgkmcnt(10)
    v_mfma_f32_16x16x32_bf16 v[64:67], v[132:135], v[12:15], v[64:67]
    ds_read_b64_tr_b16 v[34:35], v60 offset:48704
    ds_read_b128 v[100:103], v4 offset:50176
    s_waitcnt lgkmcnt(10)
    v_mfma_f32_16x16x32_bf16 v[68:71], v[144:147], v[12:15], v[68:71]
    ds_read_b64_tr_b16 v[36:37], v108 offset:384
    ds_read_b64_tr_b16 v[38:39], v108 offset:10112
    ds_read_b64_tr_b16 v[116:117], v84 offset:416
L_ta34:
    s_cbranch_execz L_ta35
    s_waitcnt lgkmcnt(11)
    v_mfma_f32_16x16x32_bf16 v[72:75], v[28:31], v[12:15], v[72:75]
    ds_read_b64_tr_b16 v[118:119], v84 offset:10144
    ds_read_b64_tr_b16 v[40:41], v108 offset:19840
    ds_read_b64_tr_b16 v[42:43], v108 offset:29568
    s_waitcnt lgkmcnt(11)
    v_mfma_f32_16x16x32_bf16 v[64:67], v[136:139], v[16:19], v[64:67]
    ds_read_b64_tr_b16 v[120:121], v84 offset:19872
    ds_read_b64_tr_b16 v[122:123], v84 offset:29600
    s_waitcnt lgkmcnt(11)
    v_mfma_f32_16x16x32_bf16 v[68:71], v[20:23], v[16:19], v[68:71]
    ds_read_b64_tr_b16 v[112:113], v108 offset:39296
    ds_read_b64_tr_b16 v[114:115], v108 offset:49024
    s_waitcnt lgkmcnt(11)
    v_mfma_f32_16x16x32_bf16 v[72:75], v[32:35], v[16:19], v[72:75]
    ds_read_b64_tr_b16 v[124:125], v84 offset:39328
L_ta35:
    s_cbranch_execz L_taret
    ds_read_b64_tr_b16 v[126:127], v84 offset:49056
    ds_read_b32 v62, v62 offset:0
    s_waitcnt lgkmcnt(11)
    v_mfma_f32_16x16x32_bf16 v[76:79], v[36:39], v[8:11], 0
    ds_read_b128 v[148:151], v90 offset:0
    v_fma_f32 v110, v64, v64, s36
    v_fma_f32 v111, v70, v70, s36
    v_fmac_f32 v110, v65, v65
    v_fmac_f32 v111, v71, v71
    v_fmac_f32 v110, v66, v66
    v_fmac_f32 v111, v72, v72
    v_fmac_f32 v110, v67, v67
    v_fmac_f32 v111, v73, v73
    v_fmac_f32 v110, v68, v68
    v_fmac_f32 v111, v74, v74
    v_fmac_f32 v110, v69, v69
    v_fmac_f32 v111, v75, v75
    v_cvt_pk_bf16_f32 v104, v110, v111
    s_waitcnt lgkmcnt(10)
    v_mfma_f32_16x16x32_bf16 v[80:83], v[116:119], v[8:11], 0
L_ta36:
    s_cbranch_execz L_ta37
    v_mfma_f32_16x16x32_bf16 v[20:23], v[100:103], v[104:107], 0
    s_waitcnt lgkmcnt(8)
    v_mfma_f32_16x16x32_bf16 v[76:79], v[40:43], v[12:15], v[76:79]
    s_waitcnt lgkmcnt(6)
    v_mfma_f32_16x16x32_bf16 v[80:83], v[120:123], v[12:15], v[80:83]
    s_nop 3
    v_rsq_f32 v20, v20
    s_waitcnt lgkmcnt(4)
    v_mfma_f32_16x16x32_bf16 v[76:79], v[112:115], v[16:19], v[76:79]
    s_waitcnt lgkmcnt(1)
    v_mul_f32 v20, v20, v62
    v_rsq_f32 v21, v21
    v_mfma_f32_16x16x32_bf16 v[80:83], v[124:127], v[16:19], v[80:83]
    v_mul_f32 v64, v64, v20
    v_mul_f32 v65, v65, v20
    v_mul_f32 v66, v66, v20
    v_mul_f32 v67, v67, v20
    v_cvt_pk_bf16_f32 v64, v64, v65
    v_mul_f32 v68, v68, v20
    v_mul_f32 v69, v69, v20
    v_cvt_pk_bf16_f32 v65, v66, v67
    v_mul_f32 v70, v70, v21
L_ta37:
    s_cbranch_execz L_ta38
    v_mul_f32 v71, v71, v21
    v_cvt_pk_bf16_f32 v66, v68, v69
    v_cvt_pk_bf16_f32 v76, v76, v77
    s_waitcnt lgkmcnt(0)
    v_cndmask_b32 v148, v148, v57, s[56:57]
    v_cndmask_b32 v149, v149, v57, s[56:57]
    v_cndmask_b32 v150, v150, v57, s[56:57]
    v_cndmask_b32 v151, v151, v57, s[56:57]
    v_mul_f32 v72, v72, v21
    v_mul_f32 v73, v73, v21
    v_mul_f32 v74, v74, v21
    v_mul_f32 v75, v75, v21
    v_cvt_pk_bf16_f32 v68, v70, v71
    v_cvt_pk_bf16_f32 v77, v78, v79
    v_cvt_pk_bf16_f32 v84, v80, v81
    v_cvt_pk_bf16_f32 v87, v82, v83
    ds_write_b128 v4, v[148:151] offset:49152
    v_mov_b32 v67, 0
L_ta38:
    s_cbranch_execz L_ta39
    v_cvt_pk_bf16_f32 v69, v72, v73
    v_cvt_pk_bf16_f32 v70, v74, v75
    v_mov_b32 v71, 0
    s_mov_b64 exec, s[62:63]
    ds_write_b64 v109, v[76:77] offset:0
    ds_write_b64 v61, v[84:85] offset:32
    ds_write_b64 v61, v[86:87] offset:64
    ds_write_b128 v63, v[68:71] offset:0
    ds_write_b128 v63, v[64:67] offset:64
    s_mov_b64 exec, -1
L_sig0:
    s_mov_b64 exec, 1
    ds_add_u32 v88, v89 offset:32
    s_mov_b64 exec, -1
    buffer_load_dwordx4 v[116:119], v152, s[16:19], 0 offen offset:0
    buffer_load_dwordx4 v[120:123], v152, s[16:19], 0 offen offset:16
    buffer_load_dwordx4 v[124:127], v152, s[16:19], 0 offen offset:32
    buffer_load_dwordx4 v[8:11], v0, s[4:7], 0 offen offset:0
L_ta39:
    s_cbranch_execz L_ta40
    buffer_load_dwordx4 v[12:15], v0, s[4:7], 0 offen offset:64
    buffer_load_dwordx4 v[16:19], v0, s[4:7], 0 offen offset:128
    buffer_load_dwordx4 v[20:23], v1, s[4:7], 0 offen offset:0
    buffer_load_dwordx4 v[24:27], v1, s[4:7], 0 offen offset:64
    buffer_load_dwordx4 v[28:31], v1, s[4:7], 0 offen offset:128
    buffer_load_dwordx4 v[32:35], v2, s[4:7], 0 offen offset:0
    buffer_load_dwordx4 v[36:39], v2, s[4:7], 0 offen offset:64
    buffer_load_dwordx4 v[40:43], v2, s[4:7], 0 offen offset:128
L_xdone:
    s_waitcnt lgkmcnt(1)
    v_readfirstlane_b32 s32, v156
    v_readfirstlane_b32 s33, v157
    v_readfirstlane_b32 s34, v158
    v_readfirstlane_b32 s35, v159
    s_max_u32 s98, s32, s33
    s_nop 0
    s_max_u32 s99, s34, s35
    s_max_u32 s98, s98, s99
    s_cmp_gt_u32 s98, 0x420a7fac
    s_cselect_b32 s42, 1, 0
    s_cmp_ge_u32 s3, 10
L_ta40:
    s_cbranch_execz L_ta41
    s_cbranch_scc1 L_nowo
    s_waitcnt vmcnt(11)
    v_lshlrev_b32 v128, 16, v116
    v_and_b32 v129, 0xffff0000, v116
    v_lshlrev_b32 v130, 16, v117
    v_and_b32 v131, 0xffff0000, v117
    v_lshlrev_b32 v132, 16, v118
    v_and_b32 v133, 0xffff0000, v118
    v_lshlrev_b32 v134, 16, v119
    v_and_b32 v135, 0xffff0000, v119
    s_waitcnt vmcnt(10)
    v_lshlrev_b32 v136, 16, v120
    v_and_b32 v137, 0xffff0000, v120
    v_lshlrev_b32 v138, 16, v121
    v_and_b32 v139, 0xffff0000, v121
    v_lshlrev_b32 v140, 16, v122
    v_and_b32 v141, 0xffff0000, v122
    v_lshlrev_b32 v142, 16, v123
    v_and_b32 v143, 0xffff0000, v123
    s_waitcnt vmcnt(9)
    v_lshlrev_b32 v144, 16, v124
L_ta41:
    s_cbranch_execz L_taret
    v_and_b32 v145, 0xffff0000, v124
    v_lshlrev_b32 v146, 16, v125
    v_and_b32 v147, 0xffff0000, v125
    v_lshlrev_b32 v148, 16, v126
    v_and_b32 v149, 0xffff0000, v126
    v_lshlrev_b32 v150, 16, v127
    v_and_b32 v151, 0xffff0000, v127
    v_pk_add_f32 v[50:51], v[128:129], v[130:131]
    v_pk_add_f32 v[50:51], v[50:51], v[132:133]
    v_pk_add_f32 v[50:51], v[50:51], v[134:135]
    v_pk_add_f32 v[50:51], v[50:51], v[136:137]
    v_pk_add_f32 v[50:51], v[50:51], v[138:139]
    v_pk_add_f32 v[50:51], v[50:51], v[140:141]
    v_pk_add_f32 v[50:51], v[50:51], v[142:143]
    v_pk_add_f32 v[50:51], v[50:51], v[144:145]
    v_pk_add_f32 v[50:51], v[50:51], v[146:147]
L_ta42:
    s_cbranch_execz L_ta43
    v_pk_add_f32 v[50:51], v[50:51], v[148:149]
    v_pk_add_f32 v[50:51], v[50:51], v[150:151]
    v_add_f32 v50, v50, v51
    s_nop 1
    v_add_f32_dpp v50, v50, v50 quad_perm:[1,0,3,2] row_mask:0xf bank_mask:0xf
    s_nop 1
    v_add_f32_dpp v50, v50, v50 quad_perm:[2,3,0,1] row_mask:0xf bank_mask:0xf
    v_mul_f32 v50, 0xbc2aaaab, v50
    v_pk_add_f32 v[128:129], v[128:129], v[50:51] op_sel_hi:[1,0]
    v_pk_add_f32 v[130:131], v[130:131], v[50:51] op_sel_hi:[1,0]
    v_pk_add_f32 v[132:133], v[132:133], v[50:51] op_sel_hi:[1,0]
    v_pk_add_f32 v[134:135], v[134:135], v[50:51] op_sel_hi:[1,0]
    v_pk_add_f32 v[136:137], v[136:137], v[50:51] op_sel_hi:[1,0]
    v_pk_add_f32 v[138:139], v[138:139], v[50:51] op_sel_hi:[1,0]
    v_pk_add_f32 v[140:141], v[140:141], v[50:51] op_sel_hi:[1,0]
    v_pk_add_f32 v[142:143], v[142:143], v[50:51] op_sel_hi:[1,0]
L_ta43:
    s_cbranch_execz L_ta44
    v_pk_add_f32 v[144:145], v[144:145], v[50:51] op_sel_hi:[1,0]
    v_pk_add_f32 v[146:147], v[146:147], v[50:51] op_sel_hi:[1,0]
    v_pk_add_f32 v[148:149], v[148:149], v[50:51] op_sel_hi:[1,0]
    v_pk_add_f32 v[150:151], v[150:151], v[50:51] op_sel_hi:[1,0]
    v_cvt_pk_bf16_f32 v116, v128, v129
    v_cvt_pk_bf16_f32 v117, v130, v131
    v_cvt_pk_bf16_f32 v118, v132, v133
    v_cvt_pk_bf16_f32 v119, v134, v135
    v_cvt_pk_bf16_f32 v120, v136, v137
    v_cvt_pk_bf16_f32 v121, v138, v139
    v_cvt_pk_bf16_f32 v122, v140, v141
    v_cvt_pk_bf16_f32 v123, v142, v143
    v_cvt_pk_bf16_f32 v124, v144, v145
    v_cvt_pk_bf16_f32 v125, v146, v147
L_ta44:
    s_cbranch_execz L_ta45
    v_cvt_pk_bf16_f32 v126, v148, v149
    v_cvt_pk_bf16_f32 v127, v150, v151
    s_mov_b32 s98, 58368
    v_and_b32 v60, 0xffff, v154
    v_lshrrev_b32 v61, 16, v154
    v_and_b32 v62, 0xffff, v155
    v_add_u32 v60, s98, v60
    ds_write2_b64 v60, v[116:117], v[118:119] offset0:0 offset1:4
    v_add_u32 v61, s98, v61
    ds_write2_b64 v61, v[120:121], v[122:123] offset0:0 offset1:4
    v_add_u32 v62, s98, v62
    ds_write2_b64 v62, v[124:125], v[126:127] offset0:0 offset1:4
    s_mov_b64 exec, 1
    ds_add_u32 v88, v89 offset:36
    s_mov_b64 exec, -1
L_nowo:
    s_waitcnt vmcnt(9) lgkmcnt(0)
    s_setprio 0
    s_cmp_lg_u32 s59, 0
    s_cbranch_scc1 L_end
    s_branch L_join
L_pathO:
L_ta45:
    s_cbranch_execz L_ta46
    s_waitcnt vmcnt(6)
    s_cmp_lt_u32 s2, 27
    s_cbranch_scc1 L_wmS1
    s_waitcnt lgkmcnt(0)
    s_mul_i32 s70, s2, 12
    s_add_u32 s70, s70, s3
    s_sub_u32 s70, s70, 324
    s_mul_i32 s46, s70, 19785
    s_lshr_b32 s46, s46, 20
    s_add_u32 s43, s70, s46
    s_mul_i32 s66, s46, 436800
    s_mul_i32 s67, s70, 1344
    s_add_u32 s66, s66, s67
    s_add_u32 s66, s66, 218304
    s_mov_b32 s45, 0
    s_mov_b32 s59, 0
    v_add_u32 v0, s66, v140
    v_add_u32 v1, s66, v141
    v_add_u32 v2, s66, v142
    s_branch L_wmE1
L_wmS1:
    s_waitcnt lgkmcnt(0)
    s_mul_i32 s66, s2, 12
    s_add_u32 s66, s66, s3
L_ta46:
    s_cbranch_execz L_ta47
    s_sub_u32 s66, s66, 324
    s_lshl_b32 s67, s2, 2
    s_add_u32 s67, s67, s3
    s_add_u32 s68, s67, 2696
    s_cmp_lt_u32 s3, 4
    s_cselect_b32 s68, 2808, s68
    s_cselect_b32 s69, s67, 999
    s_cmp_ge_u32 s3, 8
    s_cselect_b32 s59, 0x80000000, 0
    s_cselect_b32 s68, 0, s68
    s_cmp_lt_u32 s2, 27
    s_cselect_b32 s70, s68, s66
    s_cselect_b32 s69, s69, 999
    s_cselect_b32 s59, s59, 0
    s_mul_i32 s46, s70, 19785
    s_lshr_b32 s46, s46, 20
    s_mul_i32 s47, s46, 53
    s_sub_u32 s47, s70, s47
    s_sub_u32 s66, s69, 54
    s_cmp_lt_u32 s69, 54
    s_cselect_b32 s66, 53, s66
    s_cselect_b32 s67, s69, 53
L_ta47:
    s_cbranch_execz L_taret
    s_cmp_lt_u32 s69, 107
    s_cselect_b32 s46, s66, s46
    s_cselect_b32 s47, s67, s47
    s_cselect_b32 s45, 1, 0
    s_mul_i32 s43, s46, 54
    s_add_u32 s43, s43, s47
    s_mul_i32 s44, s43, 4802
    s_mul_i32 s46, s46, 7
    s_add_u32 s46, s46, 3
    s_mul_i32 s47, s47, 7
    s_add_u32 s47, s47, 3
    s_movk_i32 s101, 378
    v_or_b32 v48, s59, v45
    v_mul_u32_u24 v49, 37, v46
    v_lshrrev_b32 v49, 8, v49
    v_mad_i32_i24 v50, v49, -7, v46
    v_add_u32 v49, s46, v49
    v_add_u32 v50, s47, v50
    v_subrev_u32 v51, s101, v49
    v_min_u32 v49, v49, v51
    v_subrev_u32 v51, s101, v50
    v_min_u32 v50, v50, v51
    v_mad_u32_u24 v51, v49, s101, v50
    v_mul_u32_u24 v51, 0xc0, v51
L_ta48:
    s_cbranch_execz L_ta49
    v_add_u32 v0, v51, v48
    v_add_u32 v1, 16, v46
    v_mul_u32_u24 v49, 37, v1
    v_lshrrev_b32 v49, 8, v49
    v_mad_i32_i24 v50, v49, -7, v1
    v_add_u32 v49, s46, v49
    v_add_u32 v50, s47, v50
    v_subrev_u32 v51, s101, v49
    v_min_u32 v49, v49, v51
    v_subrev_u32 v51, s101, v50
    v_min_u32 v50, v50, v51
    v_mad_u32_u24 v51, v49, s101, v50
    v_mul_u32_u24 v51, 0xc0, v51
    v_add_u32 v1, v51, v48
    v_add_u32 v2, 32, v46
    v_mul_u32_u24 v49, 37, v2
    v_lshrrev_b32 v49, 8, v49
    v_mad_i32_i24 v50, v49, -7, v2
    v_add_u32 v49, s46, v49
    v_add_u32 v50, s47, v50
    v_subrev_u32 v51, s101, v49
    v_min_u32 v49, v49, v51
    v_subrev_u32 v51, s101, v50
    v_min_u32 v50, v50, v51
L_ta49:
    s_cbranch_execz L_ta50
    v_mad_u32_u24 v51, v49, s101, v50
    v_mul_u32_u24 v51, 0xc0, v51
    v_add_u32 v2, v51, v48
L_wmE1:
    s_mul_i32 s44, s43, 4802
    s_barrier
    buffer_load_dwordx4 v[8:11], v0, s[4:7], 0 offen offset:0
    buffer_load_dwordx4 v[12:15], v0, s[4:7], 0 offen offset:64
    buffer_load_dwordx4 v[16:19], v0, s[4:7], 0 offen offset:128
    buffer_load_dwordx4 v[20:23], v1, s[4:7], 0 offen offset:0
    buffer_load_dwordx4 v[24:27], v1, s[4:7], 0 offen offset:64
    buffer_load_dwordx4 v[28:31], v1, s[4:7], 0 offen offset:128
    buffer_load_dwordx4 v[32:35], v2, s[4:7], 0 offen offset:0
    buffer_load_dwordx4 v[36:39], v2, s[4:7], 0 offen offset:64
    buffer_load_dwordx4 v[40:43], v2, s[4:7], 0 offen offset:128
    v_and_b32 v53, 0xffff, v58
    v_lshrrev_b32 v54, 16, v58
L_ta50:
    s_cbranch_execz L_ta51
    v_and_b32 v55, 0xffff, v59
    v_lshrrev_b32 v56, 16, v59
    s_waitcnt vmcnt(9)
    ds_write2st64_b32 v53, v60, v64 offset0:0 offset1:19
    ds_write2st64_b32 v54, v61, v65 offset0:0 offset1:19
    ds_write2st64_b32 v55, v62, v66 offset0:0 offset1:19
    ds_write2st64_b32 v56, v63, v67 offset0:0 offset1:19
    ds_write2st64_b32 v53, v68, v72 offset0:76 offset1:95
    ds_write2st64_b32 v54, v69, v73 offset0:76 offset1:95
    ds_write2st64_b32 v55, v70, v74 offset0:76 offset1:95
    ds_write2st64_b32 v56, v71, v75 offset0:76 offset1:95
    ds_write2st64_b32 v53, v76, v80 offset0:152 offset1:171
    ds_write2st64_b32 v54, v77, v81 offset0:152 offset1:171
    ds_write2st64_b32 v55, v78, v82 offset0:152 offset1:171
    ds_write2st64_b32 v56, v79, v83 offset0:152 offset1:171
L_ta51:
    s_cbranch_execz L_ta52
    v_add_u32 v4, 79872, v47
    v_mov_b32 v3, v143
    s_mul_i32 s99, s3, 1536
    s_add_u32 s99, s99, 136576
    v_add_u32 v5, s99, v45
    v_lshl_add_u32 v6, v46, 1, s99
    v_add_u32 v7, s99, v144
    v_mov_b32 v88, 136192
    s_mov_b32 s36, 0x2a8cbccc
    s_mov_b32 s37, 0x397ba882
    s_mov_b32 s38, 0x33333333
    s_mov_b32 s39, 0x33333333
    s_mov_b32 s40, 0xcccccccc
    s_mov_b32 s41, 0xcccccccc
    s_cmp_lt_u32 s2, 27
    s_waitcnt lgkmcnt(0)
    s_cselect_b32 s64, 8, 12
    s_barrier
L_ta52:
    s_cbranch_execz L_ta53
    ds_read_b128 v[156:159], v88 offset:0
    s_waitcnt lgkmcnt(0)
    v_readfirstlane_b32 s32, v156
    v_readfirstlane_b32 s33, v157
    v_readfirstlane_b32 s34, v158
    v_readfirstlane_b32 s35, v159
    s_max_u32 s98, s32, s33
    s_nop 0
    s_max_u32 s99, s34, s35
    s_max_u32 s98, s98, s99
    s_cmp_gt_u32 s98, 0x420a7fac
    s_cselect_b32 s42, 1, 0
L_join:
    s_waitcnt lgkmcnt(0)
    s_sub_u32 s28, s20, 79872
    s_subb_u32 s29, s21, 0
    s_add_u32 s28, s28, s44
    s_addc_u32 s29, s29, 0
    s_mov_b32 s30, 84676
    s_mov_b32 s31, 0x00020000
    s_mov_b64 s[52:53], 0
    s_mov_b32 s56, 0x7fff7fff
    s_movk_i32 s57, 4096
L_ta53:
    s_cbranch_execz L_taret
    s_mov_b32 s65, 1000000
    s_or_b32 s98, s45, s42
    s_cbranch_scc1 L_slow
    ds_read_b64_tr_b16 v[144:145], v3 offset:0
    ds_read_b64_tr_b16 v[146:147], v3 offset:9728
    ds_read_b64_tr_b16 v[148:149], v3 offset:19456
    ds_read_b64_tr_b16 v[150:151], v3 offset:29184
    ds_read_b64_tr_b16 v[152:153], v3 offset:38912
    ds_read_b64_tr_b16 v[154:155], v3 offset:48640
    ds_read_b64_tr_b16 v[156:157], v3 offset:32
    ds_read_b64_tr_b16 v[158:159], v3 offset:9760
    ds_read_b128 v[140:143], v4 offset:51200
    ds_read_b64_tr_b16 v[166:167], v3 offset:29568
    ds_read_b128 v[84:87], v4 offset:52224
    ds_read_b128 v[88:91], v4 offset:52224
    s_setprio 3
L_ta54:
    s_cbranch_execz L_ta55
    ds_read_b128 v[92:95], v4 offset:52224
    s_waitcnt vmcnt(8) lgkmcnt(11)
    v_mfma_f32_16x16x32_bf16 v[104:107], v[144:147], v[8:11], 0
    ds_read_b128 v[96:99], v4 offset:52224
    ds_read_b128 v[100:103], v4 offset:52224
    s_waitcnt vmcnt(5)
    v_mfma_f32_16x16x32_bf16 v[116:119], v[144:147], v[20:23], 0
    s_waitcnt vmcnt(2)
    v_mfma_f32_16x16x32_bf16 v[128:131], v[144:147], v[32:35], 0
    ds_read_b64_tr_b16 v[144:145], v3 offset:19488
    ds_read_b64_tr_b16 v[146:147], v3 offset:29216
    s_waitcnt lgkmcnt(13)
    v_mfma_f32_16x16x32_bf16 v[104:107], v[148:151], v[12:15], v[104:107]
    v_mfma_f32_16x16x32_bf16 v[116:119], v[148:151], v[24:27], v[116:119]
    s_waitcnt vmcnt(1)
    v_mfma_f32_16x16x32_bf16 v[128:131], v[148:151], v[36:39], v[128:131]
    ds_read_b64_tr_b16 v[148:149], v3 offset:38944
L_ta55:
    s_cbranch_execz L_ta56
    ds_read_b64_tr_b16 v[150:151], v3 offset:48672
    s_waitcnt lgkmcnt(13)
    v_mfma_f32_16x16x32_bf16 v[104:107], v[152:155], v[16:19], v[104:107]
    v_mfma_f32_16x16x32_bf16 v[116:119], v[152:155], v[28:31], v[116:119]
    s_waitcnt vmcnt(0)
    v_mfma_f32_16x16x32_bf16 v[128:131], v[152:155], v[40:43], v[128:131]
    ds_read_b64_tr_b16 v[152:153], v3 offset:64
    ds_read_b64_tr_b16 v[154:155], v3 offset:9792
    s_waitcnt lgkmcnt(13)
    v_mfma_f32_16x16x32_bf16 v[108:111], v[156:159], v[8:11], 0
    s_nop 0
    v_fma_f32 v160, v104, v104, s36
    v_fma_f32 v162, v116, v116, s36
    v_mfma_f32_16x16x32_bf16 v[120:123], v[156:159], v[20:23], 0
    v_fmac_f32 v160, v105, v105
    v_fmac_f32 v162, v117, v117
    v_mfma_f32_16x16x32_bf16 v[132:135], v[156:159], v[32:35], 0
L_ta56:
    s_cbranch_execz L_ta57
    ds_read_b64_tr_b16 v[156:157], v3 offset:19520
    ds_read_b64_tr_b16 v[158:159], v3 offset:29248
    s_waitcnt lgkmcnt(6)
    v_mfma_f32_16x16x32_bf16 v[108:111], v[144:147], v[12:15], v[108:111]
    v_fmac_f32 v160, v106, v106
    v_fmac_f32 v162, v118, v118
    v_mfma_f32_16x16x32_bf16 v[120:123], v[144:147], v[24:27], v[120:123]
    v_fmac_f32 v160, v107, v107
    v_fmac_f32 v162, v119, v119
    v_mfma_f32_16x16x32_bf16 v[132:135], v[144:147], v[36:39], v[132:135]
    ds_read_b64_tr_b16 v[144:145], v3 offset:38976
    ds_read_b64_tr_b16 v[146:147], v3 offset:48704
    s_waitcnt lgkmcnt(6)
    v_mfma_f32_16x16x32_bf16 v[108:111], v[148:151], v[16:19], v[108:111]
    v_fma_f32 v164, v128, v128, s36
    v_fmac_f32 v164, v129, v129
    v_mfma_f32_16x16x32_bf16 v[120:123], v[148:151], v[28:31], v[120:123]
    v_fmac_f32 v164, v130, v130
    v_fmac_f32 v164, v131, v131
L_ta57:
    s_cbranch_execz L_ta58
    v_mfma_f32_16x16x32_bf16 v[132:135], v[148:151], v[40:43], v[132:135]
    s_nop 1
    v_fma_f32 v161, v110, v110, s36
    s_waitcnt lgkmcnt(4)
    v_mfma_f32_16x16x32_bf16 v[112:115], v[152:155], v[8:11], 0
    v_fmac_f32 v161, v111, v111
    v_fma_f32 v163, v122, v122, s36
    v_mfma_f32_16x16x32_bf16 v[124:127], v[152:155], v[20:23], 0
    v_fmac_f32 v163, v123, v123
    v_fmac_f32 v160, v108, v108
    v_mfma_f32_16x16x32_bf16 v[136:139], v[152:155], v[32:35], 0
    v_fmac_f32 v162, v120, v120
    v_fmac_f32 v160, v109, v109
    s_waitcnt lgkmcnt(2)
    v_mfma_f32_16x16x32_bf16 v[112:115], v[156:159], v[12:15], v[112:115]
    v_fmac_f32 v162, v121, v121
    v_fma_f32 v165, v134, v134, s36
    v_mfma_f32_16x16x32_bf16 v[124:127], v[156:159], v[24:27], v[124:127]
    v_fmac_f32 v165, v135, v135
    v_fmac_f32 v164, v132, v132
L_ta58:
    s_cbranch_execz L_ta59
    v_mfma_f32_16x16x32_bf16 v[136:139], v[156:159], v[36:39], v[136:139]
    ds_read_b128 v[156:159], v4 offset:50176
    v_fmac_f32 v164, v133, v133
    s_waitcnt lgkmcnt(1)
    v_mfma_f32_16x16x32_bf16 v[112:115], v[144:147], v[16:19], v[112:115]
    v_mfma_f32_16x16x32_bf16 v[124:127], v[144:147], v[28:31], v[124:127]
    v_mfma_f32_16x16x32_bf16 v[136:139], v[144:147], v[40:43], v[136:139]
    ds_read_b32 v147, v5 offset:896
    s_nop 4
    v_fmac_f32 v161, v112, v112
    v_fmac_f32 v161, v113, v113
    v_fmac_f32 v161, v114, v114
    v_fmac_f32 v161, v115, v115
    v_fmac_f32 v163, v124, v124
    v_fmac_f32 v163, v125, v125
    v_fmac_f32 v163, v126, v126
    v_fmac_f32 v163, v127, v127
    v_cvt_pk_bf16_f32 v144, v160, v161
    ds_read_b64_tr_b16 v[160:161], v3 offset:384
    v_cvt_pk_bf16_f32 v145, v162, v163
L_ta59:
    s_cbranch_execz L_taret
    ds_read_b64_tr_b16 v[162:163], v3 offset:10112
    v_fmac_f32 v165, v136, v136
    v_fmac_f32 v165, v137, v137
    v_fmac_f32 v165, v138, v138
    v_fmac_f32 v165, v139, v139
    v_cvt_pk_bf16_f32 v146, v164, v165
    ds_read_b64_tr_b16 v[164:165], v3 offset:19840
    s_waitcnt lgkmcnt(3)
    v_mfma_f32_16x16x32_bf16 v[148:151], v[156:159], v[144:147], 0
    ds_read_b64_tr_b16 v[156:157], v3 offset:39296
    ds_read_b64_tr_b16 v[158:159], v3 offset:49024
    v_mfma_f32_16x16x32_bf16 v[152:155], v[140:143], v[144:147], 0
    s_nop 4
    v_rsq_f32 v148, v148
    s_waitcnt lgkmcnt(3)
    v_mfma_f32_16x16x32_bf16 v[144:147], v[8:11], v[160:163], 0
    v_rsq_f32 v150, v150
    v_rsq_f32 v152, v152
    s_waitcnt lgkmcnt(2)
    v_mfma_f32_16x16x32_bf16 v[144:147], v[12:15], v[164:167], v[144:147]
L_ta60:
    s_cbranch_execz L_ta61
    v_rsq_f32 v149, v149
    v_rsq_f32 v151, v151
    v_rsq_f32 v153, v153
    v_mul_f32 v148, s32, v148
    v_mul_f32 v150, s32, v150
    v_mul_f32 v152, s32, v152
    v_mul_f32 v104, v104, v148
    v_mul_f32 v105, v105, v148
    v_mul_f32 v106, v106, v148
    v_mul_f32 v107, v107, v148
    v_mul_f32 v108, v108, v148
    v_mul_f32 v109, v109, v148
    v_mul_f32 v110, v110, v149
    v_mul_f32 v111, v111, v149
    s_waitcnt lgkmcnt(0)
    v_mfma_f32_16x16x32_bf16 v[144:147], v[16:19], v[156:159], v[144:147]
    v_mul_f32 v112, v112, v149
    v_mul_f32 v113, v113, v149
    v_mul_f32 v114, v114, v149
    v_mul_f32 v115, v115, v149
    v_mul_f32 v116, v116, v150
    v_mul_f32 v117, v117, v150
    v_mul_f32 v118, v118, v150
    v_mul_f32 v119, v119, v150
    v_mul_f32 v120, v120, v150
    v_mul_f32 v121, v121, v150
    v_mul_f32 v122, v122, v151
    v_mul_f32 v123, v123, v151
L_ta61:
    s_cbranch_execz L_ta62
    v_mul_f32 v124, v124, v151
    v_mul_f32 v125, v125, v151
    v_mul_f32 v126, v126, v151
    v_mul_f32 v127, v127, v151
    v_mfma_f32_16x16x32_bf16 v[148:151], v[20:23], v[160:163], 0
    v_mul_f32 v128, v128, v152
    v_mul_f32 v129, v129, v152
    v_mfma_f32_16x16x32_bf16 v[148:151], v[24:27], v[164:167], v[148:151]
    v_mul_f32 v130, v130, v152
    v_mul_f32 v131, v131, v152
    v_mfma_f32_16x16x32_bf16 v[148:151], v[28:31], v[156:159], v[148:151]
    v_mul_f32 v132, v132, v152
    v_mul_f32 v133, v133, v152
    v_mul_f32 v134, v134, v153
    v_mul_f32 v135, v135, v153
    v_mul_f32 v136, v136, v153
    v_mul_f32 v137, v137, v153
    v_mul_f32 v138, v138, v153
    v_mul_f32 v139, v139, v153
    v_mfma_f32_16x16x32_bf16 v[152:155], v[32:35], v[160:163], 0
    ds_read_b64_tr_b16 v[160:161], v3 offset:416
    ds_read_b64_tr_b16 v[162:163], v3 offset:10144
L_ta62:
    s_cbranch_execz L_ta63
    v_mfma_f32_16x16x32_bf16 v[152:155], v[36:39], v[164:167], v[152:155]
    ds_read_b64_tr_b16 v[164:165], v3 offset:19872
    ds_read_b64_tr_b16 v[166:167], v3 offset:29600
    v_mfma_f32_16x16x32_bf16 v[152:155], v[40:43], v[156:159], v[152:155]
    ds_read_b64_tr_b16 v[156:157], v3 offset:39328
    ds_read_b64_tr_b16 v[158:159], v3 offset:49056
L_poll0f:
    v_mov_b32 v140, 136224
    ds_read_b32 v140, v140 offset:0
    s_waitcnt lgkmcnt(0)
    v_readfirstlane_b32 s58, v140
    s_sub_u32 s65, s65, 1
    s_cbranch_scc1 L_poll0fx
    s_cmp_lt_u32 s58, 8
    s_cbranch_scc1 L_poll0f
L_poll0fx:
    ds_read_b128 v[140:143], v5 offset:0
    ds_read_u16 v86, v6 offset:512
    ds_read_u16 v94, v6 offset:544
L_ta63:
    s_cbranch_execz L_ta64
    ds_read_u16 v102, v6 offset:576
    v_cvt_pk_bf16_f32 v104, v104, v105
    v_cvt_pk_bf16_f32 v116, v116, v117
    v_cvt_pk_bf16_f32 v105, v106, v107
    ds_read_b32 v107, v5 offset:896
    v_cvt_pk_bf16_f32 v117, v118, v119
    ds_read_b32 v119, v5 offset:896
    v_cvt_pk_bf16_f32 v80, v144, v145
    v_cvt_pk_bf16_f32 v81, v146, v147
    v_cvt_pk_bf16_f32 v82, v148, v149
    v_cvt_pk_bf16_f32 v83, v150, v151
    v_cvt_pk_bf16_f32 v84, v152, v153
    v_cvt_pk_bf16_f32 v85, v154, v155
    v_cvt_pk_bf16_f32 v106, v108, v109
L_ta64:
    s_cbranch_execz L_ta65
    v_cvt_pk_bf16_f32 v118, v120, v121
    v_cvt_pk_bf16_f32 v108, v110, v111
    v_mfma_f32_16x16x32_bf16 v[144:147], v[8:11], v[160:163], 0
    ds_read_b32 v111, v5 offset:896
    v_cvt_pk_bf16_f32 v120, v122, v123
    v_mfma_f32_16x16x32_bf16 v[148:151], v[20:23], v[160:163], 0
    ds_read_b32 v123, v5 offset:896
    v_cvt_pk_bf16_f32 v128, v128, v129
    v_mfma_f32_16x16x32_bf16 v[152:155], v[32:35], v[160:163], 0
    ds_read_b128 v[160:163], v5 offset:64
    v_cvt_pk_bf16_f32 v129, v130, v131
    v_mfma_f32_16x16x32_bf16 v[144:147], v[12:15], v[164:167], v[144:147]
    ds_read_b32 v131, v5 offset:896
    v_cvt_pk_bf16_f32 v130, v132, v133
L_ta65:
    s_cbranch_execz L_taret
    v_mfma_f32_16x16x32_bf16 v[148:151], v[24:27], v[164:167], v[148:151]
    v_cvt_pk_bf16_f32 v132, v134, v135
    ds_read_b32 v135, v5 offset:896
    v_mfma_f32_16x16x32_bf16 v[152:155], v[36:39], v[164:167], v[152:155]
    ds_read_b32 v164, v4 offset:49152
    v_cvt_pk_bf16_f32 v109, v112, v113
    v_mfma_f32_16x16x32_bf16 v[144:147], v[16:19], v[156:159], v[144:147]
    v_cvt_pk_bf16_f32 v110, v114, v115
    ds_read_b32 v115, v5 offset:896
    v_mfma_f32_16x16x32_bf16 v[148:151], v[28:31], v[156:159], v[148:151]
    v_cvt_pk_bf16_f32 v121, v124, v125
    v_cvt_pk_bf16_f32 v122, v126, v127
    v_mfma_f32_16x16x32_bf16 v[152:155], v[40:43], v[156:159], v[152:155]
    ds_read_b32 v127, v5 offset:896
L_ta66:
    s_cbranch_execz L_taret
    v_cvt_pk_bf16_f32 v133, v136, v137
    v_cvt_pk_bf16_f32 v134, v138, v139
    s_mov_b64 exec, s[38:39]
    v_cvt_pk_bf16_f32 v88, v144, v145
    v_cvt_pk_bf16_f32 v89, v146, v147
    v_cvt_pk_bf16_f32 v90, v148, v149
    v_cvt_pk_bf16_f32 v91, v150, v151
    v_cvt_pk_bf16_f32 v92, v152, v153
    v_cvt_pk_bf16_f32 v93, v154, v155
    s_mov_b64 exec, -1
    s_waitcnt lgkmcnt(5)
    v_mfma_f32_16x16x32_bf16 v[156:159], v[160:163], v[140:143], 0
    s_mov_b64 exec, s[40:41]
    v_cvt_pk_bf16_f32 v96, v144, v145
    v_cvt_pk_bf16_f32 v97, v146, v147
    v_cvt_pk_bf16_f32 v98, v148, v149
    v_cvt_pk_bf16_f32 v99, v150, v151
    v_cvt_pk_bf16_f32 v100, v152, v153
    v_cvt_pk_bf16_f32 v101, v154, v155
    s_mov_b64 exec, -1
    v_mfma_f32_16x16x32_bf16 v[144:147], v[160:163], v[108:111], 0
    v_mfma_f32_16x16x32_bf16 v[148:151], v[160:163], v[120:123], 0
    s_waitcnt lgkmcnt(3)
    v_mfma_f32_16x16x32_bf16 v[152:155], v[160:163], v[132:135], 0
    s_nop 5
    v_mov_b32_dpp v144, v148 quad_perm:[0,1,2,3] row_mask:2 bank_mask:0xf
    ds_read_b128 v[148:151], v4 offset:1024
    s_nop 0
    v_mov_b32_dpp v144, v152 quad_perm:[0,1,2,3] row_mask:4 bank_mask:0xf
    ds_read_b128 v[152:155], v4 offset:2048
    s_nop 0
    v_mov_b32_dpp v144, v156 quad_perm:[0,1,2,3] row_mask:8 bank_mask:0xf
    ds_read_b32 v156, v4 offset:3072
    s_waitcnt lgkmcnt(5)
    v_add_f32 v144, v144, v164
    v_exp_f32 v144, v144
    s_nop 0
    v_cvt_pk_bf16_f32 v144, v144, v144
    ds_write_b16 v7, v144 offset:0
    ds_read_b128 v[144:147], v4 offset:0
    s_waitcnt lgkmcnt(1)
    ds_read_b128 v[136:139], v5 offset:768
    v_mfma_f32_16x16x32_bf16 v[148:151], v[120:123], v[104:107], v[148:151]
    v_mfma_f32_16x16x32_bf16 v[152:155], v[132:135], v[104:107], v[152:155]
    v_mfma_f32_16x16x32_bf16 v[156:159], v[140:143], v[104:107], v[156:159]
    s_nop 5
    v_exp_f32 v148, v148
    v_exp_f32 v149, v149
    s_waitcnt lgkmcnt(1)
    v_mfma_f32_16x16x32_bf16 v[144:147], v[108:111], v[104:107], v[144:147]
    s_waitcnt lgkmcnt(0)
    ds_read_b128 v[112:115], v5 offset:832
    v_exp_f32 v150, v150
    v_mfma_f32_16x16x32_bf16 v[160:163], v[80:83], v[136:139], 0
    v_exp_f32 v151, v151
    v_mfma_f32_16x16x32_bf16 v[164:167], v[88:91], v[136:139], 0
    s_nop 1
    v_exp_f32 v144, v144
    v_exp_f32 v145, v145
    v_exp_f32 v146, v146
    v_exp_f32 v147, v147
    v_cvt_pk_bf16_f32 v136, v144, v145
    v_cvt_pk_bf16_f32 v137, v146, v147
    ds_read_b128 v[144:147], v4 offset:4096
    v_cvt_pk_bf16_f32 v138, v148, v149
    v_cvt_pk_bf16_f32 v139, v150, v151
    ds_read_b128 v[148:151], v4 offset:5120
    v_exp_f32 v152, v152
    v_exp_f32 v153, v153
    v_exp_f32 v154, v154
    v_exp_f32 v155, v155
    v_exp_f32 v156, v156
    v_cvt_pk_bf16_f32 v124, v152, v153
    v_cvt_pk_bf16_f32 v125, v154, v155
    s_waitcnt lgkmcnt(2)
    v_mfma_f32_16x16x32_bf16 v[160:163], v[84:87], v[112:115], v[160:163]
    ds_read_b128 v[152:155], v4 offset:6144
    v_cvt_pk_bf16_f32 v126, v156, 0
    v_mfma_f32_16x16x32_bf16 v[164:167], v[92:95], v[112:115], v[164:167]
    ds_read_b32 v156, v4 offset:7168
    s_nop 3
    ds_write_b128 v5, v[160:163] offset:1024
    v_mfma_f32_16x16x32_bf16 v[160:163], v[80:83], v[136:139], 0
    s_waitcnt lgkmcnt(0)
    ds_write_b128 v5, v[164:167] offset:1088
    v_mfma_f32_16x16x32_bf16 v[164:167], v[88:91], v[136:139], 0
    v_mfma_f32_16x16x32_bf16 v[144:147], v[108:111], v[116:119], v[144:147]
    v_mfma_f32_16x16x32_bf16 v[148:151], v[120:123], v[116:119], v[148:151]
    v_mfma_f32_16x16x32_bf16 v[164:167], v[92:95], v[124:127], v[164:167]
    s_nop 5
    v_exp_f32 v144, v144
    v_mfma_f32_16x16x32_bf16 v[160:163], v[84:87], v[124:127], v[160:163]
    v_exp_f32 v145, v145
    v_mfma_f32_16x16x32_bf16 v[152:155], v[132:135], v[116:119], v[152:155]
    v_exp_f32 v146, v146
    v_mfma_f32_16x16x32_bf16 v[156:159], v[140:143], v[116:119], v[156:159]
    v_exp_f32 v147, v147
    v_cvt_pk_bf16_f32 v136, v144, v145
    v_cvt_pk_bf16_f32 v137, v146, v147
    ds_read_b128 v[144:147], v4 offset:8192
    v_exp_f32 v148, v148
    v_exp_f32 v149, v149
    v_exp_f32 v150, v150
    v_exp_f32 v151, v151
    v_cvt_pk_bf16_f32 v138, v148, v149
    v_cvt_pk_bf16_f32 v139, v150, v151
    ds_read_b128 v[148:151], v4 offset:9216
    v_exp_f32 v152, v152
    v_exp_f32 v153, v153
    v_exp_f32 v154, v154
    v_exp_f32 v155, v155
    v_exp_f32 v156, v156
    v_cvt_pk_bf16_f32 v112, v152, v153
    v_cvt_pk_bf16_f32 v113, v154, v155
    ds_read_b128 v[152:155], v4 offset:10240
    v_cvt_pk_bf16_f32 v114, v156, 0
    ds_read_b32 v156, v4 offset:11264
    v_rcp_f32 v166, v166
    s_nop 0
    v_mul_f32 v164, v164, v166
    v_mul_f32 v165, v165, v166
    v_mul_f32 v160, v160, v166
    v_mul_f32 v161, v161, v166
    v_mul_f32 v162, v162, v166
    s_waitcnt lgkmcnt(3)
    v_mfma_f32_16x16x32_bf16 v[144:147], v[108:111], v[128:131], v[144:147]
    v_mul_f32 v163, v163, v166
    v_cvt_pk_bf16_f32 v46, v164, v165
    v_mfma_f32_16x16x32_bf16 v[164:167], v[88:91], v[136:139], 0
    v_cvt_pk_bf16_f32 v44, v160, v161
    v_cvt_pk_bf16_f32 v45, v162, v163
    v_mfma_f32_16x16x32_bf16 v[160:163], v[80:83], v[136:139], 0
    s_nop 1
    v_exp_f32 v144, v144
    s_waitcnt lgkmcnt(2)
    v_mfma_f32_16x16x32_bf16 v[148:151], v[120:123], v[128:131], v[148:151]
    v_exp_f32 v145, v145
    v_mfma_f32_16x16x32_bf16 v[164:167], v[92:95], v[112:115], v[164:167]
    v_exp_f32 v146, v146
    v_mfma_f32_16x16x32_bf16 v[160:163], v[84:87], v[112:115], v[160:163]
    v_exp_f32 v147, v147
    s_waitcnt lgkmcnt(1)
    v_mfma_f32_16x16x32_bf16 v[152:155], v[132:135], v[128:131], v[152:155]
    v_cvt_pk_bf16_f32 v136, v144, v145
    ds_read_b64_tr_b16 v[144:145], v3 offset:96
    s_waitcnt lgkmcnt(1)
    v_mfma_f32_16x16x32_bf16 v[156:159], v[140:143], v[128:131], v[156:159]
    ds_read_b128 v[140:143], v4 offset:51200
    v_cvt_pk_bf16_f32 v137, v146, v147
    ds_read_b64_tr_b16 v[146:147], v3 offset:9824
    v_exp_f32 v148, v148
    v_exp_f32 v149, v149
    v_exp_f32 v150, v150
    s_nop 1
    ds_read_b64_tr_b16 v[158:159], v3 offset:9856
    v_exp_f32 v151, v151
    v_rcp_f32 v166, v166
    v_cvt_pk_bf16_f32 v138, v148, v149
    ds_read_b64_tr_b16 v[148:149], v3 offset:19552
    v_cvt_pk_bf16_f32 v139, v150, v151
    ds_read_b64_tr_b16 v[150:151], v3 offset:29280
    v_mul_f32 v164, v164, v166
    v_mul_f32 v165, v165, v166
    v_exp_f32 v152, v152
    v_exp_f32 v153, v153
    v_exp_f32 v154, v154
    v_exp_f32 v155, v155
    v_exp_f32 v156, v156
    v_mul_f32 v160, v160, v166
    v_mul_f32 v161, v161, v166
    v_mul_f32 v162, v162, v166
    v_mul_f32 v163, v163, v166
    v_cvt_pk_bf16_f32 v58, v164, v165
    v_mfma_f32_16x16x32_bf16 v[164:167], v[88:91], v[136:139], 0
    v_cvt_pk_bf16_f32 v124, v152, v153
    ds_read_b64_tr_b16 v[152:153], v3 offset:39008
    s_waitcnt lgkmcnt(4)
    v_mfma_f32_16x16x32_bf16 v[104:107], v[144:147], v[8:11], 0
    v_cvt_pk_bf16_f32 v125, v154, v155
    ds_read_b64_tr_b16 v[154:155], v3 offset:48736
    v_mfma_f32_16x16x32_bf16 v[116:119], v[144:147], v[20:23], 0
    v_cvt_pk_bf16_f32 v126, v156, 0
    ds_read_b64_tr_b16 v[156:157], v3 offset:128
    v_mfma_f32_16x16x32_bf16 v[128:131], v[144:147], v[32:35], 0
    ds_read_b64_tr_b16 v[144:145], v3 offset:19584
    ds_read_b64_tr_b16 v[146:147], v3 offset:29312
    v_mfma_f32_16x16x32_bf16 v[164:167], v[92:95], v[124:127], v[164:167]
    ds_read_u16 v94, v6 offset:672
    v_cvt_pk_bf16_f32 v56, v160, v161
    s_waitcnt lgkmcnt(6)
    v_mfma_f32_16x16x32_bf16 v[104:107], v[148:151], v[12:15], v[104:107]
    v_cvt_pk_bf16_f32 v57, v162, v163
    v_mfma_f32_16x16x32_bf16 v[116:119], v[148:151], v[24:27], v[116:119]
    s_nop 1
    v_rcp_f32 v166, v166
    v_mfma_f32_16x16x32_bf16 v[128:131], v[148:151], v[36:39], v[128:131]
    ds_read_b64_tr_b16 v[148:149], v3 offset:39040
    ds_read_b64_tr_b16 v[150:151], v3 offset:48768
    v_mfma_f32_16x16x32_bf16 v[160:163], v[80:83], v[136:139], 0
    v_mul_f32 v164, v164, v166
    v_mul_f32 v165, v165, v166
    v_mfma_f32_16x16x32_bf16 v[160:163], v[84:87], v[124:127], v[160:163]
    ds_read_u16 v86, v6 offset:608
    v_cvt_pk_bf16_f32 v70, v164, v165
    s_nop 1
    s_setprio 2
    s_waitcnt lgkmcnt(7)
    v_mfma_f32_16x16x32_bf16 v[104:107], v[152:155], v[16:19], v[104:107]
    buffer_load_dwordx4 v[52:55], v4, s[28:31], 0 offen offset:0
    buffer_load_dwordx4 v[64:67], v4, s[28:31], 0 offen offset:1024
    v_mfma_f32_16x16x32_bf16 v[116:119], v[152:155], v[28:31], v[116:119]
    buffer_load_dwordx4 v[76:79], v4, s[28:31], 0 offen offset:2048
    v_mul_f32 v160, v160, v166
    v_mfma_f32_16x16x32_bf16 v[128:131], v[152:155], v[40:43], v[128:131]
    ds_read_b64_tr_b16 v[152:153], v3 offset:160
    ds_read_b64_tr_b16 v[154:155], v3 offset:9888
    s_waitcnt lgkmcnt(8)
    v_mfma_f32_16x16x32_bf16 v[108:111], v[156:159], v[8:11], 0
    v_mul_f32 v161, v161, v166
    v_mul_f32 v162, v162, v166
    v_mfma_f32_16x16x32_bf16 v[120:123], v[156:159], v[20:23], 0
    v_mul_f32 v163, v163, v166
    ds_read_b64_tr_b16 v[166:167], v3 offset:29632
    v_mfma_f32_16x16x32_bf16 v[132:135], v[156:159], v[32:35], 0
    ds_read_b64_tr_b16 v[156:157], v3 offset:19616
    ds_read_b64_tr_b16 v[158:159], v3 offset:29344
    s_waitcnt lgkmcnt(9)
    v_mfma_f32_16x16x32_bf16 v[108:111], v[144:147], v[12:15], v[108:111]
    v_cvt_pk_bf16_f32 v68, v160, v161
    v_cvt_pk_bf16_f32 v69, v162, v163
    v_mfma_f32_16x16x32_bf16 v[120:123], v[144:147], v[24:27], v[120:123]
    v_fma_f32 v160, v104, v104, s36
    v_fma_f32 v162, v116, v116, s36
    v_mfma_f32_16x16x32_bf16 v[132:135], v[144:147], v[36:39], v[132:135]
    ds_read_b64_tr_b16 v[144:145], v3 offset:39072
    ds_read_b64_tr_b16 v[146:147], v3 offset:48800
    s_waitcnt lgkmcnt(8)
    v_mfma_f32_16x16x32_bf16 v[108:111], v[148:151], v[16:19], v[108:111]
    v_fmac_f32 v160, v105, v105
    v_fmac_f32 v162, v117, v117
    v_mfma_f32_16x16x32_bf16 v[120:123], v[148:151], v[28:31], v[120:123]
    v_fmac_f32 v160, v106, v106
    v_fmac_f32 v162, v118, v118
    v_mfma_f32_16x16x32_bf16 v[132:135], v[148:151], v[40:43], v[132:135]
    v_fmac_f32 v160, v107, v107
    s_nop 0
    v_fma_f32 v161, v110, v110, s36
    s_waitcnt lgkmcnt(5)
    v_mfma_f32_16x16x32_bf16 v[112:115], v[152:155], v[8:11], 0
    v_fmac_f32 v161, v111, v111
    v_fma_f32 v163, v122, v122, s36
    v_mfma_f32_16x16x32_bf16 v[124:127], v[152:155], v[20:23], 0
    v_fmac_f32 v163, v123, v123
    v_fmac_f32 v162, v119, v119
    v_mfma_f32_16x16x32_bf16 v[136:139], v[152:155], v[32:35], 0
    v_fmac_f32 v160, v108, v108
    v_fmac_f32 v162, v120, v120
    s_waitcnt lgkmcnt(2)
    v_mfma_f32_16x16x32_bf16 v[112:115], v[156:159], v[12:15], v[112:115]
    v_fmac_f32 v160, v109, v109
    v_fmac_f32 v162, v121, v121
    v_mfma_f32_16x16x32_bf16 v[124:127], v[156:159], v[24:27], v[124:127]
    v_fma_f32 v164, v128, v128, s36
    v_fma_f32 v165, v134, v134, s36
    v_mfma_f32_16x16x32_bf16 v[136:139], v[156:159], v[36:39], v[136:139]
    ds_read_b128 v[156:159], v4 offset:50176
    v_fmac_f32 v164, v129, v129
    s_waitcnt lgkmcnt(1)
    v_mfma_f32_16x16x32_bf16 v[112:115], v[144:147], v[16:19], v[112:115]
    v_fmac_f32 v165, v135, v135
    v_fmac_f32 v164, v130, v130
    v_mfma_f32_16x16x32_bf16 v[124:127], v[144:147], v[28:31], v[124:127]
    v_fmac_f32 v164, v131, v131
    v_fmac_f32 v164, v132, v132
    v_mfma_f32_16x16x32_bf16 v[136:139], v[144:147], v[40:43], v[136:139]
    ds_read_b32 v147, v5 offset:896
    s_nop 0
    v_fmac_f32 v161, v112, v112
    v_fmac_f32 v161, v113, v113
    v_fmac_f32 v161, v114, v114
    v_fmac_f32 v161, v115, v115
    v_fmac_f32 v163, v124, v124
    v_fmac_f32 v163, v125, v125
    v_fmac_f32 v163, v126, v126
    v_fmac_f32 v163, v127, v127
    v_cvt_pk_bf16_f32 v144, v160, v161
    ds_read_b64_tr_b16 v[160:161], v3 offset:448
    v_cvt_pk_bf16_f32 v145, v162, v163
    ds_read_b64_tr_b16 v[162:163], v3 offset:10176
    v_fmac_f32 v165, v136, v136
    v_fmac_f32 v165, v137, v137
    v_fmac_f32 v165, v138, v138
    v_fmac_f32 v164, v133, v133
    v_fmac_f32 v165, v139, v139
    v_cvt_pk_bf16_f32 v146, v164, v165
    ds_read_b64_tr_b16 v[164:165], v3 offset:19904
    s_waitcnt lgkmcnt(3)
    v_mfma_f32_16x16x32_bf16 v[148:151], v[156:159], v[144:147], 0
    ds_read_b64_tr_b16 v[156:157], v3 offset:39360
    ds_read_b64_tr_b16 v[158:159], v3 offset:49088
    v_mfma_f32_16x16x32_bf16 v[152:155], v[140:143], v[144:147], 0
    ds_read_b128 v[140:143], v5 offset:128
    s_nop 3
    v_rsq_f32 v148, v148
    s_waitcnt lgkmcnt(4)
    v_mfma_f32_16x16x32_bf16 v[144:147], v[8:11], v[160:163], 0
    v_rsq_f32 v150, v150
    v_rsq_f32 v152, v152
    s_waitcnt lgkmcnt(3)
    v_mfma_f32_16x16x32_bf16 v[144:147], v[12:15], v[164:167], v[144:147]
    v_mul_f32 v148, s33, v148
    v_rsq_f32 v149, v149
    v_mul_f32 v150, s33, v150
    v_rsq_f32 v151, v151
    v_rsq_f32 v153, v153
    v_mul_f32 v104, v104, v148
    v_mul_f32 v105, v105, v148
    v_mul_f32 v116, v116, v150
    v_mul_f32 v117, v117, v150
    v_mul_f32 v152, s33, v152
    v_mul_f32 v106, v106, v148
    v_mul_f32 v107, v107, v148
    v_cvt_pk_bf16_f32 v104, v104, v105
    v_mul_f32 v118, v118, v150
    s_waitcnt lgkmcnt(1)
    v_mfma_f32_16x16x32_bf16 v[144:147], v[16:19], v[156:159], v[144:147]
    v_mul_f32 v119, v119, v150
    v_cvt_pk_bf16_f32 v116, v116, v117
    v_mul_f32 v108, v108, v148
    v_mul_f32 v109, v109, v148
    v_mul_f32 v110, v110, v149
    v_mul_f32 v111, v111, v149
    v_mul_f32 v112, v112, v149
    v_mul_f32 v113, v113, v149
    v_mul_f32 v114, v114, v149
    v_mul_f32 v115, v115, v149
    v_cvt_pk_bf16_f32 v105, v106, v107
    ds_read_b32 v107, v5 offset:896
    v_mul_f32 v120, v120, v150
    v_mul_f32 v121, v121, v150
    v_mul_f32 v122, v122, v151
    v_mul_f32 v123, v123, v151
    v_mul_f32 v124, v124, v151
    v_mul_f32 v125, v125, v151
    v_mul_f32 v126, v126, v151
    v_mul_f32 v127, v127, v151
    v_mfma_f32_16x16x32_bf16 v[148:151], v[20:23], v[160:163], 0
    v_cvt_pk_bf16_f32 v117, v118, v119
    ds_read_b32 v119, v5 offset:896
    v_mfma_f32_16x16x32_bf16 v[148:151], v[24:27], v[164:167], v[148:151]
    v_mul_f32 v128, v128, v152
    v_mul_f32 v129, v129, v152
    v_mfma_f32_16x16x32_bf16 v[148:151], v[28:31], v[156:159], v[148:151]
    v_mul_f32 v130, v130, v152
    v_mul_f32 v131, v131, v152
    v_mul_f32 v132, v132, v152
    v_mul_f32 v133, v133, v152
    v_mul_f32 v134, v134, v153
    v_mul_f32 v135, v135, v153
    v_mul_f32 v136, v136, v153
    v_mul_f32 v137, v137, v153
    v_mul_f32 v138, v138, v153
    v_mul_f32 v139, v139, v153
    v_mfma_f32_16x16x32_bf16 v[152:155], v[32:35], v[160:163], 0
    ds_read_b128 v[160:163], v5 offset:192
    v_cvt_pk_bf16_f32 v106, v108, v109
    v_mfma_f32_16x16x32_bf16 v[152:155], v[36:39], v[164:167], v[152:155]
    ds_read_b32 v164, v4 offset:49156
    v_cvt_pk_bf16_f32 v118, v120, v121
    v_mfma_f32_16x16x32_bf16 v[152:155], v[40:43], v[156:159], v[152:155]
    v_cvt_pk_bf16_f32 v108, v110, v111
    ds_read_b32 v111, v5 offset:896
    v_cvt_pk_bf16_f32 v120, v122, v123
    ds_read_b32 v123, v5 offset:896
    v_cvt_pk_bf16_f32 v128, v128, v129
    v_cvt_pk_bf16_f32 v129, v130, v131
    ds_read_b32 v131, v5 offset:896
    v_cvt_pk_bf16_f32 v130, v132, v133
    v_cvt_pk_bf16_f32 v132, v134, v135
    ds_read_b32 v135, v5 offset:896
    v_cvt_pk_bf16_f32 v109, v112, v113
    v_cvt_pk_bf16_f32 v110, v114, v115
    ds_read_b32 v115, v5 offset:896
    v_cvt_pk_bf16_f32 v121, v124, v125
    v_cvt_pk_bf16_f32 v122, v126, v127
    ds_read_b32 v127, v5 offset:896
    v_cvt_pk_bf16_f32 v80, v144, v145
    v_cvt_pk_bf16_f32 v81, v146, v147
    v_cvt_pk_bf16_f32 v82, v148, v149
    v_cvt_pk_bf16_f32 v83, v150, v151
    v_cvt_pk_bf16_f32 v133, v136, v137
    v_cvt_pk_bf16_f32 v134, v138, v139
    v_cvt_pk_bf16_f32 v84, v152, v153
    v_cvt_pk_bf16_f32 v85, v154, v155
    s_waitcnt lgkmcnt(7)
    v_mfma_f32_16x16x32_bf16 v[156:159], v[160:163], v[140:143], 0
    s_waitcnt lgkmcnt(5)
    v_mfma_f32_16x16x32_bf16 v[144:147], v[160:163], v[108:111], 0
    s_waitcnt lgkmcnt(4)
    v_mfma_f32_16x16x32_bf16 v[148:151], v[160:163], v[120:123], 0
    s_waitcnt lgkmcnt(2)
    v_mfma_f32_16x16x32_bf16 v[152:155], v[160:163], v[132:135], 0
    s_nop 5
    v_mov_b32_dpp v144, v148 quad_perm:[0,1,2,3] row_mask:2 bank_mask:0xf
    ds_read_b128 v[148:151], v4 offset:13312
    s_nop 0
    v_mov_b32_dpp v144, v152 quad_perm:[0,1,2,3] row_mask:4 bank_mask:0xf
    ds_read_b128 v[152:155], v4 offset:14336
    s_nop 0
    v_mov_b32_dpp v144, v156 quad_perm:[0,1,2,3] row_mask:8 bank_mask:0xf
    ds_read_b32 v156, v4 offset:15360
    v_add_f32 v144, v144, v164
    v_exp_f32 v144, v144
    s_nop 0
    v_cvt_pk_bf16_f32 v144, v144, v144
    ds_write_b16 v7, v144 offset:0
    ds_read_b128 v[144:147], v4 offset:12288
    s_waitcnt lgkmcnt(1)
    ds_read_b128 v[136:139], v5 offset:768
    v_mfma_f32_16x16x32_bf16 v[148:151], v[120:123], v[104:107], v[148:151]
    v_mfma_f32_16x16x32_bf16 v[152:155], v[132:135], v[104:107], v[152:155]
    v_mfma_f32_16x16x32_bf16 v[156:159], v[140:143], v[104:107], v[156:159]
    s_nop 5
    v_exp_f32 v148, v148
    v_exp_f32 v149, v149
    s_waitcnt lgkmcnt(1)
    v_mfma_f32_16x16x32_bf16 v[144:147], v[108:111], v[104:107], v[144:147]
    s_waitcnt lgkmcnt(0)
    ds_read_b128 v[112:115], v5 offset:832
    v_exp_f32 v150, v150
    v_mfma_f32_16x16x32_bf16 v[160:163], v[80:83], v[136:139], 0
    v_exp_f32 v151, v151
    v_mfma_f32_16x16x32_bf16 v[164:167], v[96:99], v[136:139], 0
    s_nop 1
    v_exp_f32 v144, v144
    v_exp_f32 v145, v145
    v_exp_f32 v146, v146
    v_exp_f32 v147, v147
    v_cvt_pk_bf16_f32 v136, v144, v145
    v_cvt_pk_bf16_f32 v137, v146, v147
    ds_read_b128 v[144:147], v4 offset:16384
    v_cvt_pk_bf16_f32 v138, v148, v149
    v_cvt_pk_bf16_f32 v139, v150, v151
    ds_read_b128 v[148:151], v4 offset:17408
    v_exp_f32 v152, v152
    v_exp_f32 v153, v153
    v_exp_f32 v154, v154
    v_exp_f32 v155, v155
    v_exp_f32 v156, v156
    v_cvt_pk_bf16_f32 v124, v152, v153
    v_cvt_pk_bf16_f32 v125, v154, v155
    s_waitcnt lgkmcnt(2)
    v_mfma_f32_16x16x32_bf16 v[160:163], v[84:87], v[112:115], v[160:163]
    ds_read_b128 v[152:155], v4 offset:18432
    v_cvt_pk_bf16_f32 v126, v156, 0
    v_mfma_f32_16x16x32_bf16 v[164:167], v[100:103], v[112:115], v[164:167]
    ds_read_b32 v156, v4 offset:19456
    s_nop 3
    ds_write_b128 v5, v[160:163] offset:1152
    v_mfma_f32_16x16x32_bf16 v[160:163], v[80:83], v[136:139], 0
    s_waitcnt lgkmcnt(0)
    ds_write_b128 v5, v[164:167] offset:1216
    v_mfma_f32_16x16x32_bf16 v[164:167], v[96:99], v[136:139], 0
    v_mfma_f32_16x16x32_bf16 v[144:147], v[108:111], v[116:119], v[144:147]
    v_mfma_f32_16x16x32_bf16 v[148:151], v[120:123], v[116:119], v[148:151]
    v_mfma_f32_16x16x32_bf16 v[164:167], v[100:103], v[124:127], v[164:167]
    s_nop 5
    v_exp_f32 v144, v144
    v_mfma_f32_16x16x32_bf16 v[160:163], v[84:87], v[124:127], v[160:163]
    v_exp_f32 v145, v145
    v_mfma_f32_16x16x32_bf16 v[152:155], v[132:135], v[116:119], v[152:155]
    v_exp_f32 v146, v146
    v_mfma_f32_16x16x32_bf16 v[156:159], v[140:143], v[116:119], v[156:159]
    v_exp_f32 v147, v147
    v_cvt_pk_bf16_f32 v136, v144, v145
    v_cvt_pk_bf16_f32 v137, v146, v147
    ds_read_b128 v[144:147], v4 offset:20480
    v_exp_f32 v148, v148
    v_exp_f32 v149, v149
    v_exp_f32 v150, v150
    v_exp_f32 v151, v151
    v_cvt_pk_bf16_f32 v138, v148, v149
    v_cvt_pk_bf16_f32 v139, v150, v151
    ds_read_b128 v[148:151], v4 offset:21504
    v_exp_f32 v152, v152
    v_exp_f32 v153, v153
    v_exp_f32 v154, v154
    v_exp_f32 v155, v155
    v_exp_f32 v156, v156
    v_cvt_pk_bf16_f32 v112, v152, v153
    v_cvt_pk_bf16_f32 v113, v154, v155
    ds_read_b128 v[152:155], v4 offset:22528
    v_cvt_pk_bf16_f32 v114, v156, 0
    ds_read_b32 v156, v4 offset:23552
    v_rcp_f32 v164, v164
    s_nop 0
    v_mul_f32 v166, v166, v164
    v_mul_f32 v167, v167, v164
    v_mul_f32 v160, v160, v164
    v_mul_f32 v161, v161, v164
    v_mul_f32 v162, v162, v164
    s_waitcnt lgkmcnt(3)
    v_mfma_f32_16x16x32_bf16 v[144:147], v[108:111], v[128:131], v[144:147]
    v_mul_f32 v163, v163, v164
    v_cvt_pk_bf16_f32 v49, v166, v167
    v_mfma_f32_16x16x32_bf16 v[164:167], v[96:99], v[136:139], 0
    v_cvt_pk_bf16_f32 v47, v160, v161
    v_cvt_pk_bf16_f32 v48, v162, v163
    v_mfma_f32_16x16x32_bf16 v[160:163], v[80:83], v[136:139], 0
    s_nop 1
    v_exp_f32 v144, v144
    s_waitcnt lgkmcnt(2)
    v_mfma_f32_16x16x32_bf16 v[148:151], v[120:123], v[128:131], v[148:151]
    v_exp_f32 v145, v145
    v_mfma_f32_16x16x32_bf16 v[164:167], v[100:103], v[112:115], v[164:167]
    v_exp_f32 v146, v146
    v_mfma_f32_16x16x32_bf16 v[160:163], v[84:87], v[112:115], v[160:163]
    v_exp_f32 v147, v147
    s_waitcnt lgkmcnt(1)
    v_mfma_f32_16x16x32_bf16 v[152:155], v[132:135], v[128:131], v[152:155]
    v_cvt_pk_bf16_f32 v136, v144, v145
    ds_read_b64_tr_b16 v[144:145], v3 offset:192
    s_waitcnt lgkmcnt(1)
    v_mfma_f32_16x16x32_bf16 v[156:159], v[140:143], v[128:131], v[156:159]
    ds_read_b128 v[140:143], v4 offset:51200
    v_cvt_pk_bf16_f32 v137, v146, v147
    ds_read_b64_tr_b16 v[146:147], v3 offset:9920
    v_exp_f32 v148, v148
    v_exp_f32 v149, v149
    v_exp_f32 v150, v150
    s_nop 1
    ds_read_b64_tr_b16 v[158:159], v3 offset:9952
    v_exp_f32 v151, v151
    v_rcp_f32 v164, v164
    v_cvt_pk_bf16_f32 v138, v148, v149
    ds_read_b64_tr_b16 v[148:149], v3 offset:19648
    v_cvt_pk_bf16_f32 v139, v150, v151
    ds_read_b64_tr_b16 v[150:151], v3 offset:29376
    v_mul_f32 v166, v166, v164
    v_mul_f32 v167, v167, v164
    v_exp_f32 v152, v152
    v_exp_f32 v153, v153
    v_exp_f32 v154, v154
    v_exp_f32 v155, v155
    v_exp_f32 v156, v156
    v_mul_f32 v160, v160, v164
    v_mul_f32 v161, v161, v164
    v_mul_f32 v162, v162, v164
    v_mul_f32 v163, v163, v164
    v_cvt_pk_bf16_f32 v61, v166, v167
    v_mfma_f32_16x16x32_bf16 v[164:167], v[96:99], v[136:139], 0
    v_cvt_pk_bf16_f32 v124, v152, v153
    ds_read_b64_tr_b16 v[152:153], v3 offset:39104
    s_waitcnt lgkmcnt(4)
    v_mfma_f32_16x16x32_bf16 v[104:107], v[144:147], v[8:11], 0
    v_cvt_pk_bf16_f32 v125, v154, v155
    ds_read_b64_tr_b16 v[154:155], v3 offset:48832
    v_mfma_f32_16x16x32_bf16 v[116:119], v[144:147], v[20:23], 0
    v_cvt_pk_bf16_f32 v126, v156, 0
    ds_read_b64_tr_b16 v[156:157], v3 offset:224
    v_mfma_f32_16x16x32_bf16 v[128:131], v[144:147], v[32:35], 0
    ds_read_b64_tr_b16 v[144:145], v3 offset:19680
    ds_read_b64_tr_b16 v[146:147], v3 offset:29408
    v_mfma_f32_16x16x32_bf16 v[164:167], v[100:103], v[124:127], v[164:167]
    ds_read_u16 v102, v6 offset:704
    v_cvt_pk_bf16_f32 v59, v160, v161
    s_waitcnt lgkmcnt(6)
    v_mfma_f32_16x16x32_bf16 v[104:107], v[148:151], v[12:15], v[104:107]
    v_cvt_pk_bf16_f32 v60, v162, v163
    v_mfma_f32_16x16x32_bf16 v[116:119], v[148:151], v[24:27], v[116:119]
    s_nop 1
    v_rcp_f32 v164, v164
    v_mfma_f32_16x16x32_bf16 v[128:131], v[148:151], v[36:39], v[128:131]
    ds_read_b64_tr_b16 v[148:149], v3 offset:39136
    ds_read_b64_tr_b16 v[150:151], v3 offset:48864
    v_mfma_f32_16x16x32_bf16 v[160:163], v[80:83], v[136:139], 0
    v_mul_f32 v166, v166, v164
    v_mul_f32 v167, v167, v164
    v_mfma_f32_16x16x32_bf16 v[160:163], v[84:87], v[124:127], v[160:163]
    ds_read_u16 v86, v6 offset:640
    v_cvt_pk_bf16_f32 v73, v166, v167
    ds_read_b64_tr_b16 v[166:167], v3 offset:29664
    s_waitcnt lgkmcnt(8)
    v_mfma_f32_16x16x32_bf16 v[104:107], v[152:155], v[16:19], v[104:107]
    s_setprio 1
    s_waitcnt vmcnt(2)
    v_or3_b32 v52, v52, v53, v54
    v_mfma_f32_16x16x32_bf16 v[116:119], v[152:155], v[28:31], v[116:119]
    v_bitop3_b32 v52, v52, v55, s56 bitop3:0xa8
    v_cmp_ne_u32 s[54:55], 0, v52
    v_mfma_f32_16x16x32_bf16 v[128:131], v[152:155], v[40:43], v[128:131]
    buffer_load_dwordx4 v[52:55], v4, s[28:31], 0 offen offset:3072
    ds_read_b64_tr_b16 v[152:153], v3 offset:256
    s_waitcnt lgkmcnt(8)
    v_mfma_f32_16x16x32_bf16 v[108:111], v[156:159], v[8:11], 0
    ds_read_b64_tr_b16 v[154:155], v3 offset:9984
    v_mul_f32 v160, v160, v164
    v_mfma_f32_16x16x32_bf16 v[120:123], v[156:159], v[20:23], 0
    v_mul_f32 v161, v161, v164
    v_mul_f32 v162, v162, v164
    v_mfma_f32_16x16x32_bf16 v[132:135], v[156:159], v[32:35], 0
    ds_read_b64_tr_b16 v[156:157], v3 offset:19712
    ds_read_b64_tr_b16 v[158:159], v3 offset:29440
    s_waitcnt lgkmcnt(9)
    v_mfma_f32_16x16x32_bf16 v[108:111], v[144:147], v[12:15], v[108:111]
    v_mul_f32 v163, v163, v164
    v_cvt_pk_bf16_f32 v71, v160, v161
    v_mfma_f32_16x16x32_bf16 v[120:123], v[144:147], v[24:27], v[120:123]
    v_cvt_pk_bf16_f32 v72, v162, v163
    v_fma_f32 v160, v104, v104, s36
    v_mfma_f32_16x16x32_bf16 v[132:135], v[144:147], v[36:39], v[132:135]
    ds_read_b64_tr_b16 v[144:145], v3 offset:39168
    ds_read_b64_tr_b16 v[146:147], v3 offset:48896
    s_waitcnt lgkmcnt(8)
    v_mfma_f32_16x16x32_bf16 v[108:111], v[148:151], v[16:19], v[108:111]
    v_fma_f32 v162, v116, v116, s36
    v_fmac_f32 v160, v105, v105
    v_mfma_f32_16x16x32_bf16 v[120:123], v[148:151], v[28:31], v[120:123]
    v_fmac_f32 v162, v117, v117
    v_fmac_f32 v160, v106, v106
    v_mfma_f32_16x16x32_bf16 v[132:135], v[148:151], v[40:43], v[132:135]
    v_fmac_f32 v162, v118, v118
    s_nop 0
    v_fma_f32 v161, v110, v110, s36
    v_fmac_f32 v161, v111, v111
    s_waitcnt lgkmcnt(4)
    v_mfma_f32_16x16x32_bf16 v[112:115], v[152:155], v[8:11], 0
    v_fma_f32 v163, v122, v122, s36
    v_fmac_f32 v163, v123, v123
    v_mfma_f32_16x16x32_bf16 v[124:127], v[152:155], v[20:23], 0
    s_waitcnt vmcnt(2)
    v_or3_b32 v64, v64, v65, v66
    v_fmac_f32 v160, v107, v107
    v_mfma_f32_16x16x32_bf16 v[136:139], v[152:155], v[32:35], 0
    v_fmac_f32 v162, v119, v119
    s_or_b64 s[52:53], s[52:53], s[54:55]
    s_waitcnt lgkmcnt(2)
    v_mfma_f32_16x16x32_bf16 v[112:115], v[156:159], v[12:15], v[112:115]
    v_bitop3_b32 v64, v64, v67, s56 bitop3:0xa8
    v_fmac_f32 v160, v108, v108
    v_mfma_f32_16x16x32_bf16 v[124:127], v[156:159], v[24:27], v[124:127]
    v_fmac_f32 v162, v120, v120
    v_cmp_ne_u32 s[54:55], 0, v64
    v_mfma_f32_16x16x32_bf16 v[136:139], v[156:159], v[36:39], v[136:139]
    ds_read_b128 v[156:159], v4 offset:50176
    buffer_load_dwordx4 v[64:67], v4, s[28:31], s57 offen
    s_waitcnt lgkmcnt(1)
    v_mfma_f32_16x16x32_bf16 v[112:115], v[144:147], v[16:19], v[112:115]
    v_fmac_f32 v160, v109, v109
    v_fmac_f32 v162, v121, v121
    v_mfma_f32_16x16x32_bf16 v[124:127], v[144:147], v[28:31], v[124:127]
    v_fma_f32 v164, v128, v128, s36
    v_fma_f32 v165, v134, v134, s36
    v_mfma_f32_16x16x32_bf16 v[136:139], v[144:147], v[40:43], v[136:139]
    ds_read_b32 v147, v5 offset:896
    s_nop 0
    v_fmac_f32 v161, v112, v112
    v_fmac_f32 v161, v113, v113
    v_fmac_f32 v161, v114, v114
    v_fmac_f32 v161, v115, v115
    v_fmac_f32 v163, v124, v124
    v_fmac_f32 v163, v125, v125
    v_fmac_f32 v163, v126, v126
    v_fmac_f32 v163, v127, v127
    v_cvt_pk_bf16_f32 v144, v160, v161
    ds_read_b64_tr_b16 v[160:161], v3 offset:480
    v_cvt_pk_bf16_f32 v145, v162, v163
    ds_read_b64_tr_b16 v[162:163], v3 offset:10208
    v_fmac_f32 v164, v129, v129
    v_fmac_f32 v165, v135, v135
    v_fmac_f32 v164, v130, v130
    v_fmac_f32 v165, v136, v136
    v_fmac_f32 v164, v131, v131
    v_fmac_f32 v165, v137, v137
    v_fmac_f32 v164, v132, v132
    v_fmac_f32 v165, v138, v138
    v_fmac_f32 v164, v133, v133
    v_fmac_f32 v165, v139, v139
    v_cvt_pk_bf16_f32 v146, v164, v165
    ds_read_b64_tr_b16 v[164:165], v3 offset:19936
    s_waitcnt vmcnt(2)
    v_or3_b32 v76, v76, v77, v78
    s_or_b64 s[52:53], s[52:53], s[54:55]
    v_bitop3_b32 v76, v76, v79, s56 bitop3:0xa8
    v_cmp_ne_u32 s[54:55], 0, v76
    s_nop 1
    s_or_b64 s[52:53], s[52:53], s[54:55]
    s_waitcnt lgkmcnt(3)
    v_mfma_f32_16x16x32_bf16 v[148:151], v[156:159], v[144:147], 0
    ds_read_b64_tr_b16 v[156:157], v3 offset:39392
    ds_read_b64_tr_b16 v[158:159], v3 offset:49120
    v_mfma_f32_16x16x32_bf16 v[152:155], v[140:143], v[144:147], 0
    ds_read_b128 v[140:143], v5 offset:256
    s_nop 3
    v_rsq_f32 v148, v148
    s_waitcnt lgkmcnt(4)
    v_mfma_f32_16x16x32_bf16 v[144:147], v[8:11], v[160:163], 0
    v_rsq_f32 v150, v150
    v_rsq_f32 v152, v152
    v_rsq_f32 v149, v149
    v_rsq_f32 v151, v151
    v_rsq_f32 v153, v153
    s_waitcnt lgkmcnt(3)
    v_mfma_f32_16x16x32_bf16 v[144:147], v[12:15], v[164:167], v[144:147]
    v_mul_f32 v148, s34, v148
    v_mul_f32 v150, s34, v150
    v_mul_f32 v152, s34, v152
    v_mul_f32 v104, v104, v148
    v_mul_f32 v105, v105, v148
    v_mul_f32 v106, v106, v148
    v_mul_f32 v107, v107, v148
    v_mul_f32 v108, v108, v148
    v_mul_f32 v109, v109, v148
    v_mul_f32 v110, v110, v149
    v_mul_f32 v111, v111, v149
    s_waitcnt lgkmcnt(1)
    v_mfma_f32_16x16x32_bf16 v[144:147], v[16:19], v[156:159], v[144:147]
    v_mul_f32 v112, v112, v149
    v_mul_f32 v113, v113, v149
    v_mul_f32 v114, v114, v149
    v_mul_f32 v115, v115, v149
    v_mul_f32 v116, v116, v150
    v_mul_f32 v117, v117, v150
    v_mul_f32 v118, v118, v150
    v_mul_f32 v119, v119, v150
    v_mul_f32 v120, v120, v150
    v_mul_f32 v121, v121, v150
    v_mul_f32 v122, v122, v151
    v_mul_f32 v123, v123, v151
    v_mul_f32 v124, v124, v151
    v_mul_f32 v125, v125, v151
    v_mul_f32 v126, v126, v151
    v_mul_f32 v127, v127, v151
    v_mfma_f32_16x16x32_bf16 v[148:151], v[20:23], v[160:163], 0
    v_mul_f32 v128, v128, v152
    v_mul_f32 v129, v129, v152
    v_mfma_f32_16x16x32_bf16 v[148:151], v[24:27], v[164:167], v[148:151]
    v_mul_f32 v130, v130, v152
    v_mul_f32 v131, v131, v152
    v_mfma_f32_16x16x32_bf16 v[148:151], v[28:31], v[156:159], v[148:151]
    v_mul_f32 v132, v132, v152
    v_mul_f32 v133, v133, v152
    v_mul_f32 v134, v134, v153
    v_mul_f32 v135, v135, v153
    v_mul_f32 v136, v136, v153
    v_mul_f32 v137, v137, v153
    v_mul_f32 v138, v138, v153
    v_mul_f32 v139, v139, v153
    v_mfma_f32_16x16x32_bf16 v[152:155], v[32:35], v[160:163], 0
    ds_read_b64_tr_b16 v[160:161], v3 offset:512
    ds_read_b64_tr_b16 v[162:163], v3 offset:10240
    v_mfma_f32_16x16x32_bf16 v[152:155], v[36:39], v[164:167], v[152:155]
    ds_read_b64_tr_b16 v[164:165], v3 offset:19968
    ds_read_b64_tr_b16 v[166:167], v3 offset:29696
    v_mfma_f32_16x16x32_bf16 v[152:155], v[40:43], v[156:159], v[152:155]
    ds_read_b64_tr_b16 v[156:157], v3 offset:39424
    ds_read_b64_tr_b16 v[158:159], v3 offset:49152
    v_cvt_pk_bf16_f32 v104, v104, v105
    v_cvt_pk_bf16_f32 v116, v116, v117
    v_cvt_pk_bf16_f32 v105, v106, v107
    ds_read_b32 v107, v5 offset:896
    v_cvt_pk_bf16_f32 v117, v118, v119
    ds_read_b32 v119, v5 offset:896
    v_cvt_pk_bf16_f32 v80, v144, v145
    v_cvt_pk_bf16_f32 v81, v146, v147
    v_cvt_pk_bf16_f32 v82, v148, v149
    v_cvt_pk_bf16_f32 v83, v150, v151
    v_cvt_pk_bf16_f32 v84, v152, v153
    v_cvt_pk_bf16_f32 v85, v154, v155
    v_cvt_pk_bf16_f32 v106, v108, v109
    v_cvt_pk_bf16_f32 v118, v120, v121
    v_cvt_pk_bf16_f32 v108, v110, v111
    ds_read_b32 v111, v5 offset:896
    v_cvt_pk_bf16_f32 v120, v122, v123
    ds_read_b32 v123, v5 offset:896
    v_cvt_pk_bf16_f32 v128, v128, v129
    v_cvt_pk_bf16_f32 v129, v130, v131
    ds_read_b32 v131, v5 offset:896
    v_cvt_pk_bf16_f32 v130, v132, v133
    v_cvt_pk_bf16_f32 v132, v134, v135
    ds_read_b32 v135, v5 offset:896
    v_cvt_pk_bf16_f32 v109, v112, v113
    v_cvt_pk_bf16_f32 v110, v114, v115
    s_waitcnt lgkmcnt(10)
    v_mfma_f32_16x16x32_bf16 v[144:147], v[8:11], v[160:163], 0
    ds_read_b32 v115, v5 offset:896
    v_cvt_pk_bf16_f32 v121, v124, v125
    v_mfma_f32_16x16x32_bf16 v[148:151], v[20:23], v[160:163], 0
    v_cvt_pk_bf16_f32 v122, v126, v127
    ds_read_b32 v127, v5 offset:896
    v_mfma_f32_16x16x32_bf16 v[152:155], v[32:35], v[160:163], 0
    ds_read_b128 v[160:163], v5 offset:320
    v_cvt_pk_bf16_f32 v133, v136, v137
    s_waitcnt lgkmcnt(11)
    v_mfma_f32_16x16x32_bf16 v[144:147], v[12:15], v[164:167], v[144:147]
    v_cvt_pk_bf16_f32 v134, v138, v139
    v_mfma_f32_16x16x32_bf16 v[148:151], v[24:27], v[164:167], v[148:151]
    v_mfma_f32_16x16x32_bf16 v[152:155], v[36:39], v[164:167], v[152:155]
    ds_read_b32 v164, v4 offset:49160
    s_waitcnt lgkmcnt(10)
    v_mfma_f32_16x16x32_bf16 v[144:147], v[16:19], v[156:159], v[144:147]
    v_mfma_f32_16x16x32_bf16 v[148:151], v[28:31], v[156:159], v[148:151]
    v_mfma_f32_16x16x32_bf16 v[152:155], v[40:43], v[156:159], v[152:155]
    s_mov_b64 exec, s[38:39]
    s_nop 4
    v_cvt_pk_bf16_f32 v88, v144, v145
    v_cvt_pk_bf16_f32 v89, v146, v147
    v_cvt_pk_bf16_f32 v90, v148, v149
    v_cvt_pk_bf16_f32 v91, v150, v151
    v_cvt_pk_bf16_f32 v92, v152, v153
    v_cvt_pk_bf16_f32 v93, v154, v155
    s_mov_b64 exec, -1
    s_waitcnt lgkmcnt(1)
    v_mfma_f32_16x16x32_bf16 v[156:159], v[160:163], v[140:143], 0
    s_mov_b64 exec, s[40:41]
    v_cvt_pk_bf16_f32 v96, v144, v145
    v_cvt_pk_bf16_f32 v97, v146, v147
    v_cvt_pk_bf16_f32 v98, v148, v149
    v_cvt_pk_bf16_f32 v99, v150, v151
    v_cvt_pk_bf16_f32 v100, v152, v153
    v_cvt_pk_bf16_f32 v101, v154, v155
    s_mov_b64 exec, -1
    v_mfma_f32_16x16x32_bf16 v[144:147], v[160:163], v[108:111], 0
    v_mfma_f32_16x16x32_bf16 v[148:151], v[160:163], v[120:123], 0
    v_mfma_f32_16x16x32_bf16 v[152:155], v[160:163], v[132:135], 0
    s_nop 6
    v_mov_b32_dpp v144, v148 quad_perm:[0,1,2,3] row_mask:2 bank_mask:0xf
    ds_read_b128 v[148:151], v4 offset:25600
    s_nop 0
    v_mov_b32_dpp v144, v152 quad_perm:[0,1,2,3] row_mask:4 bank_mask:0xf
    ds_read_b128 v[152:155], v4 offset:26624
    s_nop 0
    v_mov_b32_dpp v144, v156 quad_perm:[0,1,2,3] row_mask:8 bank_mask:0xf
    ds_read_b32 v156, v4 offset:27648
    s_waitcnt lgkmcnt(3)
    v_add_f32 v144, v144, v164
    v_exp_f32 v144, v144
    s_nop 0
    v_cvt_pk_bf16_f32 v144, v144, v144
    ds_write_b16 v7, v144 offset:0
    ds_read_b128 v[144:147], v4 offset:24576
    s_waitcnt lgkmcnt(1)
    ds_read_b128 v[136:139], v5 offset:768
    v_mfma_f32_16x16x32_bf16 v[148:151], v[120:123], v[104:107], v[148:151]
    v_mfma_f32_16x16x32_bf16 v[152:155], v[132:135], v[104:107], v[152:155]
    v_mfma_f32_16x16x32_bf16 v[156:159], v[140:143], v[104:107], v[156:159]
    s_nop 5
    v_exp_f32 v148, v148
    v_exp_f32 v149, v149
    s_waitcnt lgkmcnt(1)
    v_mfma_f32_16x16x32_bf16 v[144:147], v[108:111], v[104:107], v[144:147]
    s_waitcnt lgkmcnt(0)
    ds_read_b128 v[112:115], v5 offset:832
    v_exp_f32 v150, v150
    v_mfma_f32_16x16x32_bf16 v[160:163], v[80:83], v[136:139], 0
    v_exp_f32 v151, v151
    v_mfma_f32_16x16x32_bf16 v[164:167], v[88:91], v[136:139], 0
    s_nop 1
    v_exp_f32 v144, v144
    v_exp_f32 v145, v145
    v_exp_f32 v146, v146
    v_exp_f32 v147, v147
    v_cvt_pk_bf16_f32 v136, v144, v145
    v_cvt_pk_bf16_f32 v137, v146, v147
    ds_read_b128 v[144:147], v4 offset:28672
    v_cvt_pk_bf16_f32 v138, v148, v149
    v_cvt_pk_bf16_f32 v139, v150, v151
    ds_read_b128 v[148:151], v4 offset:29696
    v_exp_f32 v152, v152
    v_exp_f32 v153, v153
    v_exp_f32 v154, v154
    v_exp_f32 v155, v155
    v_cvt_pk_bf16_f32 v124, v152, v153
    v_cvt_pk_bf16_f32 v125, v154, v155
    ds_read_b128 v[152:155], v4 offset:30720
    v_exp_f32 v156, v156
    s_waitcnt lgkmcnt(3)
    v_mfma_f32_16x16x32_bf16 v[160:163], v[84:87], v[112:115], v[160:163]
    v_cvt_pk_bf16_f32 v126, v156, 0
    ds_read_b32 v156, v4 offset:31744
    v_mfma_f32_16x16x32_bf16 v[164:167], v[92:95], v[112:115], v[164:167]
    s_nop 4
    ds_write_b128 v5, v[160:163] offset:1280
    v_mfma_f32_16x16x32_bf16 v[160:163], v[80:83], v[136:139], 0
    s_waitcnt lgkmcnt(0)
    ds_write_b128 v5, v[164:167] offset:1344
    v_mfma_f32_16x16x32_bf16 v[164:167], v[88:91], v[136:139], 0
    s_waitcnt vmcnt(1) lgkmcnt(0)
    v_or3_b32 v52, v52, v53, v54
    v_bitop3_b32 v52, v52, v55, s56 bitop3:0xa8
    v_mfma_f32_16x16x32_bf16 v[144:147], v[108:111], v[116:119], v[144:147]
    v_cmp_ne_u32 s[54:55], 0, v52
    s_nop 1
    s_or_b64 s[52:53], s[52:53], s[54:55]
    v_mfma_f32_16x16x32_bf16 v[148:151], v[120:123], v[116:119], v[148:151]
    v_mfma_f32_16x16x32_bf16 v[164:167], v[92:95], v[124:127], v[164:167]
    s_nop 1
    v_exp_f32 v144, v144
    v_mfma_f32_16x16x32_bf16 v[152:155], v[132:135], v[116:119], v[152:155]
    v_exp_f32 v145, v145
    v_mfma_f32_16x16x32_bf16 v[160:163], v[84:87], v[124:127], v[160:163]
    v_exp_f32 v146, v146
    v_mfma_f32_16x16x32_bf16 v[156:159], v[140:143], v[116:119], v[156:159]
    v_exp_f32 v147, v147
    v_cvt_pk_bf16_f32 v136, v144, v145
    v_cvt_pk_bf16_f32 v137, v146, v147
    ds_read_b128 v[144:147], v4 offset:32768
    v_exp_f32 v148, v148
    v_exp_f32 v149, v149
    v_exp_f32 v150, v150
    v_exp_f32 v151, v151
    v_cvt_pk_bf16_f32 v138, v148, v149
    v_cvt_pk_bf16_f32 v139, v150, v151
    ds_read_b128 v[148:151], v4 offset:33792
    v_exp_f32 v152, v152
    v_exp_f32 v153, v153
    v_exp_f32 v154, v154
    v_exp_f32 v155, v155
    v_cvt_pk_bf16_f32 v112, v152, v153
    v_cvt_pk_bf16_f32 v113, v154, v155
    ds_read_b128 v[152:155], v4 offset:34816
    v_exp_f32 v156, v156
    v_rcp_f32 v166, v166
    v_cvt_pk_bf16_f32 v114, v156, 0
    ds_read_b32 v156, v4 offset:35840
    v_mul_f32 v160, v160, v166
    v_mul_f32 v161, v161, v166
    v_mul_f32 v162, v162, v166
    v_mul_f32 v163, v163, v166
    v_mul_f32 v164, v164, v166
    v_mul_f32 v165, v165, v166
    s_waitcnt lgkmcnt(3)
    v_mfma_f32_16x16x32_bf16 v[144:147], v[108:111], v[128:131], v[144:147]
    v_cvt_pk_bf16_f32 v50, v160, v161
    v_cvt_pk_bf16_f32 v51, v162, v163
    v_mfma_f32_16x16x32_bf16 v[160:163], v[80:83], v[136:139], 0
    v_cvt_pk_bf16_f32 v52, v164, v165
    s_waitcnt vmcnt(0)
    v_or3_b32 v64, v64, v65, v66
    v_mfma_f32_16x16x32_bf16 v[164:167], v[88:91], v[136:139], 0
    v_bitop3_b32 v64, v64, v67, s56 bitop3:0xa8
    v_exp_f32 v144, v144
    s_waitcnt lgkmcnt(2)
    v_mfma_f32_16x16x32_bf16 v[148:151], v[120:123], v[128:131], v[148:151]
    v_exp_f32 v145, v145
    v_mfma_f32_16x16x32_bf16 v[164:167], v[92:95], v[112:115], v[164:167]
    v_exp_f32 v146, v146
    v_mfma_f32_16x16x32_bf16 v[160:163], v[84:87], v[112:115], v[160:163]
    v_exp_f32 v147, v147
    s_waitcnt lgkmcnt(1)
    v_mfma_f32_16x16x32_bf16 v[152:155], v[132:135], v[128:131], v[152:155]
    v_cvt_pk_bf16_f32 v136, v144, v145
    ds_read_b64_tr_b16 v[144:145], v3 offset:288
    s_waitcnt lgkmcnt(1)
    v_mfma_f32_16x16x32_bf16 v[156:159], v[140:143], v[128:131], v[156:159]
    ds_read_b128 v[140:143], v4 offset:51200
    v_cvt_pk_bf16_f32 v137, v146, v147
    ds_read_b64_tr_b16 v[146:147], v3 offset:10016
    v_exp_f32 v148, v148
    v_exp_f32 v149, v149
    v_exp_f32 v150, v150
    s_nop 1
    ds_read_b64_tr_b16 v[158:159], v3 offset:10048
    v_exp_f32 v151, v151
    v_cvt_pk_bf16_f32 v138, v148, v149
    ds_read_b64_tr_b16 v[148:149], v3 offset:19744
    v_cvt_pk_bf16_f32 v139, v150, v151
    ds_read_b64_tr_b16 v[150:151], v3 offset:29472
    v_exp_f32 v152, v152
    v_exp_f32 v153, v153
    v_exp_f32 v154, v154
    v_exp_f32 v155, v155
    v_cvt_pk_bf16_f32 v124, v152, v153
    ds_read_b64_tr_b16 v[152:153], v3 offset:39200
    v_cvt_pk_bf16_f32 v125, v154, v155
    ds_read_b64_tr_b16 v[154:155], v3 offset:48928
    v_exp_f32 v156, v156
    v_rcp_f32 v166, v166
    v_cvt_pk_bf16_f32 v126, v156, 0
    ds_read_b64_tr_b16 v[156:157], v3 offset:320
    v_cmp_ne_u32 s[54:55], 0, v64
    v_mul_f32 v160, v160, v166
    v_mul_f32 v161, v161, v166
    s_waitcnt lgkmcnt(6)
    v_mfma_f32_16x16x32_bf16 v[104:107], v[144:147], v[8:11], 0
    v_mul_f32 v162, v162, v166
    v_mul_f32 v163, v163, v166
    v_mfma_f32_16x16x32_bf16 v[116:119], v[144:147], v[20:23], 0
    v_mul_f32 v164, v164, v166
    v_mul_f32 v165, v165, v166
    v_mfma_f32_16x16x32_bf16 v[128:131], v[144:147], v[32:35], 0
    ds_read_b64_tr_b16 v[144:145], v3 offset:19776
    ds_read_b64_tr_b16 v[146:147], v3 offset:29504
    v_cvt_pk_bf16_f32 v62, v160, v161
    s_waitcnt lgkmcnt(5)
    v_mfma_f32_16x16x32_bf16 v[104:107], v[148:151], v[12:15], v[104:107]
    v_cvt_pk_bf16_f32 v63, v162, v163
    v_cvt_pk_bf16_f32 v64, v164, v165
    v_mfma_f32_16x16x32_bf16 v[116:119], v[148:151], v[24:27], v[116:119]
    s_or_b64 s[52:53], s[52:53], s[54:55]
    s_cmp_lg_u64 s[52:53], 0
    v_mfma_f32_16x16x32_bf16 v[128:131], v[148:151], v[36:39], v[128:131]
    ds_read_b64_tr_b16 v[148:149], v3 offset:39232
    ds_read_b64_tr_b16 v[150:151], v3 offset:48960
    s_waitcnt lgkmcnt(5)
    v_mfma_f32_16x16x32_bf16 v[104:107], v[152:155], v[16:19], v[104:107]
    s_cbranch_scc1 L_redo
    v_mfma_f32_16x16x32_bf16 v[116:119], v[152:155], v[28:31], v[116:119]
    v_mfma_f32_16x16x32_bf16 v[128:131], v[152:155], v[40:43], v[128:131]
    ds_read_b64_tr_b16 v[152:153], v3 offset:352
    ds_read_b64_tr_b16 v[154:155], v3 offset:10080
    s_waitcnt lgkmcnt(6)
    v_mfma_f32_16x16x32_bf16 v[108:111], v[156:159], v[8:11], 0
    v_mfma_f32_16x16x32_bf16 v[120:123], v[156:159], v[20:23], 0
    v_mfma_f32_16x16x32_bf16 v[132:135], v[156:159], v[32:35], 0
    ds_read_b64_tr_b16 v[156:157], v3 offset:19808
    ds_read_b64_tr_b16 v[158:159], v3 offset:29536
    s_waitcnt lgkmcnt(6)
    v_mfma_f32_16x16x32_bf16 v[108:111], v[144:147], v[12:15], v[108:111]
    v_mfma_f32_16x16x32_bf16 v[120:123], v[144:147], v[24:27], v[120:123]
    v_mfma_f32_16x16x32_bf16 v[132:135], v[144:147], v[36:39], v[132:135]
    ds_read_b64_tr_b16 v[144:145], v3 offset:39264
    ds_read_b64_tr_b16 v[146:147], v3 offset:48992
    v_mfma_f32_16x16x32_bf16 v[160:163], v[80:83], v[136:139], 0
    v_mfma_f32_16x16x32_bf16 v[164:167], v[88:91], v[136:139], 0
    v_mfma_f32_16x16x32_bf16 v[160:163], v[84:87], v[124:127], v[160:163]
    ds_read_u16 v86, v6 offset:736
    v_mfma_f32_16x16x32_bf16 v[164:167], v[92:95], v[124:127], v[164:167]
    s_waitcnt lgkmcnt(5)
    v_mfma_f32_16x16x32_bf16 v[112:115], v[152:155], v[8:11], 0
    v_mfma_f32_16x16x32_bf16 v[124:127], v[152:155], v[20:23], 0
    s_nop 4
    v_rcp_f32 v166, v166
    v_mfma_f32_16x16x32_bf16 v[136:139], v[152:155], v[32:35], 0
    v_mul_f32 v160, v160, v166
    v_mul_f32 v161, v161, v166
    s_waitcnt lgkmcnt(3)
    v_mfma_f32_16x16x32_bf16 v[112:115], v[156:159], v[12:15], v[112:115]
    v_mul_f32 v162, v162, v166
    v_mul_f32 v163, v163, v166
    v_mfma_f32_16x16x32_bf16 v[124:127], v[156:159], v[24:27], v[124:127]
    v_cvt_pk_bf16_f32 v74, v160, v161
    v_cvt_pk_bf16_f32 v75, v162, v163
    v_mfma_f32_16x16x32_bf16 v[136:139], v[156:159], v[36:39], v[136:139]
    ds_read_b128 v[156:159], v4 offset:50176
    v_fma_f32 v160, v104, v104, s36
    s_waitcnt lgkmcnt(2)
    v_mfma_f32_16x16x32_bf16 v[112:115], v[144:147], v[16:19], v[112:115]
    v_fma_f32 v162, v116, v116, s36
    v_fmac_f32 v160, v105, v105
    v_mfma_f32_16x16x32_bf16 v[124:127], v[144:147], v[28:31], v[124:127]
    v_fmac_f32 v162, v117, v117
    v_fmac_f32 v160, v106, v106
    v_mfma_f32_16x16x32_bf16 v[136:139], v[144:147], v[40:43], v[136:139]
    ds_read_b32 v147, v5 offset:896
    v_fmac_f32 v162, v118, v118
    v_mfma_f32_16x16x32_bf16 v[108:111], v[148:151], v[16:19], v[108:111]
    v_fmac_f32 v160, v107, v107
    v_fmac_f32 v162, v119, v119
    v_mfma_f32_16x16x32_bf16 v[120:123], v[148:151], v[28:31], v[120:123]
    v_mul_f32 v164, v164, v166
    v_mul_f32 v165, v165, v166
    v_mfma_f32_16x16x32_bf16 v[132:135], v[148:151], v[40:43], v[132:135]
    ds_read_b64_tr_b16 v[166:167], v3 offset:29728
    s_nop 0
    v_fma_f32 v161, v110, v110, s36
    v_fmac_f32 v161, v111, v111
    v_fmac_f32 v161, v112, v112
    v_fmac_f32 v161, v113, v113
    v_fma_f32 v163, v122, v122, s36
    v_fmac_f32 v163, v123, v123
    v_fmac_f32 v163, v124, v124
    v_fmac_f32 v163, v125, v125
    v_fmac_f32 v160, v108, v108
    v_fmac_f32 v161, v114, v114
    v_fmac_f32 v162, v120, v120
    v_fmac_f32 v163, v126, v126
    v_fmac_f32 v160, v109, v109
    v_fmac_f32 v161, v115, v115
    v_fmac_f32 v162, v121, v121
    v_fmac_f32 v163, v127, v127
    v_cvt_pk_bf16_f32 v144, v160, v161
    ds_read_b64_tr_b16 v[160:161], v3 offset:544
    v_cvt_pk_bf16_f32 v145, v162, v163
    ds_read_b64_tr_b16 v[162:163], v3 offset:10272
    v_cvt_pk_bf16_f32 v76, v164, v165
    v_fma_f32 v164, v128, v128, s36
    v_fma_f32 v165, v134, v134, s36
    v_fmac_f32 v164, v129, v129
    v_fmac_f32 v165, v135, v135
    v_fmac_f32 v164, v130, v130
    v_fmac_f32 v165, v136, v136
    v_fmac_f32 v164, v131, v131
    v_fmac_f32 v165, v137, v137
    v_fmac_f32 v164, v132, v132
    v_fmac_f32 v165, v138, v138
    v_fmac_f32 v164, v133, v133
    v_fmac_f32 v165, v139, v139
    v_cvt_pk_bf16_f32 v146, v164, v165
    ds_read_b64_tr_b16 v[164:165], v3 offset:20000
    s_setprio 0
    s_waitcnt lgkmcnt(4)
    v_mfma_f32_16x16x32_bf16 v[148:151], v[156:159], v[144:147], 0
    ds_read_b64_tr_b16 v[156:157], v3 offset:39456
    ds_read_b64_tr_b16 v[158:159], v3 offset:49184
    v_mfma_f32_16x16x32_bf16 v[152:155], v[140:143], v[144:147], 0
    ds_read_b128 v[140:143], v5 offset:384
    s_nop 3
    v_rsq_f32 v148, v148
    v_rsq_f32 v150, v150
    s_nop 0
    v_rsq_f32 v152, v152
    v_mul_f32 v148, s35, v148
    s_waitcnt lgkmcnt(4)
    v_mfma_f32_16x16x32_bf16 v[144:147], v[8:11], v[160:163], 0
    v_rsq_f32 v149, v149
    v_mul_f32 v150, s35, v150
    v_rsq_f32 v151, v151
    v_rsq_f32 v153, v153
    v_mul_f32 v104, v104, v148
    v_mul_f32 v105, v105, v148
    v_mul_f32 v116, v116, v150
    v_mul_f32 v117, v117, v150
    v_mul_f32 v152, s35, v152
    v_mul_f32 v106, v106, v148
    s_waitcnt lgkmcnt(3)
    v_mfma_f32_16x16x32_bf16 v[144:147], v[12:15], v[164:167], v[144:147]
    v_mul_f32 v107, v107, v148
    v_cvt_pk_bf16_f32 v104, v104, v105
    v_mul_f32 v118, v118, v150
    s_waitcnt lgkmcnt(1)
    v_mfma_f32_16x16x32_bf16 v[144:147], v[16:19], v[156:159], v[144:147]
    v_mul_f32 v119, v119, v150
    v_cvt_pk_bf16_f32 v116, v116, v117
    v_mul_f32 v108, v108, v148
    v_mul_f32 v109, v109, v148
    v_mul_f32 v110, v110, v149
    v_mul_f32 v111, v111, v149
    v_mul_f32 v112, v112, v149
    v_mul_f32 v113, v113, v149
    v_mul_f32 v114, v114, v149
    v_mul_f32 v115, v115, v149
    v_cvt_pk_bf16_f32 v105, v106, v107
    ds_read_b32 v107, v5 offset:896
    v_mul_f32 v120, v120, v150
    v_mul_f32 v121, v121, v150
    v_mul_f32 v122, v122, v151
    v_mul_f32 v123, v123, v151
    v_mul_f32 v124, v124, v151
    v_mul_f32 v125, v125, v151
    v_mul_f32 v126, v126, v151
    v_mul_f32 v127, v127, v151
    v_mfma_f32_16x16x32_bf16 v[148:151], v[20:23], v[160:163], 0
    v_cvt_pk_bf16_f32 v117, v118, v119
    ds_read_b32 v119, v5 offset:896
    v_mfma_f32_16x16x32_bf16 v[148:151], v[24:27], v[164:167], v[148:151]
    v_mul_f32 v128, v128, v152
    v_mul_f32 v129, v129, v152
    v_mfma_f32_16x16x32_bf16 v[148:151], v[28:31], v[156:159], v[148:151]
    v_mul_f32 v130, v130, v152
    v_mul_f32 v131, v131, v152
    v_mul_f32 v132, v132, v152
    v_mul_f32 v133, v133, v152
    v_mul_f32 v134, v134, v153
    v_mul_f32 v135, v135, v153
    v_mul_f32 v136, v136, v153
    v_mul_f32 v137, v137, v153
    v_mul_f32 v138, v138, v153
    v_mul_f32 v139, v139, v153
    v_mfma_f32_16x16x32_bf16 v[152:155], v[32:35], v[160:163], 0
    ds_read_b128 v[160:163], v5 offset:448
    v_cvt_pk_bf16_f32 v106, v108, v109
    v_mfma_f32_16x16x32_bf16 v[152:155], v[36:39], v[164:167], v[152:155]
    ds_read_b32 v164, v4 offset:49164
    v_cvt_pk_bf16_f32 v118, v120, v121
    v_mfma_f32_16x16x32_bf16 v[152:155], v[40:43], v[156:159], v[152:155]
    v_cvt_pk_bf16_f32 v108, v110, v111
    ds_read_b32 v111, v5 offset:896
    v_cvt_pk_bf16_f32 v120, v122, v123
    ds_read_b32 v123, v5 offset:896
    v_cvt_pk_bf16_f32 v128, v128, v129
    v_cvt_pk_bf16_f32 v129, v130, v131
    ds_read_b32 v131, v5 offset:896
    v_cvt_pk_bf16_f32 v130, v132, v133
    v_cvt_pk_bf16_f32 v132, v134, v135
    ds_read_b32 v135, v5 offset:896
    v_cvt_pk_bf16_f32 v109, v112, v113
    v_cvt_pk_bf16_f32 v110, v114, v115
    ds_read_b32 v115, v5 offset:896
    v_cvt_pk_bf16_f32 v121, v124, v125
    v_cvt_pk_bf16_f32 v122, v126, v127
    ds_read_b32 v127, v5 offset:896
    v_cvt_pk_bf16_f32 v80, v144, v145
    v_cvt_pk_bf16_f32 v81, v146, v147
    v_cvt_pk_bf16_f32 v82, v148, v149
    v_cvt_pk_bf16_f32 v83, v150, v151
    v_cvt_pk_bf16_f32 v133, v136, v137
    v_cvt_pk_bf16_f32 v134, v138, v139
    v_cvt_pk_bf16_f32 v84, v152, v153
    v_cvt_pk_bf16_f32 v85, v154, v155
L_poll1f:
    v_mov_b32 v42, 136228
    ds_read_b32 v42, v42 offset:0
    s_waitcnt lgkmcnt(0)
    v_readfirstlane_b32 s58, v42
    s_sub_u32 s65, s65, 1
    s_cbranch_scc1 L_poll1fx
    s_cmp_lt_u32 s58, 6
    s_cbranch_scc1 L_poll1f
L_poll1fx:
    v_mfma_f32_16x16x32_bf16 v[156:159], v[160:163], v[140:143], 0
    v_mfma_f32_16x16x32_bf16 v[144:147], v[160:163], v[108:111], 0
    v_mfma_f32_16x16x32_bf16 v[148:151], v[160:163], v[120:123], 0
    v_mfma_f32_16x16x32_bf16 v[152:155], v[160:163], v[132:135], 0
    s_nop 6
    v_mov_b32_dpp v144, v148 quad_perm:[0,1,2,3] row_mask:2 bank_mask:0xf
    ds_read_b128 v[148:151], v4 offset:37888
    s_nop 0
    v_mov_b32_dpp v144, v152 quad_perm:[0,1,2,3] row_mask:4 bank_mask:0xf
    ds_read_b128 v[152:155], v4 offset:38912
    s_nop 0
    v_mov_b32_dpp v144, v156 quad_perm:[0,1,2,3] row_mask:8 bank_mask:0xf
    ds_read_b32 v156, v4 offset:39936
    v_add_f32 v144, v144, v164
    v_exp_f32 v144, v144
    s_nop 0
    v_cvt_pk_bf16_f32 v144, v144, v144
    ds_write_b16 v7, v144 offset:0
    ds_read_b128 v[144:147], v4 offset:36864
    s_waitcnt lgkmcnt(1)
    ds_read_b128 v[136:139], v5 offset:768
    v_mfma_f32_16x16x32_bf16 v[148:151], v[120:123], v[104:107], v[148:151]
    v_mfma_f32_16x16x32_bf16 v[152:155], v[132:135], v[104:107], v[152:155]
    v_mfma_f32_16x16x32_bf16 v[156:159], v[140:143], v[104:107], v[156:159]
    s_nop 5
    v_exp_f32 v148, v148
    v_exp_f32 v149, v149
    s_waitcnt lgkmcnt(1)
    v_mfma_f32_16x16x32_bf16 v[144:147], v[108:111], v[104:107], v[144:147]
    s_waitcnt lgkmcnt(0)
    ds_read_b128 v[112:115], v5 offset:832
    v_exp_f32 v150, v150
    v_mfma_f32_16x16x32_bf16 v[160:163], v[80:83], v[136:139], 0
    v_exp_f32 v151, v151
    v_mfma_f32_16x16x32_bf16 v[164:167], v[96:99], v[136:139], 0
    v_cvt_pk_bf16_f32 v138, v148, v149
    v_cvt_pk_bf16_f32 v139, v150, v151
    ds_read_b128 v[148:151], v4 offset:41984
    v_exp_f32 v144, v144
    v_exp_f32 v145, v145
    v_exp_f32 v146, v146
    v_exp_f32 v147, v147
    v_exp_f32 v152, v152
    v_exp_f32 v153, v153
    v_exp_f32 v154, v154
    v_exp_f32 v155, v155
    v_cvt_pk_bf16_f32 v136, v144, v145
    v_cvt_pk_bf16_f32 v137, v146, v147
    ds_read_b128 v[144:147], v4 offset:40960
    v_cvt_pk_bf16_f32 v124, v152, v153
    v_cvt_pk_bf16_f32 v125, v154, v155
    ds_read_b128 v[152:155], v4 offset:43008
    v_exp_f32 v156, v156
    s_waitcnt lgkmcnt(3)
    v_mfma_f32_16x16x32_bf16 v[160:163], v[84:87], v[112:115], v[160:163]
    v_cvt_pk_bf16_f32 v126, v156, 0
    ds_read_b32 v156, v4 offset:44032
    v_mfma_f32_16x16x32_bf16 v[164:167], v[100:103], v[112:115], v[164:167]
    s_waitcnt lgkmcnt(3)
    v_mfma_f32_16x16x32_bf16 v[148:151], v[120:123], v[116:119], v[148:151]
    s_nop 2
    ds_write_b128 v5, v[160:163] offset:1408
    v_mfma_f32_16x16x32_bf16 v[160:163], v[80:83], v[136:139], 0
    s_waitcnt lgkmcnt(0)
    ds_write_b128 v5, v[164:167] offset:1472
    v_mov_b32 v40, 136232
    v_mov_b32 v41, 1
    s_mov_b64 exec, 1
    ds_add_u32 v40, v41
    s_mov_b64 exec, -1
    v_mfma_f32_16x16x32_bf16 v[164:167], v[96:99], v[136:139], 0
    v_exp_f32 v148, v148
    v_mfma_f32_16x16x32_bf16 v[164:167], v[100:103], v[124:127], v[164:167]
    v_exp_f32 v149, v149
    v_mfma_f32_16x16x32_bf16 v[144:147], v[108:111], v[116:119], v[144:147]
    v_exp_f32 v150, v150
    v_mfma_f32_16x16x32_bf16 v[152:155], v[132:135], v[116:119], v[152:155]
    v_exp_f32 v151, v151
    v_mfma_f32_16x16x32_bf16 v[156:159], v[140:143], v[116:119], v[156:159]
    v_cvt_pk_bf16_f32 v138, v148, v149
    v_cvt_pk_bf16_f32 v139, v150, v151
    v_mfma_f32_16x16x32_bf16 v[160:163], v[84:87], v[124:127], v[160:163]
    ds_read_b128 v[148:151], v4 offset:46080
    v_exp_f32 v144, v144
    v_exp_f32 v145, v145
    v_exp_f32 v146, v146
    v_exp_f32 v147, v147
    v_exp_f32 v152, v152
    v_exp_f32 v153, v153
    v_exp_f32 v154, v154
    v_exp_f32 v155, v155
    v_cvt_pk_bf16_f32 v136, v144, v145
    v_cvt_pk_bf16_f32 v137, v146, v147
    ds_read_b128 v[144:147], v4 offset:45056
    v_cvt_pk_bf16_f32 v112, v152, v153
    v_cvt_pk_bf16_f32 v113, v154, v155
    ds_read_b128 v[152:155], v4 offset:47104
    v_exp_f32 v156, v156
    v_subrev_u32 v40, 79872, v4
    v_cvt_pk_bf16_f32 v114, v156, 0
    ds_read_b32 v156, v4 offset:48128
    v_lshrrev_b32 v41, 6, v40
    v_mul_u32_u24 v41, 224, v41
    v_bfe_u32 v40, v40, 4, 2
    v_lshl_add_u32 v41, v40, 3, v41
    v_add_u32 v3, 58368, v41
    ds_read_b64_tr_b16 v[32:33], v3 offset:0
    ds_read_b64_tr_b16 v[34:35], v3 offset:3584
    s_waitcnt lgkmcnt(5)
    v_mfma_f32_16x16x32_bf16 v[148:151], v[120:123], v[128:131], v[148:151]
    ds_read_b64_tr_b16 v[36:37], v3 offset:7168
    ds_read_b64_tr_b16 v[38:39], v3 offset:10752
    ds_read_b128 v[40:43], v4 offset:50176
    v_rcp_f32 v164, v164
    s_nop 0
    v_mul_f32 v160, v160, v164
    v_mul_f32 v161, v161, v164
    v_mul_f32 v162, v162, v164
    v_mul_f32 v163, v163, v164
    v_mul_f32 v166, v166, v164
    v_mul_f32 v167, v167, v164
    v_cvt_pk_bf16_f32 v53, v160, v161
    v_cvt_pk_bf16_f32 v54, v162, v163
    v_mfma_f32_16x16x32_bf16 v[160:163], v[80:83], v[136:139], 0
    v_cvt_pk_bf16_f32 v55, v166, v167
    v_exp_f32 v148, v148
    s_waitcnt lgkmcnt(7)
    v_mfma_f32_16x16x32_bf16 v[144:147], v[108:111], v[128:131], v[144:147]
    v_exp_f32 v149, v149
    s_waitcnt lgkmcnt(6)
    v_mfma_f32_16x16x32_bf16 v[152:155], v[132:135], v[128:131], v[152:155]
    v_exp_f32 v150, v150
    s_waitcnt lgkmcnt(5)
    v_mfma_f32_16x16x32_bf16 v[156:159], v[140:143], v[128:131], v[156:159]
    ds_read_b32 v141, v5 offset:896
    ds_read_b32 v142, v5 offset:896
    v_mfma_f32_16x16x32_bf16 v[164:167], v[96:99], v[136:139], 0
    v_exp_f32 v151, v151
    v_mfma_f32_16x16x32_bf16 v[164:167], v[100:103], v[112:115], v[164:167]
    v_cvt_pk_bf16_f32 v138, v148, v149
    ds_read_b64_tr_b16 v[148:149], v3 offset:32
    v_mfma_f32_16x16x32_bf16 v[160:163], v[84:87], v[112:115], v[160:163]
    ds_read_b64_tr_b16 v[158:159], v3 offset:17952
    v_cvt_pk_bf16_f32 v139, v150, v151
    s_waitcnt lgkmcnt(7)
    v_mfma_f32_16x16x32_bf16 v[8:11], v[32:35], v[44:47], 0
    ds_read_b64_tr_b16 v[150:151], v3 offset:3616
    v_exp_f32 v144, v144
    v_mfma_f32_16x16x32_bf16 v[104:107], v[32:35], v[56:59], 0
    v_exp_f32 v145, v145
    s_waitcnt lgkmcnt(6)
    v_mfma_f32_16x16x32_bf16 v[8:11], v[36:39], v[48:51], v[8:11]
    v_exp_f32 v146, v146
    v_mfma_f32_16x16x32_bf16 v[104:107], v[36:39], v[60:63], v[104:107]
    v_exp_f32 v147, v147
    v_exp_f32 v152, v152
    v_exp_f32 v153, v153
    v_exp_f32 v154, v154
    v_exp_f32 v155, v155
    v_cvt_pk_bf16_f32 v136, v144, v145
    ds_read_b64_tr_b16 v[144:145], v3 offset:14336
    v_cvt_pk_bf16_f32 v137, v146, v147
    ds_read_b64_tr_b16 v[146:147], v3 offset:17920
    v_cvt_pk_bf16_f32 v124, v152, v153
    ds_read_b64_tr_b16 v[152:153], v3 offset:7200
    v_cvt_pk_bf16_f32 v125, v154, v155
    ds_read_b64_tr_b16 v[154:155], v3 offset:10784
    v_exp_f32 v156, v156
    v_rcp_f32 v164, v164
    s_waitcnt lgkmcnt(4)
    v_mfma_f32_16x16x32_bf16 v[12:15], v[148:151], v[44:47], 0
    v_cvt_pk_bf16_f32 v126, v156, 0
    ds_read_b64_tr_b16 v[156:157], v3 offset:14368
    v_mfma_f32_16x16x32_bf16 v[108:111], v[148:151], v[56:59], 0
    v_mul_f32 v166, v166, v164
    v_mul_f32 v167, v167, v164
    v_mul_f32 v160, v160, v164
    v_mul_f32 v161, v161, v164
    v_mul_f32 v162, v162, v164
    v_mul_f32 v163, v163, v164
    v_cvt_pk_bf16_f32 v67, v166, v167
    v_mfma_f32_16x16x32_bf16 v[164:167], v[96:99], v[136:139], 0
    v_cvt_pk_bf16_f32 v65, v160, v161
    v_cvt_pk_bf16_f32 v66, v162, v163
    v_mfma_f32_16x16x32_bf16 v[160:163], v[80:83], v[136:139], 0
    v_mfma_f32_16x16x32_bf16 v[164:167], v[100:103], v[124:127], v[164:167]
    v_mfma_f32_16x16x32_bf16 v[160:163], v[84:87], v[124:127], v[160:163]
    v_mfma_f32_16x16x32_bf16 v[80:83], v[32:35], v[68:71], 0
    ds_read_b64_tr_b16 v[32:33], v3 offset:64
    ds_read_b64_tr_b16 v[34:35], v3 offset:3648
    v_mfma_f32_16x16x32_bf16 v[80:83], v[36:39], v[72:75], v[80:83]
    ds_read_b64_tr_b16 v[36:37], v3 offset:7232
    ds_read_b64_tr_b16 v[38:39], v3 offset:10816
    v_mfma_f32_16x16x32_bf16 v[84:87], v[148:151], v[68:71], 0
    ds_read_b64_tr_b16 v[148:149], v3 offset:96
    ds_read_b64_tr_b16 v[150:151], v3 offset:3680
    s_waitcnt lgkmcnt(9)
    v_mfma_f32_16x16x32_bf16 v[8:11], v[144:147], v[52:55], v[8:11]
    v_rcp_f32 v164, v164
    v_mfma_f32_16x16x32_bf16 v[104:107], v[144:147], v[64:67], v[104:107]
    v_mul_f32 v160, v160, v164
    v_mul_f32 v161, v161, v164
    s_waitcnt lgkmcnt(7)
    v_mfma_f32_16x16x32_bf16 v[12:15], v[152:155], v[48:51], v[12:15]
    v_mul_f32 v162, v162, v164
    v_mul_f32 v163, v163, v164
    v_mfma_f32_16x16x32_bf16 v[108:111], v[152:155], v[60:63], v[108:111]
    v_mul_f32 v166, v166, v164
    v_mul_f32 v167, v167, v164
    v_mfma_f32_16x16x32_bf16 v[84:87], v[152:155], v[72:75], v[84:87]
    ds_read_b64_tr_b16 v[152:153], v3 offset:7264
    ds_read_b64_tr_b16 v[154:155], v3 offset:10848
    s_waitcnt lgkmcnt(8)
    v_mfma_f32_16x16x32_bf16 v[12:15], v[156:159], v[52:55], v[12:15]
    v_cvt_pk_bf16_f32 v77, v160, v161
    v_cvt_pk_bf16_f32 v78, v162, v163
    v_mfma_f32_16x16x32_bf16 v[108:111], v[156:159], v[64:67], v[108:111]
    v_cvt_pk_bf16_f32 v79, v166, v167
    v_fma_f32 v160, v8, v8, s37
    s_waitcnt lgkmcnt(6)
    v_mfma_f32_16x16x32_bf16 v[16:19], v[32:35], v[44:47], 0
    v_fmac_f32 v160, v9, v9
    v_fmac_f32 v160, v10, v10
    v_mfma_f32_16x16x32_bf16 v[80:83], v[144:147], v[76:79], v[80:83]
    ds_read_b64_tr_b16 v[144:145], v3 offset:14400
    ds_read_b64_tr_b16 v[146:147], v3 offset:17984
    v_mfma_f32_16x16x32_bf16 v[84:87], v[156:159], v[76:79], v[84:87]
    ds_read_b64_tr_b16 v[156:157], v3 offset:14432
    ds_read_b64_tr_b16 v[158:159], v3 offset:18016
    v_mfma_f32_16x16x32_bf16 v[112:115], v[32:35], v[56:59], 0
    v_fmac_f32 v160, v11, v11
    v_fma_f32 v161, v104, v104, s37
    v_mfma_f32_16x16x32_bf16 v[88:91], v[32:35], v[68:71], 0
    ds_read_b64_tr_b16 v[32:33], v3 offset:128
    ds_read_b64_tr_b16 v[34:35], v3 offset:3712
    s_waitcnt lgkmcnt(10)
    v_mfma_f32_16x16x32_bf16 v[16:19], v[36:39], v[48:51], v[16:19]
    v_fma_f32 v162, v80, v80, s37
    v_fmac_f32 v160, v12, v12
    v_mfma_f32_16x16x32_bf16 v[112:115], v[36:39], v[60:63], v[112:115]
    v_fmac_f32 v161, v105, v105
    v_fmac_f32 v162, v81, v81
    v_mfma_f32_16x16x32_bf16 v[88:91], v[36:39], v[72:75], v[88:91]
    ds_read_b64_tr_b16 v[36:37], v3 offset:7296
    ds_read_b64_tr_b16 v[38:39], v3 offset:10880
    s_waitcnt lgkmcnt(10)
    v_mfma_f32_16x16x32_bf16 v[20:23], v[148:151], v[44:47], 0
    v_fmac_f32 v160, v13, v13
    v_fmac_f32 v161, v106, v106
    v_mfma_f32_16x16x32_bf16 v[116:119], v[148:151], v[56:59], 0
    v_fmac_f32 v162, v82, v82
    v_fmac_f32 v160, v14, v14
    v_mfma_f32_16x16x32_bf16 v[92:95], v[148:151], v[68:71], 0
    ds_read_b64_tr_b16 v[148:149], v3 offset:160
    ds_read_b64_tr_b16 v[150:151], v3 offset:3744
    s_waitcnt lgkmcnt(8)
    v_mfma_f32_16x16x32_bf16 v[16:19], v[144:147], v[52:55], v[16:19]
    v_fmac_f32 v161, v107, v107
    v_fmac_f32 v162, v83, v83
    v_mfma_f32_16x16x32_bf16 v[112:115], v[144:147], v[64:67], v[112:115]
    v_fmac_f32 v160, v15, v15
    v_fmac_f32 v161, v108, v108
    v_mfma_f32_16x16x32_bf16 v[88:91], v[144:147], v[76:79], v[88:91]
    ds_read_b64_tr_b16 v[144:145], v3 offset:14464
    ds_read_b64_tr_b16 v[146:147], v3 offset:18048
    v_mfma_f32_16x16x32_bf16 v[20:23], v[152:155], v[48:51], v[20:23]
    v_fmac_f32 v162, v84, v84
    v_fmac_f32 v160, v16, v16
    v_mfma_f32_16x16x32_bf16 v[116:119], v[152:155], v[60:63], v[116:119]
    v_fmac_f32 v161, v109, v109
    v_fmac_f32 v162, v85, v85
    v_mfma_f32_16x16x32_bf16 v[92:95], v[152:155], v[72:75], v[92:95]
    ds_read_b64_tr_b16 v[152:153], v3 offset:7328
    ds_read_b64_tr_b16 v[154:155], v3 offset:10912
    s_waitcnt lgkmcnt(10)
    v_mfma_f32_16x16x32_bf16 v[20:23], v[156:159], v[52:55], v[20:23]
    v_fmac_f32 v160, v17, v17
    v_fmac_f32 v161, v110, v110
    v_mfma_f32_16x16x32_bf16 v[116:119], v[156:159], v[64:67], v[116:119]
    v_fmac_f32 v162, v86, v86
    v_fmac_f32 v160, v18, v18
    v_mfma_f32_16x16x32_bf16 v[92:95], v[156:159], v[76:79], v[92:95]
    ds_read_b64_tr_b16 v[156:157], v3 offset:14496
    ds_read_b64_tr_b16 v[158:159], v3 offset:18080
    s_waitcnt lgkmcnt(10)
    v_mfma_f32_16x16x32_bf16 v[24:27], v[32:35], v[44:47], 0
    v_fmac_f32 v161, v111, v111
    v_fmac_f32 v162, v87, v87
    v_mfma_f32_16x16x32_bf16 v[120:123], v[32:35], v[56:59], 0
    v_fmac_f32 v160, v19, v19
    v_fmac_f32 v161, v112, v112
    v_mfma_f32_16x16x32_bf16 v[96:99], v[32:35], v[68:71], 0
    ds_read_b32 v33, v5 offset:896
    ds_read_b32 v34, v5 offset:896
    s_waitcnt lgkmcnt(10)
    v_mfma_f32_16x16x32_bf16 v[24:27], v[36:39], v[48:51], v[24:27]
    ds_read_b32 v35, v5 offset:896
    v_fmac_f32 v162, v88, v88
    s_waitcnt lgkmcnt(9)
    v_mfma_f32_16x16x32_bf16 v[28:31], v[148:151], v[44:47], 0
    v_fmac_f32 v160, v20, v20
    v_fmac_f32 v161, v113, v113
    v_mfma_f32_16x16x32_bf16 v[120:123], v[36:39], v[60:63], v[120:123]
    v_fmac_f32 v162, v89, v89
    v_fmac_f32 v160, v21, v21
    v_mfma_f32_16x16x32_bf16 v[96:99], v[36:39], v[72:75], v[96:99]
    v_fmac_f32 v161, v114, v114
    v_fmac_f32 v162, v90, v90
    v_mfma_f32_16x16x32_bf16 v[124:127], v[148:151], v[56:59], 0
    v_fmac_f32 v160, v22, v22
    v_fmac_f32 v161, v115, v115
    v_mfma_f32_16x16x32_bf16 v[100:103], v[148:151], v[68:71], 0
    v_fmac_f32 v162, v91, v91
    v_fmac_f32 v160, v23, v23
    s_waitcnt lgkmcnt(7)
    v_mfma_f32_16x16x32_bf16 v[24:27], v[144:147], v[52:55], v[24:27]
    v_fmac_f32 v161, v116, v116
    v_fmac_f32 v162, v92, v92
    s_waitcnt lgkmcnt(5)
    v_mfma_f32_16x16x32_bf16 v[28:31], v[152:155], v[48:51], v[28:31]
    v_fmac_f32 v161, v117, v117
    v_fmac_f32 v162, v93, v93
    v_mfma_f32_16x16x32_bf16 v[120:123], v[144:147], v[64:67], v[120:123]
    v_fmac_f32 v161, v118, v118
    v_fmac_f32 v160, v24, v24
    v_mfma_f32_16x16x32_bf16 v[96:99], v[144:147], v[76:79], v[96:99]
    v_fmac_f32 v160, v25, v25
    v_fmac_f32 v162, v94, v94
    v_mfma_f32_16x16x32_bf16 v[124:127], v[152:155], v[60:63], v[124:127]
    v_fmac_f32 v160, v26, v26
    v_fmac_f32 v161, v119, v119
    v_mfma_f32_16x16x32_bf16 v[100:103], v[152:155], v[72:75], v[100:103]
    v_fmac_f32 v162, v95, v95
    v_fmac_f32 v160, v27, v27
    s_waitcnt lgkmcnt(3)
    v_mfma_f32_16x16x32_bf16 v[28:31], v[156:159], v[52:55], v[28:31]
    v_fmac_f32 v161, v120, v120
    v_fmac_f32 v162, v96, v96
    v_mfma_f32_16x16x32_bf16 v[124:127], v[156:159], v[64:67], v[124:127]
    v_fmac_f32 v161, v121, v121
    v_fmac_f32 v162, v97, v97
    v_mfma_f32_16x16x32_bf16 v[100:103], v[156:159], v[76:79], v[100:103]
    v_fmac_f32 v161, v122, v122
    s_nop 0
    v_fmac_f32 v160, v28, v28
    v_fmac_f32 v160, v29, v29
    v_fmac_f32 v162, v98, v98
    v_fmac_f32 v160, v30, v30
    v_fmac_f32 v161, v123, v123
    v_fmac_f32 v162, v99, v99
    v_fmac_f32 v160, v31, v31
    v_fmac_f32 v161, v124, v124
    v_fmac_f32 v162, v100, v100
    v_fmac_f32 v161, v125, v125
    v_fmac_f32 v162, v101, v101
    v_cvt_pk_bf16_f32 v32, v160, v160
    v_fmac_f32 v161, v126, v126
    v_fmac_f32 v162, v102, v102
    s_waitcnt lgkmcnt(0)
    v_mfma_f32_16x16x32_bf16 v[36:39], v[40:43], v[32:35], 0
    v_fmac_f32 v161, v127, v127
    v_fmac_f32 v162, v103, v103
    v_cvt_pk_bf16_f32 v140, v161, v162
    s_nop 1
    v_mfma_f32_16x16x32_bf16 v[164:167], v[40:43], v[140:143], 0
    s_nop 1
    v_rsq_f32 v36, v36
    s_nop 0
    v_mul_f32 v36, 0x411cc471, v36
    v_mul_f32 v8, v8, v36
    v_mul_f32 v9, v9, v36
    v_mul_f32 v10, v10, v36
    v_rsq_f32 v164, v164
    v_mul_f32 v11, v11, v36
    v_mul_f32 v16, v16, v36
    v_mul_f32 v17, v17, v36
    v_cvt_pk_bf16_f32 v8, v8, v9
    v_mul_f32 v12, v12, v36
    v_mul_f32 v13, v13, v36
    v_mul_f32 v14, v14, v36
    v_mul_f32 v15, v15, v36
    v_mul_f32 v18, v18, v36
    v_mul_f32 v19, v19, v36
    v_mul_f32 v24, v24, v36
    v_mul_f32 v25, v25, v36
    v_cvt_pk_bf16_f32 v9, v10, v11
    v_cvt_pk_bf16_f32 v16, v16, v17
    v_mul_f32 v164, 0x411cc471, v164
    v_rsq_f32 v165, v165
    v_mul_f32 v20, v20, v36
    v_mul_f32 v21, v21, v36
    v_mul_f32 v22, v22, v36
    v_mul_f32 v23, v23, v36
    v_mul_f32 v26, v26, v36
    v_mul_f32 v27, v27, v36
    v_cvt_pk_bf16_f32 v10, v12, v13
    v_cvt_pk_bf16_f32 v11, v14, v15
    v_cvt_pk_bf16_f32 v17, v18, v19
    v_cvt_pk_bf16_f32 v24, v24, v25
    v_mul_f32 v104, v104, v164
    v_mul_f32 v105, v105, v164
    v_mul_f32 v28, v28, v36
    v_mul_f32 v29, v29, v36
    v_mul_f32 v30, v30, v36
    v_mul_f32 v31, v31, v36
    buffer_store_dwordx4 v[8:11], v0, s[8:11], 0 offen offset:0 sc1
    v_cvt_pk_bf16_f32 v18, v20, v21
    v_cvt_pk_bf16_f32 v19, v22, v23
    v_cvt_pk_bf16_f32 v25, v26, v27
    v_mul_f32 v106, v106, v164
    v_mul_f32 v107, v107, v164
    v_mul_f32 v112, v112, v164
    v_mul_f32 v113, v113, v164
    v_cvt_pk_bf16_f32 v104, v104, v105
    buffer_store_dwordx4 v[16:19], v0, s[8:11], 0 offen offset:64 sc1
    v_cvt_pk_bf16_f32 v26, v28, v29
    v_cvt_pk_bf16_f32 v27, v30, v31
    v_mul_f32 v108, v108, v164
    v_mul_f32 v109, v109, v164
    v_mul_f32 v110, v110, v164
    v_mul_f32 v111, v111, v164
    v_mul_f32 v114, v114, v164
    v_mul_f32 v115, v115, v164
    v_mul_f32 v120, v120, v164
    v_mul_f32 v121, v121, v164
    v_cvt_pk_bf16_f32 v105, v106, v107
    v_cvt_pk_bf16_f32 v112, v112, v113
    v_mul_f32 v165, 0x411cc471, v165
    buffer_store_dwordx4 v[24:27], v0, s[8:11], 0 offen offset:128 sc1
    v_mul_f32 v116, v116, v164
    v_mul_f32 v117, v117, v164
    v_mul_f32 v118, v118, v164
    v_mul_f32 v119, v119, v164
    v_mul_f32 v122, v122, v164
    v_mul_f32 v123, v123, v164
    v_cvt_pk_bf16_f32 v106, v108, v109
    v_cvt_pk_bf16_f32 v107, v110, v111
    v_cvt_pk_bf16_f32 v113, v114, v115
    v_cvt_pk_bf16_f32 v120, v120, v121
    v_mul_f32 v80, v80, v165
    v_mul_f32 v81, v81, v165
    v_mul_f32 v124, v124, v164
    v_mul_f32 v125, v125, v164
    v_mul_f32 v126, v126, v164
    v_mul_f32 v127, v127, v164
    buffer_store_dwordx4 v[104:107], v1, s[8:11], 0 offen offset:0 sc1
    v_cvt_pk_bf16_f32 v114, v116, v117
    v_cvt_pk_bf16_f32 v115, v118, v119
    v_cvt_pk_bf16_f32 v121, v122, v123
    v_mul_f32 v82, v82, v165
    v_mul_f32 v83, v83, v165
    v_mul_f32 v88, v88, v165
    v_mul_f32 v89, v89, v165
    v_cvt_pk_bf16_f32 v80, v80, v81
    buffer_store_dwordx4 v[112:115], v1, s[8:11], 0 offen offset:64 sc1
    v_cvt_pk_bf16_f32 v122, v124, v125
    v_cvt_pk_bf16_f32 v123, v126, v127
    v_mul_f32 v84, v84, v165
    v_mul_f32 v85, v85, v165
    v_mul_f32 v86, v86, v165
    v_mul_f32 v87, v87, v165
    v_mul_f32 v90, v90, v165
    v_mul_f32 v91, v91, v165
    v_mul_f32 v96, v96, v165
    v_mul_f32 v97, v97, v165
    v_cvt_pk_bf16_f32 v81, v82, v83
    v_cvt_pk_bf16_f32 v88, v88, v89
    buffer_store_dwordx4 v[120:123], v1, s[8:11], 0 offen offset:128 sc1
    v_mul_f32 v92, v92, v165
    v_mul_f32 v93, v93, v165
    v_mul_f32 v94, v94, v165
    v_mul_f32 v95, v95, v165
    v_mul_f32 v98, v98, v165
    v_mul_f32 v99, v99, v165
    v_cvt_pk_bf16_f32 v82, v84, v85
    v_cvt_pk_bf16_f32 v83, v86, v87
    v_cvt_pk_bf16_f32 v89, v90, v91
    v_cvt_pk_bf16_f32 v96, v96, v97
    v_mul_f32 v100, v100, v165
    v_mul_f32 v101, v101, v165
    v_mul_f32 v102, v102, v165
    v_mul_f32 v103, v103, v165
    buffer_store_dwordx4 v[80:83], v2, s[8:11], 0 offen offset:0 sc1
    v_cvt_pk_bf16_f32 v90, v92, v93
    v_cvt_pk_bf16_f32 v91, v94, v95
    v_cvt_pk_bf16_f32 v97, v98, v99
    buffer_store_dwordx4 v[88:91], v2, s[8:11], 0 offen offset:64 sc1
    v_cvt_pk_bf16_f32 v98, v100, v101
    v_cvt_pk_bf16_f32 v99, v102, v103
    buffer_store_dwordx4 v[96:99], v2, s[8:11], 0 offen offset:128 sc1
    s_cmp_eq_u32 s3, 0
    s_cbranch_scc1 L_jo
    s_endpgm
L_jo:
    s_nop 7
    s_setprio 0
L_poll2f:
    s_sleep 4
    v_mov_b32 v8, 136232
    ds_read_b32 v8, v8 offset:0
    s_waitcnt lgkmcnt(0)
    v_readfirstlane_b32 s58, v8
    s_sub_u32 s65, s65, 1
    s_cbranch_scc1 L_poll2fx
    s_cmp_lt_u32 s58, s64
    s_cbranch_scc1 L_poll2f
L_poll2fx:
    ds_read_b64_tr_b16 v[48:49], v3 offset:0
    ds_read_b64_tr_b16 v[50:51], v3 offset:3584
    ds_read_b64_tr_b16 v[52:53], v3 offset:7168
    ds_read_b64_tr_b16 v[54:55], v3 offset:10752
    ds_read_b64_tr_b16 v[60:61], v3 offset:32
    ds_read_b64_tr_b16 v[62:63], v3 offset:3616
    ds_read_b64_tr_b16 v[56:57], v3 offset:14336
    ds_read_b64_tr_b16 v[58:59], v3 offset:17920
    ds_read_b64_tr_b16 v[64:65], v3 offset:7200
    ds_read_b64_tr_b16 v[66:67], v3 offset:10784
    ds_read_b64_tr_b16 v[72:73], v3 offset:64
    ds_read_b64_tr_b16 v[74:75], v3 offset:3648
    v_bfe_u32 v8, v4, 4, 4
    v_min_u32 v8, 11, v8
    v_bfe_u32 v9, v4, 8, 2
    v_mul_u32_u24 v8, 1536, v8
    v_lshl_add_u32 v8, v9, 4, v8
    v_add_u32 v8, 137600, v8
    v_bfe_u32 v10, v4, 4, 6
    v_lshlrev_b32 v10, 2, v10
    v_add_u32 v10, 136256, v10
    v_mov_b32 v125, 0
    v_mov_b32 v126, 0
    v_mov_b32 v127, 0
    ds_read_b128 v[136:139], v8 offset:64
    ds_read_b128 v[144:147], v8 offset:192
    ds_read_b128 v[132:135], v8 offset:0
    ds_read_b128 v[140:143], v8 offset:128
    ds_read_b128 v[152:155], v8 offset:320
    ds_read_b128 v[148:151], v8 offset:256
    ds_read_b128 v[160:163], v8 offset:448
    ds_read_b128 v[156:159], v8 offset:384
    ds_read_b64_tr_b16 v[68:69], v3 offset:14368
    ds_read_b64_tr_b16 v[70:71], v3 offset:17952
    ds_read_b64_tr_b16 v[76:77], v3 offset:7232
    ds_read_b64_tr_b16 v[78:79], v3 offset:10816
    ds_read_b64_tr_b16 v[84:85], v3 offset:96
    ds_read_b64_tr_b16 v[86:87], v3 offset:3680
    ds_read_b64_tr_b16 v[80:81], v3 offset:14400
    ds_read_b64_tr_b16 v[82:83], v3 offset:17984
    ds_read_b64_tr_b16 v[88:89], v3 offset:7264
    ds_read_b64_tr_b16 v[90:91], v3 offset:10848
    ds_read_b64_tr_b16 v[96:97], v3 offset:128
    ds_read_b64_tr_b16 v[98:99], v3 offset:3712
    ds_read_b64_tr_b16 v[92:93], v3 offset:14432
    ds_read_b64_tr_b16 v[94:95], v3 offset:18016
    ds_read_b64_tr_b16 v[100:101], v3 offset:7296
    ds_read_b64_tr_b16 v[102:103], v3 offset:10880
    s_waitcnt lgkmcnt(15)
    v_rcp_f32 v138, v138
    v_rcp_f32 v144, v144
    v_mul_f32 v132, v132, v138
    v_mul_f32 v133, v133, v138
    v_mul_f32 v134, v134, v138
    v_mul_f32 v135, v135, v138
    v_mul_f32 v136, v136, v138
    v_mul_f32 v137, v137, v138
    v_mul_f32 v140, v140, v144
    v_mul_f32 v141, v141, v144
    v_cvt_pk_bf16_f32 v12, v132, v133
    v_cvt_pk_bf16_f32 v13, v134, v135
    v_cvt_pk_bf16_f32 v14, v136, v137
    v_cvt_pk_bf16_f32 v15, v140, v141
    v_rcp_f32 v154, v154
    s_nop 0
    v_mfma_f32_16x16x32_bf16 v[24:27], v[48:51], v[12:15], 0
    v_mul_f32 v142, v142, v144
    v_mul_f32 v143, v143, v144
    v_mfma_f32_16x16x32_bf16 v[28:31], v[60:63], v[12:15], 0
    ds_read_b64_tr_b16 v[108:109], v3 offset:160
    ds_read_b64_tr_b16 v[110:111], v3 offset:3744
    v_mfma_f32_16x16x32_bf16 v[32:35], v[72:75], v[12:15], 0
    ds_read_b64_tr_b16 v[104:105], v3 offset:14464
    ds_read_b64_tr_b16 v[106:107], v3 offset:18048
    s_waitcnt lgkmcnt(14)
    v_mfma_f32_16x16x32_bf16 v[36:39], v[84:87], v[12:15], 0
    ds_read_b64_tr_b16 v[112:113], v3 offset:7328
    ds_read_b64_tr_b16 v[114:115], v3 offset:10912
    s_waitcnt lgkmcnt(10)
    v_mfma_f32_16x16x32_bf16 v[40:43], v[96:99], v[12:15], 0
    ds_read_b64_tr_b16 v[116:117], v3 offset:14496
    ds_read_b64_tr_b16 v[118:119], v3 offset:18080
    ds_read_b128 v[120:123], v4 offset:50176
    ds_read_b32 v10, v10 offset:0
    v_mul_f32 v146, v146, v144
    v_mul_f32 v147, v147, v144
    v_mul_f32 v148, v148, v154
    v_mul_f32 v149, v149, v154
    v_mul_f32 v150, v150, v154
    v_mul_f32 v151, v151, v154
    v_cvt_pk_bf16_f32 v16, v142, v143
    v_cvt_pk_bf16_f32 v17, v146, v147
    v_cvt_pk_bf16_f32 v18, v148, v149
    v_cvt_pk_bf16_f32 v19, v150, v151
    v_rcp_f32 v160, v160
    s_nop 0
    v_mfma_f32_16x16x32_bf16 v[24:27], v[52:55], v[16:19], v[24:27]
    v_mul_f32 v152, v152, v154
    v_mul_f32 v153, v153, v154
    v_mfma_f32_16x16x32_bf16 v[28:31], v[64:67], v[16:19], v[28:31]
    v_mul_f32 v156, v156, v160
    v_mul_f32 v157, v157, v160
    v_mfma_f32_16x16x32_bf16 v[32:35], v[76:79], v[16:19], v[32:35]
    v_mul_f32 v158, v158, v160
    v_mul_f32 v159, v159, v160
    v_mfma_f32_16x16x32_bf16 v[36:39], v[88:91], v[16:19], v[36:39]
    v_mul_f32 v162, v162, v160
    v_mul_f32 v163, v163, v160
    s_waitcnt lgkmcnt(10)
    v_mfma_f32_16x16x32_bf16 v[40:43], v[100:103], v[16:19], v[40:43]
    v_cvt_pk_bf16_f32 v20, v152, v153
    v_cvt_pk_bf16_f32 v21, v156, v157
    s_waitcnt lgkmcnt(8)
    v_mfma_f32_16x16x32_bf16 v[44:47], v[108:111], v[12:15], 0
    v_cvt_pk_bf16_f32 v22, v158, v159
    v_cvt_pk_bf16_f32 v23, v162, v163
    s_waitcnt lgkmcnt(4)
    v_mfma_f32_16x16x32_bf16 v[44:47], v[112:115], v[16:19], v[44:47]
    v_mfma_f32_16x16x32_bf16 v[24:27], v[56:59], v[20:23], v[24:27]
    v_mfma_f32_16x16x32_bf16 v[28:31], v[68:71], v[20:23], v[28:31]
    v_mfma_f32_16x16x32_bf16 v[32:35], v[80:83], v[20:23], v[32:35]
    s_nop 5
    v_fma_f32 v11, v24, v24, s37
    v_mfma_f32_16x16x32_bf16 v[36:39], v[92:95], v[20:23], v[36:39]
    v_fmac_f32 v11, v25, v25
    v_fmac_f32 v11, v26, v26
    v_mfma_f32_16x16x32_bf16 v[40:43], v[104:107], v[20:23], v[40:43]
    v_fmac_f32 v11, v27, v27
    v_fmac_f32 v11, v28, v28
    s_waitcnt lgkmcnt(2)
    v_mfma_f32_16x16x32_bf16 v[44:47], v[116:119], v[20:23], v[44:47]
    v_fmac_f32 v11, v29, v29
    v_fmac_f32 v11, v30, v30
    v_fmac_f32 v11, v31, v31
    v_fmac_f32 v11, v32, v32
    v_fmac_f32 v11, v33, v33
    v_fmac_f32 v11, v34, v34
    v_fmac_f32 v11, v35, v35
    v_fmac_f32 v11, v36, v36
    v_fmac_f32 v11, v37, v37
    v_fmac_f32 v11, v38, v38
    v_fmac_f32 v11, v39, v39
    v_fmac_f32 v11, v40, v40
    v_fmac_f32 v11, v41, v41
    v_fmac_f32 v11, v42, v42
    v_fmac_f32 v11, v43, v43
    v_fmac_f32 v11, v44, v44
    v_fmac_f32 v11, v45, v45
    v_fmac_f32 v11, v46, v46
    v_fmac_f32 v11, v47, v47
    v_cvt_pk_bf16_f32 v124, v11, v11
    s_waitcnt lgkmcnt(1)
    s_nop 0
    v_mfma_f32_16x16x32_bf16 v[128:131], v[120:123], v[124:127], 0
    s_nop 7
    v_rsq_f32 v128, v128
    s_nop 0
    v_mul_f32 v128, 0x411cc471, v128
    v_mul_f32 v24, v24, v128
    v_mul_f32 v25, v25, v128
    v_mul_f32 v26, v26, v128
    v_mul_f32 v27, v27, v128
    v_mul_f32 v32, v32, v128
    v_mul_f32 v33, v33, v128
    v_cvt_pk_bf16_f32 v24, v24, v25
    v_mul_f32 v28, v28, v128
    v_mul_f32 v29, v29, v128
    v_mul_f32 v30, v30, v128
    v_mul_f32 v31, v31, v128
    v_mul_f32 v34, v34, v128
    v_mul_f32 v35, v35, v128
    v_mul_f32 v40, v40, v128
    v_mul_f32 v41, v41, v128
    v_cvt_pk_bf16_f32 v25, v26, v27
    v_cvt_pk_bf16_f32 v32, v32, v33
    v_mul_f32 v36, v36, v128
    v_mul_f32 v37, v37, v128
    v_mul_f32 v38, v38, v128
    v_mul_f32 v39, v39, v128
    v_mul_f32 v42, v42, v128
    v_mul_f32 v43, v43, v128
    v_cvt_pk_bf16_f32 v26, v28, v29
    v_cvt_pk_bf16_f32 v27, v30, v31
    v_cvt_pk_bf16_f32 v33, v34, v35
    v_cvt_pk_bf16_f32 v40, v40, v41
    v_mul_f32 v44, v44, v128
    v_mul_f32 v45, v45, v128
    v_mul_f32 v46, v46, v128
    v_mul_f32 v47, v47, v128
    s_waitcnt lgkmcnt(0)
    buffer_store_dwordx4 v[24:27], v10, s[8:11], 0 offen offset:0 sc1
    v_cvt_pk_bf16_f32 v34, v36, v37
    v_cvt_pk_bf16_f32 v35, v38, v39
    v_cvt_pk_bf16_f32 v41, v42, v43
    buffer_store_dwordx4 v[32:35], v10, s[8:11], 0 offen offset:64 sc1
    v_cvt_pk_bf16_f32 v42, v44, v45
    v_cvt_pk_bf16_f32 v43, v46, v47
    buffer_store_dwordx4 v[40:43], v10, s[8:11], 0 offen offset:128 sc1
    s_endpgm
L_redo:
    s_waitcnt vmcnt(0) lgkmcnt(0)
    s_nop 15
    buffer_load_dwordx4 v[8:11], v0, s[4:7], 0 offen offset:0
    buffer_load_dwordx4 v[12:15], v0, s[4:7], 0 offen offset:64
    buffer_load_dwordx4 v[16:19], v0, s[4:7], 0 offen offset:128
    buffer_load_dwordx4 v[20:23], v1, s[4:7], 0 offen offset:0
    buffer_load_dwordx4 v[24:27], v1, s[4:7], 0 offen offset:64
    buffer_load_dwordx4 v[28:31], v1, s[4:7], 0 offen offset:128
    buffer_load_dwordx4 v[32:35], v2, s[4:7], 0 offen offset:0
    buffer_load_dwordx4 v[36:39], v2, s[4:7], 0 offen offset:64
    buffer_load_dwordx4 v[40:43], v2, s[4:7], 0 offen offset:128
L_slow:
    ds_read_b64_tr_b16 v[144:145], v3 offset:0
    ds_read_b64_tr_b16 v[146:147], v3 offset:9728
    ds_read_b64_tr_b16 v[148:149], v3 offset:19456
    ds_read_b64_tr_b16 v[150:151], v3 offset:29184
    ds_read_b64_tr_b16 v[152:153], v3 offset:38912
    ds_read_b64_tr_b16 v[154:155], v3 offset:48640
    ds_read_b64_tr_b16 v[156:157], v3 offset:32
    ds_read_b64_tr_b16 v[158:159], v3 offset:9760
    ds_read_b128 v[140:143], v4 offset:51200
    ds_read_b64_tr_b16 v[166:167], v3 offset:29568
    ds_read_b128 v[84:87], v4 offset:52224
    ds_read_b128 v[88:91], v4 offset:52224
    v_bfe_u32 v66, v4, 4, 6
    v_min_u32 v66, 48, v66
    v_lshl_add_u32 v66, v66, 1, s44
    buffer_load_ushort v53, v66, s[20:23], s57 offen offset:608
    v_bfe_u32 v65, v4, 8, 2
    s_setprio 3
    ds_read_b128 v[92:95], v4 offset:52224
    s_waitcnt vmcnt(9) lgkmcnt(11)
    v_mfma_f32_16x16x32_bf16 v[104:107], v[144:147], v[8:11], 0
    ds_read_b128 v[96:99], v4 offset:52224
    ds_read_b128 v[100:103], v4 offset:52224
    s_waitcnt vmcnt(6)
    v_mfma_f32_16x16x32_bf16 v[116:119], v[144:147], v[20:23], 0
    s_waitcnt vmcnt(3)
    v_mfma_f32_16x16x32_bf16 v[128:131], v[144:147], v[32:35], 0
    ds_read_b64_tr_b16 v[144:145], v3 offset:19488
    ds_read_b64_tr_b16 v[146:147], v3 offset:29216
    s_waitcnt lgkmcnt(13)
    v_mfma_f32_16x16x32_bf16 v[104:107], v[148:151], v[12:15], v[104:107]
    v_mfma_f32_16x16x32_bf16 v[116:119], v[148:151], v[24:27], v[116:119]
    s_waitcnt vmcnt(2)
    v_mfma_f32_16x16x32_bf16 v[128:131], v[148:151], v[36:39], v[128:131]
    ds_read_b64_tr_b16 v[148:149], v3 offset:38944
    ds_read_b64_tr_b16 v[150:151], v3 offset:48672
    s_waitcnt lgkmcnt(13)
    v_mfma_f32_16x16x32_bf16 v[104:107], v[152:155], v[16:19], v[104:107]
    v_mfma_f32_16x16x32_bf16 v[116:119], v[152:155], v[28:31], v[116:119]
    s_waitcnt vmcnt(1)
    v_mfma_f32_16x16x32_bf16 v[128:131], v[152:155], v[40:43], v[128:131]
    ds_read_b64_tr_b16 v[152:153], v3 offset:64
    ds_read_b64_tr_b16 v[154:155], v3 offset:9792
    s_waitcnt lgkmcnt(13)
    v_mfma_f32_16x16x32_bf16 v[108:111], v[156:159], v[8:11], 0
    s_nop 0
    v_fma_f32 v160, v104, v104, s36
    v_fma_f32 v162, v116, v116, s36
    v_mfma_f32_16x16x32_bf16 v[120:123], v[156:159], v[20:23], 0
    v_fmac_f32 v160, v105, v105
    v_fmac_f32 v162, v117, v117
    v_mfma_f32_16x16x32_bf16 v[132:135], v[156:159], v[32:35], 0
    ds_read_b64_tr_b16 v[156:157], v3 offset:19520
    ds_read_b64_tr_b16 v[158:159], v3 offset:29248
    s_waitcnt lgkmcnt(6)
    v_mfma_f32_16x16x32_bf16 v[108:111], v[144:147], v[12:15], v[108:111]
    v_fmac_f32 v160, v106, v106
    v_fmac_f32 v162, v118, v118
    v_mfma_f32_16x16x32_bf16 v[120:123], v[144:147], v[24:27], v[120:123]
    v_fmac_f32 v160, v107, v107
    v_fmac_f32 v162, v119, v119
    v_mfma_f32_16x16x32_bf16 v[132:135], v[144:147], v[36:39], v[132:135]
    ds_read_b64_tr_b16 v[144:145], v3 offset:38976
    ds_read_b64_tr_b16 v[146:147], v3 offset:48704
    s_waitcnt lgkmcnt(6)
    v_mfma_f32_16x16x32_bf16 v[108:111], v[148:151], v[16:19], v[108:111]
    v_fma_f32 v164, v128, v128, s36
    v_fmac_f32 v164, v129, v129
    v_mfma_f32_16x16x32_bf16 v[120:123], v[148:151], v[28:31], v[120:123]
    v_fmac_f32 v164, v130, v130
    v_fmac_f32 v164, v131, v131
    v_mfma_f32_16x16x32_bf16 v[132:135], v[148:151], v[40:43], v[132:135]
    s_nop 1
    v_fma_f32 v161, v110, v110, s36
    s_waitcnt lgkmcnt(4)
    v_mfma_f32_16x16x32_bf16 v[112:115], v[152:155], v[8:11], 0
    v_fmac_f32 v161, v111, v111
    v_fma_f32 v163, v122, v122, s36
    v_mfma_f32_16x16x32_bf16 v[124:127], v[152:155], v[20:23], 0
    v_fmac_f32 v163, v123, v123
    v_fmac_f32 v160, v108, v108
    v_mfma_f32_16x16x32_bf16 v[136:139], v[152:155], v[32:35], 0
    v_fmac_f32 v162, v120, v120
    v_fmac_f32 v160, v109, v109
    s_waitcnt lgkmcnt(2)
    v_mfma_f32_16x16x32_bf16 v[112:115], v[156:159], v[12:15], v[112:115]
    v_fmac_f32 v162, v121, v121
    v_fma_f32 v165, v134, v134, s36
    v_mfma_f32_16x16x32_bf16 v[124:127], v[156:159], v[24:27], v[124:127]
    v_fmac_f32 v165, v135, v135
    v_fmac_f32 v164, v132, v132
    v_mfma_f32_16x16x32_bf16 v[136:139], v[156:159], v[36:39], v[136:139]
    ds_read_b128 v[156:159], v4 offset:50176
    v_fmac_f32 v164, v133, v133
    s_waitcnt lgkmcnt(1)
    v_mfma_f32_16x16x32_bf16 v[112:115], v[144:147], v[16:19], v[112:115]
    v_mfma_f32_16x16x32_bf16 v[124:127], v[144:147], v[28:31], v[124:127]
    v_mfma_f32_16x16x32_bf16 v[136:139], v[144:147], v[40:43], v[136:139]
    ds_read_b32 v147, v5 offset:896
    s_nop 4
    v_fmac_f32 v161, v112, v112
    v_fmac_f32 v161, v113, v113
    v_fmac_f32 v161, v114, v114
    v_fmac_f32 v161, v115, v115
    v_fmac_f32 v163, v124, v124
    v_fmac_f32 v163, v125, v125
    v_fmac_f32 v163, v126, v126
    v_fmac_f32 v163, v127, v127
    v_cvt_pk_bf16_f32 v144, v160, v161
    ds_read_b64_tr_b16 v[160:161], v3 offset:384
    v_cvt_pk_bf16_f32 v145, v162, v163
    ds_read_b64_tr_b16 v[162:163], v3 offset:10112
    v_fmac_f32 v165, v136, v136
    v_fmac_f32 v165, v137, v137
    v_fmac_f32 v165, v138, v138
    v_fmac_f32 v165, v139, v139
    v_cvt_pk_bf16_f32 v146, v164, v165
    ds_read_b64_tr_b16 v[164:165], v3 offset:19840
    s_waitcnt lgkmcnt(3)
    v_mfma_f32_16x16x32_bf16 v[148:151], v[156:159], v[144:147], 0
    ds_read_b64_tr_b16 v[156:157], v3 offset:39296
    ds_read_b64_tr_b16 v[158:159], v3 offset:49024
    v_mfma_f32_16x16x32_bf16 v[152:155], v[140:143], v[144:147], 0
    s_nop 4
    v_rsq_f32 v148, v148
    s_waitcnt lgkmcnt(3)
    v_mfma_f32_16x16x32_bf16 v[144:147], v[8:11], v[160:163], 0
    v_rsq_f32 v150, v150
    v_rsq_f32 v152, v152
    s_waitcnt lgkmcnt(2)
    v_mfma_f32_16x16x32_bf16 v[144:147], v[12:15], v[164:167], v[144:147]
    v_rsq_f32 v149, v149
    v_rsq_f32 v151, v151
    v_rsq_f32 v153, v153
    v_mul_f32 v148, s32, v148
    v_mul_f32 v150, s32, v150
    v_mul_f32 v152, s32, v152
    v_mul_f32 v104, v104, v148
    v_mul_f32 v105, v105, v148
    v_mul_f32 v106, v106, v148
    v_mul_f32 v107, v107, v148
    v_mul_f32 v108, v108, v148
    v_mul_f32 v109, v109, v148
    v_mul_f32 v110, v110, v149
    v_mul_f32 v111, v111, v149
    s_waitcnt lgkmcnt(0)
    v_mfma_f32_16x16x32_bf16 v[144:147], v[16:19], v[156:159], v[144:147]
    v_mul_f32 v112, v112, v149
    v_mul_f32 v113, v113, v149
    v_mul_f32 v114, v114, v149
    v_mul_f32 v115, v115, v149
    v_mul_f32 v116, v116, v150
    v_mul_f32 v117, v117, v150
    v_mul_f32 v118, v118, v150
    v_mul_f32 v119, v119, v150
    v_mul_f32 v120, v120, v150
    v_mul_f32 v121, v121, v150
    v_mul_f32 v122, v122, v151
    v_mul_f32 v123, v123, v151
    v_mul_f32 v124, v124, v151
    v_mul_f32 v125, v125, v151
    v_mul_f32 v126, v126, v151
    v_mul_f32 v127, v127, v151
    v_mfma_f32_16x16x32_bf16 v[148:151], v[20:23], v[160:163], 0
    v_mul_f32 v128, v128, v152
    v_mul_f32 v129, v129, v152
    v_mfma_f32_16x16x32_bf16 v[148:151], v[24:27], v[164:167], v[148:151]
    v_mul_f32 v130, v130, v152
    v_mul_f32 v131, v131, v152
    v_mfma_f32_16x16x32_bf16 v[148:151], v[28:31], v[156:159], v[148:151]
    v_mul_f32 v132, v132, v152
    v_mul_f32 v133, v133, v152
    v_mul_f32 v134, v134, v153
    v_mul_f32 v135, v135, v153
    v_mul_f32 v136, v136, v153
    v_mul_f32 v137, v137, v153
    v_mul_f32 v138, v138, v153
    v_mul_f32 v139, v139, v153
    v_mfma_f32_16x16x32_bf16 v[152:155], v[32:35], v[160:163], 0
    ds_read_b64_tr_b16 v[160:161], v3 offset:416
    ds_read_b64_tr_b16 v[162:163], v3 offset:10144
    v_mfma_f32_16x16x32_bf16 v[152:155], v[36:39], v[164:167], v[152:155]
    ds_read_b64_tr_b16 v[164:165], v3 offset:19872
    ds_read_b64_tr_b16 v[166:167], v3 offset:29600
    v_mfma_f32_16x16x32_bf16 v[152:155], v[40:43], v[156:159], v[152:155]
    ds_read_b64_tr_b16 v[156:157], v3 offset:39328
    ds_read_b64_tr_b16 v[158:159], v3 offset:49056
L_poll0s:
    v_mov_b32 v140, 136224
    ds_read_b32 v140, v140 offset:0
    s_waitcnt lgkmcnt(0)
    v_readfirstlane_b32 s58, v140
    s_sub_u32 s65, s65, 1
    s_cbranch_scc1 L_poll0sx
    s_cmp_lt_u32 s58, 8
    s_cbranch_scc1 L_poll0s
L_poll0sx:
    ds_read_b128 v[140:143], v5 offset:0
    ds_read_u16 v86, v6 offset:512
    ds_read_u16 v94, v6 offset:544
    ds_read_u16 v102, v6 offset:576
    v_cvt_pk_bf16_f32 v104, v104, v105
    v_cvt_pk_bf16_f32 v116, v116, v117
    v_cvt_pk_bf16_f32 v105, v106, v107
    ds_read_b32 v107, v5 offset:896
    v_cvt_pk_bf16_f32 v117, v118, v119
    ds_read_b32 v119, v5 offset:896
    v_cvt_pk_bf16_f32 v80, v144, v145
    v_cvt_pk_bf16_f32 v81, v146, v147
    v_cvt_pk_bf16_f32 v82, v148, v149
    v_cvt_pk_bf16_f32 v83, v150, v151
    v_cvt_pk_bf16_f32 v84, v152, v153
    v_cvt_pk_bf16_f32 v85, v154, v155
    v_cvt_pk_bf16_f32 v106, v108, v109
    v_cvt_pk_bf16_f32 v118, v120, v121
    v_cvt_pk_bf16_f32 v108, v110, v111
    v_mfma_f32_16x16x32_bf16 v[144:147], v[8:11], v[160:163], 0
    ds_read_b32 v111, v5 offset:896
    v_cvt_pk_bf16_f32 v120, v122, v123
    v_mfma_f32_16x16x32_bf16 v[148:151], v[20:23], v[160:163], 0
    ds_read_b32 v123, v5 offset:896
    v_cvt_pk_bf16_f32 v128, v128, v129
    v_mfma_f32_16x16x32_bf16 v[152:155], v[32:35], v[160:163], 0
    ds_read_b128 v[160:163], v5 offset:64
    v_cvt_pk_bf16_f32 v129, v130, v131
    v_mfma_f32_16x16x32_bf16 v[144:147], v[12:15], v[164:167], v[144:147]
    ds_read_b32 v131, v5 offset:896
    v_cvt_pk_bf16_f32 v130, v132, v133
    v_mfma_f32_16x16x32_bf16 v[148:151], v[24:27], v[164:167], v[148:151]
    v_cvt_pk_bf16_f32 v132, v134, v135
    ds_read_b32 v135, v5 offset:896
    v_mfma_f32_16x16x32_bf16 v[152:155], v[36:39], v[164:167], v[152:155]
    ds_read_b32 v164, v4 offset:49152
    v_cvt_pk_bf16_f32 v109, v112, v113
    v_mfma_f32_16x16x32_bf16 v[144:147], v[16:19], v[156:159], v[144:147]
    v_cvt_pk_bf16_f32 v110, v114, v115
    ds_read_b32 v115, v5 offset:896
    v_mfma_f32_16x16x32_bf16 v[148:151], v[28:31], v[156:159], v[148:151]
    v_cvt_pk_bf16_f32 v121, v124, v125
    v_cvt_pk_bf16_f32 v122, v126, v127
    v_mfma_f32_16x16x32_bf16 v[152:155], v[40:43], v[156:159], v[152:155]
    v_cvt_pk_bf16_f32 v133, v136, v137
    v_cvt_pk_bf16_f32 v134, v138, v139
    s_mov_b64 exec, s[38:39]
    v_cvt_pk_bf16_f32 v88, v144, v145
    v_cvt_pk_bf16_f32 v89, v146, v147
    v_cvt_pk_bf16_f32 v90, v148, v149
    v_cvt_pk_bf16_f32 v91, v150, v151
    s_nop 0
    v_cvt_pk_bf16_f32 v92, v152, v153
    v_cvt_pk_bf16_f32 v93, v154, v155
    s_mov_b64 exec, -1
    s_waitcnt lgkmcnt(4)
    v_mfma_f32_16x16x32_bf16 v[156:159], v[160:163], v[140:143], 0
    s_mov_b64 exec, s[40:41]
    v_cvt_pk_bf16_f32 v96, v144, v145
    v_cvt_pk_bf16_f32 v97, v146, v147
    v_cvt_pk_bf16_f32 v98, v148, v149
    v_cvt_pk_bf16_f32 v99, v150, v151
    v_cvt_pk_bf16_f32 v100, v152, v153
    v_cvt_pk_bf16_f32 v101, v154, v155
    s_mov_b64 exec, -1
    v_mfma_f32_16x16x32_bf16 v[144:147], v[160:163], v[108:111], 0
    v_mfma_f32_16x16x32_bf16 v[148:151], v[160:163], v[120:123], 0
    s_waitcnt lgkmcnt(2)
    v_mfma_f32_16x16x32_bf16 v[152:155], v[160:163], v[132:135], 0
    s_nop 5
    v_mov_b32_dpp v144, v148 quad_perm:[0,1,2,3] row_mask:2 bank_mask:0xf
    ds_read_b128 v[148:151], v4 offset:1024
    s_nop 0
    v_mov_b32_dpp v144, v152 quad_perm:[0,1,2,3] row_mask:4 bank_mask:0xf
    ds_read_b128 v[152:155], v4 offset:2048
    s_nop 0
    v_mov_b32_dpp v144, v156 quad_perm:[0,1,2,3] row_mask:8 bank_mask:0xf
    ds_read_b32 v156, v4 offset:3072
    s_waitcnt lgkmcnt(4)
    v_add_f32 v144, v144, v164
    s_waitcnt vmcnt(0)
    v_lshlrev_b32 v66, 16, v53
    v_fmamk_f32 v144, v66, 0x3fb8aa3b, v144
    v_bfe_u32 v66, v4, 4, 4
    v_mul_u32_u24 v66, 0x62, v66
    v_add_u32 v66, s44, v66
    buffer_load_ushort v53, v66, s[20:23], 0 offen offset:96
    v_lshl_add_u32 v65, v65, 3, v66
    buffer_load_dwordx2 v[124:125], v65, s[20:23], 0 offen offset:0
    buffer_load_dwordx2 v[126:127], v65, s[20:23], 0 offen offset:32
    buffer_load_dwordx2 v[54:55], v65, s[20:23], 0 offen offset:64
    v_mov_b32 v67, v144
    s_waitcnt lgkmcnt(2)
    v_mfma_f32_16x16x32_bf16 v[148:151], v[120:123], v[104:107], v[148:151]
    v_max_f32_dpp v67, v67, v67 row_ror:8 row_mask:0xf bank_mask:0xf
    v_bfe_u32 v65, v4, 8, 2
    s_waitcnt lgkmcnt(1)
    v_mfma_f32_16x16x32_bf16 v[152:155], v[132:135], v[104:107], v[152:155]
    v_max_f32_dpp v67, v67, v67 row_ror:4 row_mask:0xf bank_mask:0xf
    s_waitcnt lgkmcnt(0)
    v_mfma_f32_16x16x32_bf16 v[156:159], v[140:143], v[104:107], v[156:159]
    v_max_f32_dpp v67, v67, v67 row_ror:2 row_mask:0xf bank_mask:0xf
    s_nop 1
    v_max_f32_dpp v67, v67, v67 row_ror:1 row_mask:0xf bank_mask:0xf
    v_mov_b32 v77, v67
    s_nop 1
    v_permlane32_swap_b32 v67, v77
    v_max_f32 v67, v67, v77
    v_mov_b32 v77, v67
    s_nop 1
    v_permlane16_swap_b32 v67, v77
    v_max_f32 v67, v67, v77
    v_sub_f32 v144, v144, v67
    v_exp_f32 v144, v144
    s_nop 0
    v_cvt_pk_bf16_f32 v144, v144, v144
    ds_write_b16 v7, v144 offset:0
    ds_read_b128 v[144:147], v4 offset:0
    s_waitcnt lgkmcnt(1)
    ds_read_b128 v[136:139], v5 offset:768
    s_waitcnt lgkmcnt(1)
    v_mfma_f32_16x16x32_bf16 v[144:147], v[108:111], v[104:107], v[144:147]
    s_waitcnt lgkmcnt(0)
    ds_read_b128 v[112:115], v5 offset:832
    v_mfma_f32_16x16x32_bf16 v[160:163], v[80:83], v[136:139], 0
    v_mfma_f32_16x16x32_bf16 v[164:167], v[88:91], v[136:139], 0
    s_waitcnt lgkmcnt(0)
    v_mfma_f32_16x16x32_bf16 v[160:163], v[84:87], v[112:115], v[160:163]
    v_mfma_f32_16x16x32_bf16 v[164:167], v[92:95], v[112:115], v[164:167]
    s_nop 6
    ds_write_b128 v5, v[160:163] offset:1024
    s_waitcnt lgkmcnt(0)
    ds_write_b128 v5, v[164:167] offset:1088
    s_waitcnt vmcnt(2)
    v_lshlrev_b32 v66, 16, v124
    v_fmamk_f32 v144, v66, 0x3fb8aa3b, v144
    v_and_b32 v66, 0xffff0000, v124
    v_fmamk_f32 v145, v66, 0x3fb8aa3b, v145
    v_lshlrev_b32 v66, 16, v125
    v_fmamk_f32 v146, v66, 0x3fb8aa3b, v146
    v_and_b32 v66, 0xffff0000, v125
    v_fmamk_f32 v147, v66, 0x3fb8aa3b, v147
    s_waitcnt vmcnt(1)
    v_lshlrev_b32 v66, 16, v126
    v_fmamk_f32 v148, v66, 0x3fb8aa3b, v148
    v_and_b32 v66, 0xffff0000, v126
    v_fmamk_f32 v149, v66, 0x3fb8aa3b, v149
    v_lshlrev_b32 v66, 16, v127
    v_fmamk_f32 v150, v66, 0x3fb8aa3b, v150
    v_and_b32 v66, 0xffff0000, v127
    v_fmamk_f32 v151, v66, 0x3fb8aa3b, v151
    s_waitcnt vmcnt(0)
    v_lshlrev_b32 v66, 16, v54
    v_fmamk_f32 v152, v66, 0x3fb8aa3b, v152
    v_and_b32 v66, 0xffff0000, v54
    v_fmamk_f32 v153, v66, 0x3fb8aa3b, v153
    v_lshlrev_b32 v66, 16, v55
    v_fmamk_f32 v154, v66, 0x3fb8aa3b, v154
    v_and_b32 v66, 0xffff0000, v55
    v_fmamk_f32 v155, v66, 0x3fb8aa3b, v155
    v_lshlrev_b32 v66, 16, v53
    v_fmamk_f32 v156, v66, 0x3fb8aa3b, v156
    v_bfe_u32 v66, v4, 4, 4
    v_add_u32 v66, 16, v66
    v_mul_u32_u24 v66, 0x62, v66
    v_add_u32 v66, s44, v66
    buffer_load_ushort v53, v66, s[20:23], 0 offen offset:96
    v_lshl_add_u32 v65, v65, 3, v66
    buffer_load_dwordx2 v[124:125], v65, s[20:23], 0 offen offset:0
    buffer_load_dwordx2 v[126:127], v65, s[20:23], 0 offen offset:32
    buffer_load_dwordx2 v[54:55], v65, s[20:23], 0 offen offset:64
    v_max3_f32 v67, v144, v145, v146
    v_max3_f32 v67, v67, v147, v148
    v_max3_f32 v67, v67, v149, v150
    v_max3_f32 v67, v67, v151, v152
    v_max3_f32 v67, v67, v153, v154
    v_max3_f32 v67, v67, v155, v156
    v_mov_b32 v77, v67
    v_bfe_u32 v65, v4, 8, 2
    s_nop 0
    v_permlane32_swap_b32 v67, v77
    v_max_f32 v67, v67, v77
    v_mov_b32 v77, v67
    s_nop 1
    v_permlane16_swap_b32 v67, v77
    v_max_f32 v67, v67, v77
    v_sub_f32 v144, v144, v67
    v_sub_f32 v145, v145, v67
    v_sub_f32 v146, v146, v67
    v_sub_f32 v147, v147, v67
    v_exp_f32 v144, v144
    v_exp_f32 v145, v145
    v_exp_f32 v146, v146
    v_exp_f32 v147, v147
    v_cvt_pk_bf16_f32 v136, v144, v145
    v_cvt_pk_bf16_f32 v137, v146, v147
    ds_read_b128 v[144:147], v4 offset:4096
    v_sub_f32 v148, v148, v67
    v_sub_f32 v149, v149, v67
    v_sub_f32 v150, v150, v67
    v_sub_f32 v151, v151, v67
    v_exp_f32 v148, v148
    v_exp_f32 v149, v149
    v_exp_f32 v150, v150
    v_exp_f32 v151, v151
    v_cvt_pk_bf16_f32 v138, v148, v149
    v_cvt_pk_bf16_f32 v139, v150, v151
    ds_read_b128 v[148:151], v4 offset:5120
    v_sub_f32 v152, v152, v67
    v_mfma_f32_16x16x32_bf16 v[160:163], v[80:83], v[136:139], 0
    v_sub_f32 v153, v153, v67
    v_sub_f32 v154, v154, v67
    v_mfma_f32_16x16x32_bf16 v[164:167], v[88:91], v[136:139], 0
    v_sub_f32 v155, v155, v67
    v_exp_f32 v152, v152
    v_exp_f32 v153, v153
    v_exp_f32 v154, v154
    v_exp_f32 v155, v155
    v_cvt_pk_bf16_f32 v112, v152, v153
    v_cvt_pk_bf16_f32 v113, v154, v155
    ds_read_b128 v[152:155], v4 offset:6144
    s_waitcnt lgkmcnt(2)
    v_mfma_f32_16x16x32_bf16 v[144:147], v[108:111], v[116:119], v[144:147]
    v_sub_f32 v156, v156, v67
    v_exp_f32 v156, v156
    s_nop 0
    v_cvt_pk_bf16_f32 v114, v156, 0
    ds_read_b32 v156, v4 offset:7168
    s_nop 0
    v_mfma_f32_16x16x32_bf16 v[160:163], v[84:87], v[112:115], v[160:163]
    v_mfma_f32_16x16x32_bf16 v[164:167], v[92:95], v[112:115], v[164:167]
    s_waitcnt lgkmcnt(2)
    v_mfma_f32_16x16x32_bf16 v[148:151], v[120:123], v[116:119], v[148:151]
    s_nop 5
    v_rcp_f32 v166, v166
    s_nop 0
    v_mul_f32 v160, v160, v166
    v_mul_f32 v161, v161, v166
    v_mul_f32 v162, v162, v166
    v_mul_f32 v163, v163, v166
    v_mul_f32 v164, v164, v166
    v_mul_f32 v165, v165, v166
    v_cvt_pk_bf16_f32 v44, v160, v161
    s_waitcnt lgkmcnt(1)
    v_mfma_f32_16x16x32_bf16 v[152:155], v[132:135], v[116:119], v[152:155]
    v_cvt_pk_bf16_f32 v45, v162, v163
    v_cvt_pk_bf16_f32 v46, v164, v165
    s_waitcnt lgkmcnt(0)
    v_mfma_f32_16x16x32_bf16 v[156:159], v[140:143], v[116:119], v[156:159]
    s_waitcnt vmcnt(2)
    v_lshlrev_b32 v66, 16, v124
    v_fmamk_f32 v144, v66, 0x3fb8aa3b, v144
    v_and_b32 v66, 0xffff0000, v124
    v_fmamk_f32 v145, v66, 0x3fb8aa3b, v145
    v_lshlrev_b32 v66, 16, v125
    v_fmamk_f32 v146, v66, 0x3fb8aa3b, v146
    v_and_b32 v66, 0xffff0000, v125
    v_fmamk_f32 v147, v66, 0x3fb8aa3b, v147
    s_waitcnt vmcnt(1)
    v_lshlrev_b32 v66, 16, v126
    v_fmamk_f32 v148, v66, 0x3fb8aa3b, v148
    v_and_b32 v66, 0xffff0000, v126
    v_fmamk_f32 v149, v66, 0x3fb8aa3b, v149
    v_lshlrev_b32 v66, 16, v127
    v_fmamk_f32 v150, v66, 0x3fb8aa3b, v150
    v_and_b32 v66, 0xffff0000, v127
    v_fmamk_f32 v151, v66, 0x3fb8aa3b, v151
    s_waitcnt vmcnt(0)
    v_lshlrev_b32 v66, 16, v54
    v_fmamk_f32 v152, v66, 0x3fb8aa3b, v152
    v_and_b32 v66, 0xffff0000, v54
    v_fmamk_f32 v153, v66, 0x3fb8aa3b, v153
    v_lshlrev_b32 v66, 16, v55
    v_fmamk_f32 v154, v66, 0x3fb8aa3b, v154
    v_and_b32 v66, 0xffff0000, v55
    v_fmamk_f32 v155, v66, 0x3fb8aa3b, v155
    v_lshlrev_b32 v66, 16, v53
    v_fmamk_f32 v156, v66, 0x3fb8aa3b, v156
    v_bfe_u32 v66, v4, 4, 4
    v_add_u32 v66, 32, v66
    v_mul_u32_u24 v66, 0x62, v66
    v_add_u32 v66, s44, v66
    buffer_load_ushort v53, v66, s[20:23], 0 offen offset:96
    v_lshl_add_u32 v65, v65, 3, v66
    buffer_load_dwordx2 v[124:125], v65, s[20:23], 0 offen offset:0
    buffer_load_dwordx2 v[126:127], v65, s[20:23], 0 offen offset:32
    buffer_load_dwordx2 v[54:55], v65, s[20:23], 0 offen offset:64
    v_max3_f32 v67, v144, v145, v146
    v_max3_f32 v67, v67, v147, v148
    v_max3_f32 v67, v67, v149, v150
    v_max3_f32 v67, v67, v151, v152
    v_max3_f32 v67, v67, v153, v154
    v_max3_f32 v67, v67, v155, v156
    v_mov_b32 v77, v67
    v_bfe_u32 v65, v4, 8, 2
    s_nop 0
    v_permlane32_swap_b32 v67, v77
    v_max_f32 v67, v67, v77
    v_mov_b32 v77, v67
    s_nop 1
    v_permlane16_swap_b32 v67, v77
    v_max_f32 v67, v67, v77
    v_sub_f32 v144, v144, v67
    v_sub_f32 v145, v145, v67
    v_sub_f32 v146, v146, v67
    v_sub_f32 v147, v147, v67
    v_exp_f32 v144, v144
    v_exp_f32 v145, v145
    v_exp_f32 v146, v146
    v_exp_f32 v147, v147
    v_cvt_pk_bf16_f32 v136, v144, v145
    v_cvt_pk_bf16_f32 v137, v146, v147
    ds_read_b128 v[144:147], v4 offset:8192
    v_sub_f32 v148, v148, v67
    v_sub_f32 v149, v149, v67
    v_sub_f32 v150, v150, v67
    v_sub_f32 v151, v151, v67
    v_exp_f32 v148, v148
    v_exp_f32 v149, v149
    v_exp_f32 v150, v150
    v_exp_f32 v151, v151
    v_cvt_pk_bf16_f32 v138, v148, v149
    v_cvt_pk_bf16_f32 v139, v150, v151
    ds_read_b128 v[148:151], v4 offset:9216
    v_sub_f32 v152, v152, v67
    v_mfma_f32_16x16x32_bf16 v[160:163], v[80:83], v[136:139], 0
    v_sub_f32 v153, v153, v67
    v_sub_f32 v154, v154, v67
    v_mfma_f32_16x16x32_bf16 v[164:167], v[88:91], v[136:139], 0
    v_sub_f32 v155, v155, v67
    v_exp_f32 v152, v152
    v_exp_f32 v153, v153
    v_exp_f32 v154, v154
    v_exp_f32 v155, v155
    v_cvt_pk_bf16_f32 v112, v152, v153
    v_cvt_pk_bf16_f32 v113, v154, v155
    ds_read_b128 v[152:155], v4 offset:10240
    s_waitcnt lgkmcnt(2)
    v_mfma_f32_16x16x32_bf16 v[144:147], v[108:111], v[128:131], v[144:147]
    v_sub_f32 v156, v156, v67
    v_exp_f32 v156, v156
    s_nop 0
    v_cvt_pk_bf16_f32 v114, v156, 0
    ds_read_b32 v156, v4 offset:11264
    s_nop 0
    v_mfma_f32_16x16x32_bf16 v[160:163], v[84:87], v[112:115], v[160:163]
    v_mfma_f32_16x16x32_bf16 v[164:167], v[92:95], v[112:115], v[164:167]
    s_waitcnt lgkmcnt(2)
    v_mfma_f32_16x16x32_bf16 v[148:151], v[120:123], v[128:131], v[148:151]
    s_nop 5
    v_rcp_f32 v166, v166
    s_nop 0
    v_mul_f32 v160, v160, v166
    v_mul_f32 v161, v161, v166
    v_mul_f32 v162, v162, v166
    v_mul_f32 v163, v163, v166
    v_mul_f32 v164, v164, v166
    v_mul_f32 v165, v165, v166
    v_cvt_pk_bf16_f32 v56, v160, v161
    s_waitcnt lgkmcnt(1)
    v_mfma_f32_16x16x32_bf16 v[152:155], v[132:135], v[128:131], v[152:155]
    v_cvt_pk_bf16_f32 v57, v162, v163
    v_cvt_pk_bf16_f32 v58, v164, v165
    s_waitcnt lgkmcnt(0)
    v_mfma_f32_16x16x32_bf16 v[156:159], v[140:143], v[128:131], v[156:159]
    ds_read_b128 v[140:143], v4 offset:51200
    s_nop 6
    ds_read_b64_tr_b16 v[158:159], v3 offset:9856
    s_waitcnt vmcnt(2)
    v_lshlrev_b32 v66, 16, v124
    v_fmamk_f32 v144, v66, 0x3fb8aa3b, v144
    v_and_b32 v66, 0xffff0000, v124
    v_fmamk_f32 v145, v66, 0x3fb8aa3b, v145
    v_lshlrev_b32 v66, 16, v125
    v_fmamk_f32 v146, v66, 0x3fb8aa3b, v146
    v_and_b32 v66, 0xffff0000, v125
    v_fmamk_f32 v147, v66, 0x3fb8aa3b, v147
    s_waitcnt vmcnt(1)
    v_lshlrev_b32 v66, 16, v126
    v_fmamk_f32 v148, v66, 0x3fb8aa3b, v148
    v_and_b32 v66, 0xffff0000, v126
    v_fmamk_f32 v149, v66, 0x3fb8aa3b, v149
    v_lshlrev_b32 v66, 16, v127
    v_fmamk_f32 v150, v66, 0x3fb8aa3b, v150
    v_and_b32 v66, 0xffff0000, v127
    v_fmamk_f32 v151, v66, 0x3fb8aa3b, v151
    s_waitcnt vmcnt(0)
    v_lshlrev_b32 v66, 16, v54
    v_fmamk_f32 v152, v66, 0x3fb8aa3b, v152
    v_and_b32 v66, 0xffff0000, v54
    v_fmamk_f32 v153, v66, 0x3fb8aa3b, v153
    v_lshlrev_b32 v66, 16, v55
    v_fmamk_f32 v154, v66, 0x3fb8aa3b, v154
    v_and_b32 v66, 0xffff0000, v55
    v_fmamk_f32 v155, v66, 0x3fb8aa3b, v155
    v_lshlrev_b32 v66, 16, v53
    v_fmamk_f32 v156, v66, 0x3fb8aa3b, v156
    v_bfe_u32 v66, v4, 4, 6
    v_min_u32 v66, 48, v66
    v_lshl_add_u32 v66, v66, 1, s44
    buffer_load_ushort v53, v66, s[20:23], s57 offen offset:608
    v_max3_f32 v67, v144, v145, v146
    v_max3_f32 v67, v67, v147, v148
    v_max3_f32 v67, v67, v149, v150
    v_max3_f32 v67, v67, v151, v152
    v_max3_f32 v67, v67, v153, v154
    v_max3_f32 v67, v67, v155, v156
    v_mov_b32 v77, v67
    s_nop 1
    v_permlane32_swap_b32 v67, v77
    v_max_f32 v67, v67, v77
    v_mov_b32 v77, v67
    s_nop 1
    v_permlane16_swap_b32 v67, v77
    v_max_f32 v67, v67, v77
    v_sub_f32 v144, v144, v67
    v_sub_f32 v145, v145, v67
    v_sub_f32 v146, v146, v67
    v_sub_f32 v147, v147, v67
    v_exp_f32 v144, v144
    v_exp_f32 v145, v145
    v_exp_f32 v146, v146
    v_exp_f32 v147, v147
    v_cvt_pk_bf16_f32 v136, v144, v145
    ds_read_b64_tr_b16 v[144:145], v3 offset:96
    v_cvt_pk_bf16_f32 v137, v146, v147
    ds_read_b64_tr_b16 v[146:147], v3 offset:9824
    v_sub_f32 v148, v148, v67
    v_sub_f32 v149, v149, v67
    v_sub_f32 v150, v150, v67
    v_sub_f32 v151, v151, v67
    v_exp_f32 v148, v148
    v_exp_f32 v149, v149
    v_exp_f32 v150, v150
    v_exp_f32 v151, v151
    v_sub_f32 v152, v152, v67
    v_sub_f32 v153, v153, v67
    v_sub_f32 v154, v154, v67
    v_sub_f32 v155, v155, v67
    v_cvt_pk_bf16_f32 v138, v148, v149
    ds_read_b64_tr_b16 v[148:149], v3 offset:19552
    v_cvt_pk_bf16_f32 v139, v150, v151
    ds_read_b64_tr_b16 v[150:151], v3 offset:29280
    v_exp_f32 v152, v152
    v_mfma_f32_16x16x32_bf16 v[160:163], v[80:83], v[136:139], 0
    v_exp_f32 v153, v153
    v_mfma_f32_16x16x32_bf16 v[164:167], v[88:91], v[136:139], 0
    v_exp_f32 v154, v154
    v_exp_f32 v155, v155
    v_sub_f32 v156, v156, v67
    v_cvt_pk_bf16_f32 v112, v152, v153
    s_waitcnt lgkmcnt(2)
    v_mfma_f32_16x16x32_bf16 v[104:107], v[144:147], v[8:11], 0
    ds_read_b64_tr_b16 v[152:153], v3 offset:39008
    v_cvt_pk_bf16_f32 v113, v154, v155
    v_mfma_f32_16x16x32_bf16 v[116:119], v[144:147], v[20:23], 0
    ds_read_b64_tr_b16 v[154:155], v3 offset:48736
    v_exp_f32 v156, v156
    v_mfma_f32_16x16x32_bf16 v[128:131], v[144:147], v[32:35], 0
    ds_read_b64_tr_b16 v[144:145], v3 offset:19584
    ds_read_b64_tr_b16 v[146:147], v3 offset:29312
    v_cvt_pk_bf16_f32 v114, v156, 0
    ds_read_b64_tr_b16 v[156:157], v3 offset:128
    s_nop 0
    v_mfma_f32_16x16x32_bf16 v[160:163], v[84:87], v[112:115], v[160:163]
    ds_read_u16 v86, v6 offset:608
    s_waitcnt lgkmcnt(6)
    v_mfma_f32_16x16x32_bf16 v[104:107], v[148:151], v[12:15], v[104:107]
    v_mfma_f32_16x16x32_bf16 v[116:119], v[148:151], v[24:27], v[116:119]
    v_mfma_f32_16x16x32_bf16 v[128:131], v[148:151], v[36:39], v[128:131]
    ds_read_b64_tr_b16 v[148:149], v3 offset:39040
    ds_read_b64_tr_b16 v[150:151], v3 offset:48768
    v_mfma_f32_16x16x32_bf16 v[164:167], v[92:95], v[112:115], v[164:167]
    ds_read_u16 v94, v6 offset:672
    s_waitcnt lgkmcnt(7)
    v_mfma_f32_16x16x32_bf16 v[104:107], v[152:155], v[16:19], v[104:107]
    s_nop 4
    v_rcp_f32 v166, v166
    v_mfma_f32_16x16x32_bf16 v[116:119], v[152:155], v[28:31], v[116:119]
    v_mul_f32 v160, v160, v166
    v_mul_f32 v161, v161, v166
    v_mfma_f32_16x16x32_bf16 v[128:131], v[152:155], v[40:43], v[128:131]
    ds_read_b64_tr_b16 v[152:153], v3 offset:160
    ds_read_b64_tr_b16 v[154:155], v3 offset:9888
    s_waitcnt lgkmcnt(6)
    v_mfma_f32_16x16x32_bf16 v[108:111], v[156:159], v[8:11], 0
    v_mul_f32 v162, v162, v166
    v_mul_f32 v163, v163, v166
    v_mfma_f32_16x16x32_bf16 v[120:123], v[156:159], v[20:23], 0
    v_cvt_pk_bf16_f32 v68, v160, v161
    v_cvt_pk_bf16_f32 v69, v162, v163
    v_mfma_f32_16x16x32_bf16 v[132:135], v[156:159], v[32:35], 0
    ds_read_b64_tr_b16 v[156:157], v3 offset:19616
    ds_read_b64_tr_b16 v[158:159], v3 offset:29344
    v_mfma_f32_16x16x32_bf16 v[108:111], v[144:147], v[12:15], v[108:111]
    v_fma_f32 v160, v104, v104, s36
    v_fma_f32 v162, v116, v116, s36
    v_mfma_f32_16x16x32_bf16 v[120:123], v[144:147], v[24:27], v[120:123]
    v_fmac_f32 v160, v105, v105
    v_fmac_f32 v162, v117, v117
    v_mfma_f32_16x16x32_bf16 v[132:135], v[144:147], v[36:39], v[132:135]
    ds_read_b64_tr_b16 v[144:145], v3 offset:39072
    ds_read_b64_tr_b16 v[146:147], v3 offset:48800
    s_waitcnt lgkmcnt(7)
    v_mfma_f32_16x16x32_bf16 v[108:111], v[148:151], v[16:19], v[108:111]
    v_fmac_f32 v160, v106, v106
    v_fmac_f32 v162, v118, v118
    v_mfma_f32_16x16x32_bf16 v[120:123], v[148:151], v[28:31], v[120:123]
    v_fmac_f32 v160, v107, v107
    v_fmac_f32 v162, v119, v119
    v_mfma_f32_16x16x32_bf16 v[132:135], v[148:151], v[40:43], v[132:135]
    v_mul_f32 v164, v164, v166
    s_nop 0
    v_fma_f32 v161, v110, v110, s36
    s_waitcnt lgkmcnt(4)
    v_mfma_f32_16x16x32_bf16 v[112:115], v[152:155], v[8:11], 0
    v_fmac_f32 v161, v111, v111
    v_fma_f32 v163, v122, v122, s36
    v_mfma_f32_16x16x32_bf16 v[124:127], v[152:155], v[20:23], 0
    v_fmac_f32 v163, v123, v123
    v_fmac_f32 v160, v108, v108
    v_mfma_f32_16x16x32_bf16 v[136:139], v[152:155], v[32:35], 0
    v_fmac_f32 v162, v120, v120
    v_fmac_f32 v160, v109, v109
    s_waitcnt lgkmcnt(2)
    v_mfma_f32_16x16x32_bf16 v[112:115], v[156:159], v[12:15], v[112:115]
    v_fmac_f32 v162, v121, v121
    v_mul_f32 v165, v165, v166
    v_mfma_f32_16x16x32_bf16 v[124:127], v[156:159], v[24:27], v[124:127]
    ds_read_b64_tr_b16 v[166:167], v3 offset:29632
    v_cvt_pk_bf16_f32 v70, v164, v165
    v_mfma_f32_16x16x32_bf16 v[136:139], v[156:159], v[36:39], v[136:139]
    ds_read_b128 v[156:159], v4 offset:50176
    v_fma_f32 v164, v128, v128, s36
    s_waitcnt lgkmcnt(2)
    v_mfma_f32_16x16x32_bf16 v[112:115], v[144:147], v[16:19], v[112:115]
    v_fma_f32 v165, v134, v134, s36
    v_fmac_f32 v164, v129, v129
    v_mfma_f32_16x16x32_bf16 v[124:127], v[144:147], v[28:31], v[124:127]
    v_fmac_f32 v165, v135, v135
    v_fmac_f32 v164, v130, v130
    v_mfma_f32_16x16x32_bf16 v[136:139], v[144:147], v[40:43], v[136:139]
    ds_read_b32 v147, v5 offset:896
    s_nop 0
    v_fmac_f32 v161, v112, v112
    v_fmac_f32 v161, v113, v113
    v_fmac_f32 v161, v114, v114
    v_fmac_f32 v161, v115, v115
    v_fmac_f32 v163, v124, v124
    v_fmac_f32 v163, v125, v125
    v_fmac_f32 v163, v126, v126
    v_fmac_f32 v163, v127, v127
    v_cvt_pk_bf16_f32 v144, v160, v161
    ds_read_b64_tr_b16 v[160:161], v3 offset:448
    v_cvt_pk_bf16_f32 v145, v162, v163
    ds_read_b64_tr_b16 v[162:163], v3 offset:10176
    v_fmac_f32 v165, v136, v136
    v_fmac_f32 v164, v131, v131
    v_fmac_f32 v165, v137, v137
    v_fmac_f32 v164, v132, v132
    v_fmac_f32 v165, v138, v138
    v_fmac_f32 v164, v133, v133
    v_fmac_f32 v165, v139, v139
    v_cvt_pk_bf16_f32 v146, v164, v165
    ds_read_b64_tr_b16 v[164:165], v3 offset:19904
    s_setprio 2
    s_waitcnt lgkmcnt(3)
    v_mfma_f32_16x16x32_bf16 v[148:151], v[156:159], v[144:147], 0
    ds_read_b64_tr_b16 v[156:157], v3 offset:39360
    ds_read_b64_tr_b16 v[158:159], v3 offset:49088
    v_mfma_f32_16x16x32_bf16 v[152:155], v[140:143], v[144:147], 0
    ds_read_b128 v[140:143], v5 offset:128
    s_nop 3
    v_rsq_f32 v148, v148
    s_waitcnt lgkmcnt(4)
    v_mfma_f32_16x16x32_bf16 v[144:147], v[8:11], v[160:163], 0
    v_rsq_f32 v150, v150
    v_rsq_f32 v152, v152
    v_mul_f32 v148, s33, v148
    v_rsq_f32 v149, v149
    s_waitcnt lgkmcnt(3)
    v_mfma_f32_16x16x32_bf16 v[144:147], v[12:15], v[164:167], v[144:147]
    v_mul_f32 v150, s33, v150
    v_rsq_f32 v151, v151
    v_rsq_f32 v153, v153
    v_mul_f32 v104, v104, v148
    v_mul_f32 v105, v105, v148
    v_mul_f32 v116, v116, v150
    v_mul_f32 v117, v117, v150
    v_mul_f32 v152, s33, v152
    v_mul_f32 v106, v106, v148
    v_mul_f32 v107, v107, v148
    v_cvt_pk_bf16_f32 v104, v104, v105
    v_mul_f32 v118, v118, v150
    s_waitcnt lgkmcnt(1)
    v_mfma_f32_16x16x32_bf16 v[144:147], v[16:19], v[156:159], v[144:147]
    v_mul_f32 v119, v119, v150
    v_cvt_pk_bf16_f32 v116, v116, v117
    v_mul_f32 v108, v108, v148
    v_mul_f32 v109, v109, v148
    v_mul_f32 v110, v110, v149
    v_mul_f32 v111, v111, v149
    v_mul_f32 v112, v112, v149
    v_mul_f32 v113, v113, v149
    v_mul_f32 v114, v114, v149
    v_mul_f32 v115, v115, v149
    v_cvt_pk_bf16_f32 v105, v106, v107
    ds_read_b32 v107, v5 offset:896
    v_mul_f32 v120, v120, v150
    v_mul_f32 v121, v121, v150
    v_mul_f32 v122, v122, v151
    v_mul_f32 v123, v123, v151
    v_mul_f32 v124, v124, v151
    v_mul_f32 v125, v125, v151
    v_mul_f32 v126, v126, v151
    v_mul_f32 v127, v127, v151
    v_mfma_f32_16x16x32_bf16 v[148:151], v[20:23], v[160:163], 0
    v_cvt_pk_bf16_f32 v117, v118, v119
    ds_read_b32 v119, v5 offset:896
    v_mfma_f32_16x16x32_bf16 v[148:151], v[24:27], v[164:167], v[148:151]
    v_mul_f32 v128, v128, v152
    v_mul_f32 v129, v129, v152
    v_mfma_f32_16x16x32_bf16 v[148:151], v[28:31], v[156:159], v[148:151]
    v_mul_f32 v130, v130, v152
    v_mul_f32 v131, v131, v152
    v_mul_f32 v132, v132, v152
    v_mul_f32 v133, v133, v152
    v_mul_f32 v134, v134, v153
    v_mul_f32 v135, v135, v153
    v_mul_f32 v136, v136, v153
    v_mul_f32 v137, v137, v153
    v_mul_f32 v138, v138, v153
    v_mul_f32 v139, v139, v153
    v_mfma_f32_16x16x32_bf16 v[152:155], v[32:35], v[160:163], 0
    ds_read_b128 v[160:163], v5 offset:192
    v_cvt_pk_bf16_f32 v106, v108, v109
    v_mfma_f32_16x16x32_bf16 v[152:155], v[36:39], v[164:167], v[152:155]
    ds_read_b32 v164, v4 offset:49156
    v_cvt_pk_bf16_f32 v118, v120, v121
    v_mfma_f32_16x16x32_bf16 v[152:155], v[40:43], v[156:159], v[152:155]
    v_cvt_pk_bf16_f32 v108, v110, v111
    ds_read_b32 v111, v5 offset:896
    v_cvt_pk_bf16_f32 v120, v122, v123
    ds_read_b32 v123, v5 offset:896
    v_cvt_pk_bf16_f32 v128, v128, v129
    v_cvt_pk_bf16_f32 v129, v130, v131
    ds_read_b32 v131, v5 offset:896
    v_cvt_pk_bf16_f32 v130, v132, v133
    v_cvt_pk_bf16_f32 v132, v134, v135
    ds_read_b32 v135, v5 offset:896
    v_cvt_pk_bf16_f32 v109, v112, v113
    v_cvt_pk_bf16_f32 v110, v114, v115
    ds_read_b32 v115, v5 offset:896
    v_cvt_pk_bf16_f32 v121, v124, v125
    v_cvt_pk_bf16_f32 v122, v126, v127
    v_cvt_pk_bf16_f32 v80, v144, v145
    v_cvt_pk_bf16_f32 v81, v146, v147
    v_cvt_pk_bf16_f32 v82, v148, v149
    v_cvt_pk_bf16_f32 v83, v150, v151
    v_cvt_pk_bf16_f32 v133, v136, v137
    v_cvt_pk_bf16_f32 v134, v138, v139
    v_cvt_pk_bf16_f32 v84, v152, v153
    v_cvt_pk_bf16_f32 v85, v154, v155
    s_waitcnt lgkmcnt(6)
    v_mfma_f32_16x16x32_bf16 v[156:159], v[160:163], v[140:143], 0
    s_waitcnt lgkmcnt(4)
    v_mfma_f32_16x16x32_bf16 v[144:147], v[160:163], v[108:111], 0
    s_waitcnt lgkmcnt(3)
    v_mfma_f32_16x16x32_bf16 v[148:151], v[160:163], v[120:123], 0
    s_waitcnt lgkmcnt(1)
    v_mfma_f32_16x16x32_bf16 v[152:155], v[160:163], v[132:135], 0
    s_nop 5
    v_mov_b32_dpp v144, v148 quad_perm:[0,1,2,3] row_mask:2 bank_mask:0xf
    ds_read_b128 v[148:151], v4 offset:13312
    s_nop 0
    v_mov_b32_dpp v144, v152 quad_perm:[0,1,2,3] row_mask:4 bank_mask:0xf
    ds_read_b128 v[152:155], v4 offset:14336
    s_nop 0
    v_mov_b32_dpp v144, v156 quad_perm:[0,1,2,3] row_mask:8 bank_mask:0xf
    ds_read_b32 v156, v4 offset:15360
    v_add_f32 v144, v144, v164
    s_waitcnt vmcnt(0)
    v_lshlrev_b32 v66, 16, v53
    v_fmamk_f32 v144, v66, 0x3fb8aa3b, v144
    v_bfe_u32 v66, v4, 4, 4
    v_mul_u32_u24 v66, 0x62, v66
    v_add_u32 v66, s44, v66
    buffer_load_ushort v53, v66, s[20:23], 0 offen offset:96
    v_lshl_add_u32 v65, v65, 3, v66
    buffer_load_dwordx2 v[124:125], v65, s[20:23], 0 offen offset:0
    buffer_load_dwordx2 v[126:127], v65, s[20:23], 0 offen offset:32
    buffer_load_dwordx2 v[54:55], v65, s[20:23], 0 offen offset:64
    v_mov_b32 v67, v144
    v_bfe_u32 v65, v4, 8, 2
    s_nop 0
    v_max_f32_dpp v67, v67, v67 row_ror:8 row_mask:0xf bank_mask:0xf
    s_nop 1
    v_max_f32_dpp v67, v67, v67 row_ror:4 row_mask:0xf bank_mask:0xf
    s_nop 1
    v_max_f32_dpp v67, v67, v67 row_ror:2 row_mask:0xf bank_mask:0xf
    s_nop 1
    v_max_f32_dpp v67, v67, v67 row_ror:1 row_mask:0xf bank_mask:0xf
    v_mov_b32 v77, v67
    s_waitcnt lgkmcnt(2)
    v_mfma_f32_16x16x32_bf16 v[148:151], v[120:123], v[104:107], v[148:151]
    v_permlane32_swap_b32 v67, v77
    s_waitcnt lgkmcnt(1)
    v_mfma_f32_16x16x32_bf16 v[152:155], v[132:135], v[104:107], v[152:155]
    v_max_f32 v67, v67, v77
    v_mov_b32 v77, v67
    s_waitcnt lgkmcnt(0)
    v_mfma_f32_16x16x32_bf16 v[156:159], v[140:143], v[104:107], v[156:159]
    v_permlane16_swap_b32 v67, v77
    v_max_f32 v67, v67, v77
    v_sub_f32 v144, v144, v67
    v_exp_f32 v144, v144
    s_nop 0
    v_cvt_pk_bf16_f32 v144, v144, v144
    ds_write_b16 v7, v144 offset:0
    ds_read_b128 v[144:147], v4 offset:12288
    s_waitcnt lgkmcnt(1)
    ds_read_b128 v[136:139], v5 offset:768
    s_waitcnt lgkmcnt(1)
    v_mfma_f32_16x16x32_bf16 v[144:147], v[108:111], v[104:107], v[144:147]
    s_waitcnt lgkmcnt(0)
    ds_read_b128 v[112:115], v5 offset:832
    v_mfma_f32_16x16x32_bf16 v[160:163], v[80:83], v[136:139], 0
    v_mfma_f32_16x16x32_bf16 v[164:167], v[96:99], v[136:139], 0
    s_waitcnt lgkmcnt(0)
    v_mfma_f32_16x16x32_bf16 v[160:163], v[84:87], v[112:115], v[160:163]
    v_mfma_f32_16x16x32_bf16 v[164:167], v[100:103], v[112:115], v[164:167]
    s_nop 6
    ds_write_b128 v5, v[160:163] offset:1152
    s_waitcnt lgkmcnt(0)
    ds_write_b128 v5, v[164:167] offset:1216
    s_waitcnt vmcnt(2)
    v_lshlrev_b32 v66, 16, v124
    v_fmamk_f32 v144, v66, 0x3fb8aa3b, v144
    v_and_b32 v66, 0xffff0000, v124
    v_fmamk_f32 v145, v66, 0x3fb8aa3b, v145
    v_lshlrev_b32 v66, 16, v125
    v_fmamk_f32 v146, v66, 0x3fb8aa3b, v146
    v_and_b32 v66, 0xffff0000, v125
    v_fmamk_f32 v147, v66, 0x3fb8aa3b, v147
    s_waitcnt vmcnt(1)
    v_lshlrev_b32 v66, 16, v126
    v_fmamk_f32 v148, v66, 0x3fb8aa3b, v148
    v_and_b32 v66, 0xffff0000, v126
    v_fmamk_f32 v149, v66, 0x3fb8aa3b, v149
    v_lshlrev_b32 v66, 16, v127
    v_fmamk_f32 v150, v66, 0x3fb8aa3b, v150
    v_and_b32 v66, 0xffff0000, v127
    v_fmamk_f32 v151, v66, 0x3fb8aa3b, v151
    s_waitcnt vmcnt(0)
    v_lshlrev_b32 v66, 16, v54
    v_fmamk_f32 v152, v66, 0x3fb8aa3b, v152
    v_and_b32 v66, 0xffff0000, v54
    v_fmamk_f32 v153, v66, 0x3fb8aa3b, v153
    v_lshlrev_b32 v66, 16, v55
    v_fmamk_f32 v154, v66, 0x3fb8aa3b, v154
    v_and_b32 v66, 0xffff0000, v55
    v_fmamk_f32 v155, v66, 0x3fb8aa3b, v155
    v_lshlrev_b32 v66, 16, v53
    v_fmamk_f32 v156, v66, 0x3fb8aa3b, v156
    v_bfe_u32 v66, v4, 4, 4
    v_add_u32 v66, 16, v66
    v_mul_u32_u24 v66, 0x62, v66
    v_add_u32 v66, s44, v66
    buffer_load_ushort v53, v66, s[20:23], 0 offen offset:96
    v_lshl_add_u32 v65, v65, 3, v66
    buffer_load_dwordx2 v[124:125], v65, s[20:23], 0 offen offset:0
    buffer_load_dwordx2 v[126:127], v65, s[20:23], 0 offen offset:32
    buffer_load_dwordx2 v[54:55], v65, s[20:23], 0 offen offset:64
    v_max3_f32 v67, v144, v145, v146
    v_max3_f32 v67, v67, v147, v148
    v_max3_f32 v67, v67, v149, v150
    v_max3_f32 v67, v67, v151, v152
    v_max3_f32 v67, v67, v153, v154
    v_max3_f32 v67, v67, v155, v156
    v_mov_b32 v77, v67
    v_bfe_u32 v65, v4, 8, 2
    s_nop 0
    v_permlane32_swap_b32 v67, v77
    v_max_f32 v67, v67, v77
    v_mov_b32 v77, v67
    s_nop 1
    v_permlane16_swap_b32 v67, v77
    v_max_f32 v67, v67, v77
    v_sub_f32 v144, v144, v67
    v_sub_f32 v145, v145, v67
    v_sub_f32 v146, v146, v67
    v_sub_f32 v147, v147, v67
    v_exp_f32 v144, v144
    v_exp_f32 v145, v145
    v_exp_f32 v146, v146
    v_exp_f32 v147, v147
    v_cvt_pk_bf16_f32 v136, v144, v145
    v_cvt_pk_bf16_f32 v137, v146, v147
    ds_read_b128 v[144:147], v4 offset:16384
    v_sub_f32 v148, v148, v67
    v_sub_f32 v149, v149, v67
    v_sub_f32 v150, v150, v67
    v_sub_f32 v151, v151, v67
    v_exp_f32 v148, v148
    v_exp_f32 v149, v149
    v_exp_f32 v150, v150
    v_exp_f32 v151, v151
    v_cvt_pk_bf16_f32 v138, v148, v149
    v_cvt_pk_bf16_f32 v139, v150, v151
    ds_read_b128 v[148:151], v4 offset:17408
    v_sub_f32 v152, v152, v67
    v_mfma_f32_16x16x32_bf16 v[160:163], v[80:83], v[136:139], 0
    v_sub_f32 v153, v153, v67
    v_sub_f32 v154, v154, v67
    v_mfma_f32_16x16x32_bf16 v[164:167], v[96:99], v[136:139], 0
    v_sub_f32 v155, v155, v67
    v_exp_f32 v152, v152
    v_exp_f32 v153, v153
    v_exp_f32 v154, v154
    v_exp_f32 v155, v155
    v_cvt_pk_bf16_f32 v112, v152, v153
    v_cvt_pk_bf16_f32 v113, v154, v155
    ds_read_b128 v[152:155], v4 offset:18432
    s_waitcnt lgkmcnt(2)
    v_mfma_f32_16x16x32_bf16 v[144:147], v[108:111], v[116:119], v[144:147]
    v_sub_f32 v156, v156, v67
    v_exp_f32 v156, v156
    s_nop 0
    v_cvt_pk_bf16_f32 v114, v156, 0
    ds_read_b32 v156, v4 offset:19456
    s_nop 0
    v_mfma_f32_16x16x32_bf16 v[160:163], v[84:87], v[112:115], v[160:163]
    v_mfma_f32_16x16x32_bf16 v[164:167], v[100:103], v[112:115], v[164:167]
    s_waitcnt lgkmcnt(2)
    v_mfma_f32_16x16x32_bf16 v[148:151], v[120:123], v[116:119], v[148:151]
    s_nop 5
    v_rcp_f32 v164, v164
    s_nop 0
    v_mul_f32 v160, v160, v164
    v_mul_f32 v161, v161, v164
    v_mul_f32 v162, v162, v164
    v_mul_f32 v163, v163, v164
    v_mul_f32 v166, v166, v164
    v_mul_f32 v167, v167, v164
    v_cvt_pk_bf16_f32 v47, v160, v161
    s_waitcnt lgkmcnt(1)
    v_mfma_f32_16x16x32_bf16 v[152:155], v[132:135], v[116:119], v[152:155]
    v_cvt_pk_bf16_f32 v48, v162, v163
    v_cvt_pk_bf16_f32 v49, v166, v167
    s_waitcnt lgkmcnt(0)
    v_mfma_f32_16x16x32_bf16 v[156:159], v[140:143], v[116:119], v[156:159]
    s_waitcnt vmcnt(2)
    v_lshlrev_b32 v66, 16, v124
    v_fmamk_f32 v144, v66, 0x3fb8aa3b, v144
    v_and_b32 v66, 0xffff0000, v124
    v_fmamk_f32 v145, v66, 0x3fb8aa3b, v145
    v_lshlrev_b32 v66, 16, v125
    v_fmamk_f32 v146, v66, 0x3fb8aa3b, v146
    v_and_b32 v66, 0xffff0000, v125
    v_fmamk_f32 v147, v66, 0x3fb8aa3b, v147
    s_waitcnt vmcnt(1)
    v_lshlrev_b32 v66, 16, v126
    v_fmamk_f32 v148, v66, 0x3fb8aa3b, v148
    v_and_b32 v66, 0xffff0000, v126
    v_fmamk_f32 v149, v66, 0x3fb8aa3b, v149
    v_lshlrev_b32 v66, 16, v127
    v_fmamk_f32 v150, v66, 0x3fb8aa3b, v150
    v_and_b32 v66, 0xffff0000, v127
    v_fmamk_f32 v151, v66, 0x3fb8aa3b, v151
    s_waitcnt vmcnt(0)
    v_lshlrev_b32 v66, 16, v54
    v_fmamk_f32 v152, v66, 0x3fb8aa3b, v152
    v_and_b32 v66, 0xffff0000, v54
    v_fmamk_f32 v153, v66, 0x3fb8aa3b, v153
    v_lshlrev_b32 v66, 16, v55
    v_fmamk_f32 v154, v66, 0x3fb8aa3b, v154
    v_and_b32 v66, 0xffff0000, v55
    v_fmamk_f32 v155, v66, 0x3fb8aa3b, v155
    v_lshlrev_b32 v66, 16, v53
    v_fmamk_f32 v156, v66, 0x3fb8aa3b, v156
    v_bfe_u32 v66, v4, 4, 4
    v_add_u32 v66, 32, v66
    v_mul_u32_u24 v66, 0x62, v66
    v_add_u32 v66, s44, v66
    buffer_load_ushort v53, v66, s[20:23], 0 offen offset:96
    v_lshl_add_u32 v65, v65, 3, v66
    buffer_load_dwordx2 v[124:125], v65, s[20:23], 0 offen offset:0
    buffer_load_dwordx2 v[126:127], v65, s[20:23], 0 offen offset:32
    buffer_load_dwordx2 v[54:55], v65, s[20:23], 0 offen offset:64
    v_max3_f32 v67, v144, v145, v146
    v_max3_f32 v67, v67, v147, v148
    v_max3_f32 v67, v67, v149, v150
    v_max3_f32 v67, v67, v151, v152
    v_max3_f32 v67, v67, v153, v154
    v_max3_f32 v67, v67, v155, v156
    v_mov_b32 v77, v67
    v_bfe_u32 v65, v4, 8, 2
    s_nop 0
    v_permlane32_swap_b32 v67, v77
    v_max_f32 v67, v67, v77
    v_mov_b32 v77, v67
    s_nop 1
    v_permlane16_swap_b32 v67, v77
    v_max_f32 v67, v67, v77
    v_sub_f32 v144, v144, v67
    v_sub_f32 v145, v145, v67
    v_sub_f32 v146, v146, v67
    v_sub_f32 v147, v147, v67
    v_exp_f32 v144, v144
    v_exp_f32 v145, v145
    v_exp_f32 v146, v146
    v_exp_f32 v147, v147
    v_cvt_pk_bf16_f32 v136, v144, v145
    v_cvt_pk_bf16_f32 v137, v146, v147
    ds_read_b128 v[144:147], v4 offset:20480
    v_sub_f32 v148, v148, v67
    v_sub_f32 v149, v149, v67
    v_sub_f32 v150, v150, v67
    v_sub_f32 v151, v151, v67
    v_exp_f32 v148, v148
    v_exp_f32 v149, v149
    v_exp_f32 v150, v150
    v_exp_f32 v151, v151
    v_cvt_pk_bf16_f32 v138, v148, v149
    v_cvt_pk_bf16_f32 v139, v150, v151
    ds_read_b128 v[148:151], v4 offset:21504
    v_sub_f32 v152, v152, v67
    v_mfma_f32_16x16x32_bf16 v[160:163], v[80:83], v[136:139], 0
    v_sub_f32 v153, v153, v67
    v_sub_f32 v154, v154, v67
    v_mfma_f32_16x16x32_bf16 v[164:167], v[96:99], v[136:139], 0
    v_sub_f32 v155, v155, v67
    v_exp_f32 v152, v152
    v_exp_f32 v153, v153
    v_exp_f32 v154, v154
    v_exp_f32 v155, v155
    v_cvt_pk_bf16_f32 v112, v152, v153
    v_cvt_pk_bf16_f32 v113, v154, v155
    ds_read_b128 v[152:155], v4 offset:22528
    s_waitcnt lgkmcnt(2)
    v_mfma_f32_16x16x32_bf16 v[144:147], v[108:111], v[128:131], v[144:147]
    v_sub_f32 v156, v156, v67
    v_exp_f32 v156, v156
    s_nop 0
    v_cvt_pk_bf16_f32 v114, v156, 0
    ds_read_b32 v156, v4 offset:23552
    s_nop 0
    v_mfma_f32_16x16x32_bf16 v[160:163], v[84:87], v[112:115], v[160:163]
    v_mfma_f32_16x16x32_bf16 v[164:167], v[100:103], v[112:115], v[164:167]
    s_waitcnt lgkmcnt(2)
    v_mfma_f32_16x16x32_bf16 v[148:151], v[120:123], v[128:131], v[148:151]
    s_nop 5
    v_rcp_f32 v164, v164
    s_nop 0
    v_mul_f32 v160, v160, v164
    v_mul_f32 v161, v161, v164
    v_mul_f32 v162, v162, v164
    v_mul_f32 v163, v163, v164
    v_mul_f32 v166, v166, v164
    v_mul_f32 v167, v167, v164
    v_cvt_pk_bf16_f32 v59, v160, v161
    s_waitcnt lgkmcnt(1)
    v_mfma_f32_16x16x32_bf16 v[152:155], v[132:135], v[128:131], v[152:155]
    v_cvt_pk_bf16_f32 v60, v162, v163
    v_cvt_pk_bf16_f32 v61, v166, v167
    s_waitcnt lgkmcnt(0)
    v_mfma_f32_16x16x32_bf16 v[156:159], v[140:143], v[128:131], v[156:159]
    ds_read_b128 v[140:143], v4 offset:51200
    s_nop 6
    ds_read_b64_tr_b16 v[158:159], v3 offset:9952
    s_waitcnt vmcnt(2)
    v_lshlrev_b32 v66, 16, v124
    v_fmamk_f32 v144, v66, 0x3fb8aa3b, v144
    v_and_b32 v66, 0xffff0000, v124
    v_fmamk_f32 v145, v66, 0x3fb8aa3b, v145
    v_lshlrev_b32 v66, 16, v125
    v_fmamk_f32 v146, v66, 0x3fb8aa3b, v146
    v_and_b32 v66, 0xffff0000, v125
    v_fmamk_f32 v147, v66, 0x3fb8aa3b, v147
    s_waitcnt vmcnt(1)
    v_lshlrev_b32 v66, 16, v126
    v_fmamk_f32 v148, v66, 0x3fb8aa3b, v148
    v_and_b32 v66, 0xffff0000, v126
    v_fmamk_f32 v149, v66, 0x3fb8aa3b, v149
    v_lshlrev_b32 v66, 16, v127
    v_fmamk_f32 v150, v66, 0x3fb8aa3b, v150
    v_and_b32 v66, 0xffff0000, v127
    v_fmamk_f32 v151, v66, 0x3fb8aa3b, v151
    s_waitcnt vmcnt(0)
    v_lshlrev_b32 v66, 16, v54
    v_fmamk_f32 v152, v66, 0x3fb8aa3b, v152
    v_and_b32 v66, 0xffff0000, v54
    v_fmamk_f32 v153, v66, 0x3fb8aa3b, v153
    v_lshlrev_b32 v66, 16, v55
    v_fmamk_f32 v154, v66, 0x3fb8aa3b, v154
    v_and_b32 v66, 0xffff0000, v55
    v_fmamk_f32 v155, v66, 0x3fb8aa3b, v155
    v_lshlrev_b32 v66, 16, v53
    v_fmamk_f32 v156, v66, 0x3fb8aa3b, v156
    v_bfe_u32 v66, v4, 4, 6
    v_min_u32 v66, 48, v66
    v_lshl_add_u32 v66, v66, 1, s44
    buffer_load_ushort v53, v66, s[20:23], s57 offen offset:608
    v_max3_f32 v67, v144, v145, v146
    v_max3_f32 v67, v67, v147, v148
    v_max3_f32 v67, v67, v149, v150
    v_max3_f32 v67, v67, v151, v152
    v_max3_f32 v67, v67, v153, v154
    v_max3_f32 v67, v67, v155, v156
    v_mov_b32 v77, v67
    s_nop 1
    v_permlane32_swap_b32 v67, v77
    v_max_f32 v67, v67, v77
    v_mov_b32 v77, v67
    s_nop 1
    v_permlane16_swap_b32 v67, v77
    v_max_f32 v67, v67, v77
    v_sub_f32 v144, v144, v67
    v_sub_f32 v145, v145, v67
    v_sub_f32 v146, v146, v67
    v_sub_f32 v147, v147, v67
    v_exp_f32 v144, v144
    v_exp_f32 v145, v145
    v_exp_f32 v146, v146
    v_exp_f32 v147, v147
    v_cvt_pk_bf16_f32 v136, v144, v145
    ds_read_b64_tr_b16 v[144:145], v3 offset:192
    v_cvt_pk_bf16_f32 v137, v146, v147
    ds_read_b64_tr_b16 v[146:147], v3 offset:9920
    v_sub_f32 v148, v148, v67
    v_sub_f32 v149, v149, v67
    v_sub_f32 v150, v150, v67
    v_sub_f32 v151, v151, v67
    v_exp_f32 v148, v148
    v_exp_f32 v149, v149
    v_exp_f32 v150, v150
    v_exp_f32 v151, v151
    v_sub_f32 v152, v152, v67
    v_sub_f32 v153, v153, v67
    v_sub_f32 v154, v154, v67
    v_sub_f32 v155, v155, v67
    v_cvt_pk_bf16_f32 v138, v148, v149
    ds_read_b64_tr_b16 v[148:149], v3 offset:19648
    v_cvt_pk_bf16_f32 v139, v150, v151
    ds_read_b64_tr_b16 v[150:151], v3 offset:29376
    v_exp_f32 v152, v152
    v_mfma_f32_16x16x32_bf16 v[160:163], v[80:83], v[136:139], 0
    v_exp_f32 v153, v153
    v_mfma_f32_16x16x32_bf16 v[164:167], v[96:99], v[136:139], 0
    v_exp_f32 v154, v154
    v_exp_f32 v155, v155
    v_sub_f32 v156, v156, v67
    v_cvt_pk_bf16_f32 v112, v152, v153
    s_waitcnt lgkmcnt(2)
    v_mfma_f32_16x16x32_bf16 v[104:107], v[144:147], v[8:11], 0
    ds_read_b64_tr_b16 v[152:153], v3 offset:39104
    v_cvt_pk_bf16_f32 v113, v154, v155
    v_mfma_f32_16x16x32_bf16 v[116:119], v[144:147], v[20:23], 0
    ds_read_b64_tr_b16 v[154:155], v3 offset:48832
    v_exp_f32 v156, v156
    v_mfma_f32_16x16x32_bf16 v[128:131], v[144:147], v[32:35], 0
    ds_read_b64_tr_b16 v[144:145], v3 offset:19680
    ds_read_b64_tr_b16 v[146:147], v3 offset:29408
    v_cvt_pk_bf16_f32 v114, v156, 0
    ds_read_b64_tr_b16 v[156:157], v3 offset:224
    s_nop 0
    v_mfma_f32_16x16x32_bf16 v[160:163], v[84:87], v[112:115], v[160:163]
    ds_read_u16 v86, v6 offset:640
    s_waitcnt lgkmcnt(6)
    v_mfma_f32_16x16x32_bf16 v[104:107], v[148:151], v[12:15], v[104:107]
    v_mfma_f32_16x16x32_bf16 v[116:119], v[148:151], v[24:27], v[116:119]
    v_mfma_f32_16x16x32_bf16 v[128:131], v[148:151], v[36:39], v[128:131]
    ds_read_b64_tr_b16 v[148:149], v3 offset:39136
    ds_read_b64_tr_b16 v[150:151], v3 offset:48864
    v_mfma_f32_16x16x32_bf16 v[164:167], v[100:103], v[112:115], v[164:167]
    ds_read_u16 v102, v6 offset:704
    s_waitcnt lgkmcnt(7)
    v_mfma_f32_16x16x32_bf16 v[104:107], v[152:155], v[16:19], v[104:107]
    s_nop 4
    v_rcp_f32 v164, v164
    v_mfma_f32_16x16x32_bf16 v[116:119], v[152:155], v[28:31], v[116:119]
    v_mul_f32 v160, v160, v164
    v_mul_f32 v161, v161, v164
    v_mfma_f32_16x16x32_bf16 v[128:131], v[152:155], v[40:43], v[128:131]
    ds_read_b64_tr_b16 v[152:153], v3 offset:256
    ds_read_b64_tr_b16 v[154:155], v3 offset:9984
    s_waitcnt lgkmcnt(6)
    v_mfma_f32_16x16x32_bf16 v[108:111], v[156:159], v[8:11], 0
    v_mul_f32 v162, v162, v164
    v_mul_f32 v163, v163, v164
    v_mfma_f32_16x16x32_bf16 v[120:123], v[156:159], v[20:23], 0
    v_cvt_pk_bf16_f32 v71, v160, v161
    v_cvt_pk_bf16_f32 v72, v162, v163
    v_mfma_f32_16x16x32_bf16 v[132:135], v[156:159], v[32:35], 0
    ds_read_b64_tr_b16 v[156:157], v3 offset:19712
    ds_read_b64_tr_b16 v[158:159], v3 offset:29440
    v_mfma_f32_16x16x32_bf16 v[108:111], v[144:147], v[12:15], v[108:111]
    v_fma_f32 v160, v104, v104, s36
    v_fma_f32 v162, v116, v116, s36
    v_mfma_f32_16x16x32_bf16 v[120:123], v[144:147], v[24:27], v[120:123]
    v_fmac_f32 v160, v105, v105
    v_fmac_f32 v162, v117, v117
    v_mfma_f32_16x16x32_bf16 v[132:135], v[144:147], v[36:39], v[132:135]
    ds_read_b64_tr_b16 v[144:145], v3 offset:39168
    ds_read_b64_tr_b16 v[146:147], v3 offset:48896
    s_waitcnt lgkmcnt(7)
    v_mfma_f32_16x16x32_bf16 v[108:111], v[148:151], v[16:19], v[108:111]
    v_fmac_f32 v160, v106, v106
    v_fmac_f32 v162, v118, v118
    v_mfma_f32_16x16x32_bf16 v[120:123], v[148:151], v[28:31], v[120:123]
    v_fmac_f32 v160, v107, v107
    v_fmac_f32 v162, v119, v119
    v_mfma_f32_16x16x32_bf16 v[132:135], v[148:151], v[40:43], v[132:135]
    v_mul_f32 v166, v166, v164
    s_nop 0
    v_fma_f32 v161, v110, v110, s36
    s_waitcnt lgkmcnt(4)
    v_mfma_f32_16x16x32_bf16 v[112:115], v[152:155], v[8:11], 0
    v_fmac_f32 v161, v111, v111
    v_fma_f32 v163, v122, v122, s36
    v_mfma_f32_16x16x32_bf16 v[124:127], v[152:155], v[20:23], 0
    v_fmac_f32 v163, v123, v123
    v_fmac_f32 v160, v108, v108
    v_mfma_f32_16x16x32_bf16 v[136:139], v[152:155], v[32:35], 0
    v_fmac_f32 v162, v120, v120
    v_fmac_f32 v160, v109, v109
    s_waitcnt lgkmcnt(2)
    v_mfma_f32_16x16x32_bf16 v[112:115], v[156:159], v[12:15], v[112:115]
    v_fmac_f32 v162, v121, v121
    v_mul_f32 v167, v167, v164
    v_mfma_f32_16x16x32_bf16 v[124:127], v[156:159], v[24:27], v[124:127]
    v_fma_f32 v164, v128, v128, s36
    v_fma_f32 v165, v134, v134, s36
    v_mfma_f32_16x16x32_bf16 v[136:139], v[156:159], v[36:39], v[136:139]
    ds_read_b128 v[156:159], v4 offset:50176
    v_fmac_f32 v164, v129, v129
    s_waitcnt lgkmcnt(1)
    v_mfma_f32_16x16x32_bf16 v[112:115], v[144:147], v[16:19], v[112:115]
    v_fmac_f32 v165, v135, v135
    v_fmac_f32 v164, v130, v130
    v_mfma_f32_16x16x32_bf16 v[124:127], v[144:147], v[28:31], v[124:127]
    v_fmac_f32 v164, v131, v131
    v_fmac_f32 v164, v132, v132
    v_mfma_f32_16x16x32_bf16 v[136:139], v[144:147], v[40:43], v[136:139]
    ds_read_b32 v147, v5 offset:896
    s_nop 0
    v_fmac_f32 v161, v112, v112
    v_fmac_f32 v161, v113, v113
    v_fmac_f32 v161, v114, v114
    v_fmac_f32 v161, v115, v115
    v_fmac_f32 v163, v124, v124
    v_fmac_f32 v163, v125, v125
    v_fmac_f32 v163, v126, v126
    v_fmac_f32 v163, v127, v127
    v_cvt_pk_bf16_f32 v144, v160, v161
    ds_read_b64_tr_b16 v[160:161], v3 offset:480
    v_cvt_pk_bf16_f32 v145, v162, v163
    ds_read_b64_tr_b16 v[162:163], v3 offset:10208
    v_fmac_f32 v165, v136, v136
    v_fmac_f32 v165, v137, v137
    v_fmac_f32 v165, v138, v138
    v_fmac_f32 v164, v133, v133
    v_fmac_f32 v165, v139, v139
    v_cvt_pk_bf16_f32 v73, v166, v167
    ds_read_b64_tr_b16 v[166:167], v3 offset:29664
    v_cvt_pk_bf16_f32 v146, v164, v165
    ds_read_b64_tr_b16 v[164:165], v3 offset:19936
    s_setprio 1
    s_waitcnt lgkmcnt(4)
    v_mfma_f32_16x16x32_bf16 v[148:151], v[156:159], v[144:147], 0
    ds_read_b64_tr_b16 v[156:157], v3 offset:39392
    ds_read_b64_tr_b16 v[158:159], v3 offset:49120
    v_mfma_f32_16x16x32_bf16 v[152:155], v[140:143], v[144:147], 0
    ds_read_b128 v[140:143], v5 offset:256
    s_nop 3
    v_rsq_f32 v148, v148
    s_waitcnt lgkmcnt(5)
    v_mfma_f32_16x16x32_bf16 v[144:147], v[8:11], v[160:163], 0
    v_rsq_f32 v150, v150
    v_rsq_f32 v152, v152
    v_rsq_f32 v149, v149
    s_waitcnt lgkmcnt(3)
    v_mfma_f32_16x16x32_bf16 v[144:147], v[12:15], v[164:167], v[144:147]
    v_rsq_f32 v151, v151
    v_rsq_f32 v153, v153
    v_mul_f32 v148, s34, v148
    v_mul_f32 v150, s34, v150
    v_mul_f32 v152, s34, v152
    v_mul_f32 v104, v104, v148
    v_mul_f32 v105, v105, v148
    v_mul_f32 v106, v106, v148
    v_mul_f32 v107, v107, v148
    v_mul_f32 v108, v108, v148
    v_mul_f32 v109, v109, v148
    v_mul_f32 v110, v110, v149
    v_mul_f32 v111, v111, v149
    s_waitcnt lgkmcnt(1)
    v_mfma_f32_16x16x32_bf16 v[144:147], v[16:19], v[156:159], v[144:147]
    v_mul_f32 v112, v112, v149
    v_mul_f32 v113, v113, v149
    v_mul_f32 v114, v114, v149
    v_mul_f32 v115, v115, v149
    v_mul_f32 v116, v116, v150
    v_mul_f32 v117, v117, v150
    v_mul_f32 v118, v118, v150
    v_mul_f32 v119, v119, v150
    v_mul_f32 v120, v120, v150
    v_mul_f32 v121, v121, v150
    v_mul_f32 v122, v122, v151
    v_mul_f32 v123, v123, v151
    v_mul_f32 v124, v124, v151
    v_mul_f32 v125, v125, v151
    v_mul_f32 v126, v126, v151
    v_mul_f32 v127, v127, v151
    v_mfma_f32_16x16x32_bf16 v[148:151], v[20:23], v[160:163], 0
    v_mul_f32 v128, v128, v152
    v_mul_f32 v129, v129, v152
    v_mfma_f32_16x16x32_bf16 v[148:151], v[24:27], v[164:167], v[148:151]
    v_mul_f32 v130, v130, v152
    v_mul_f32 v131, v131, v152
    v_mfma_f32_16x16x32_bf16 v[148:151], v[28:31], v[156:159], v[148:151]
    v_mul_f32 v132, v132, v152
    v_mul_f32 v133, v133, v152
    v_mul_f32 v134, v134, v153
    v_mul_f32 v135, v135, v153
    v_mul_f32 v136, v136, v153
    v_mul_f32 v137, v137, v153
    v_mul_f32 v138, v138, v153
    v_mul_f32 v139, v139, v153
    v_mfma_f32_16x16x32_bf16 v[152:155], v[32:35], v[160:163], 0
    ds_read_b64_tr_b16 v[160:161], v3 offset:512
    ds_read_b64_tr_b16 v[162:163], v3 offset:10240
    v_mfma_f32_16x16x32_bf16 v[152:155], v[36:39], v[164:167], v[152:155]
    ds_read_b64_tr_b16 v[164:165], v3 offset:19968
    ds_read_b64_tr_b16 v[166:167], v3 offset:29696
    v_mfma_f32_16x16x32_bf16 v[152:155], v[40:43], v[156:159], v[152:155]
    ds_read_b64_tr_b16 v[156:157], v3 offset:39424
    ds_read_b64_tr_b16 v[158:159], v3 offset:49152
    v_cvt_pk_bf16_f32 v104, v104, v105
    v_cvt_pk_bf16_f32 v116, v116, v117
    v_cvt_pk_bf16_f32 v105, v106, v107
    ds_read_b32 v107, v5 offset:896
    v_cvt_pk_bf16_f32 v117, v118, v119
    ds_read_b32 v119, v5 offset:896
    v_cvt_pk_bf16_f32 v80, v144, v145
    v_cvt_pk_bf16_f32 v81, v146, v147
    v_cvt_pk_bf16_f32 v82, v148, v149
    v_cvt_pk_bf16_f32 v83, v150, v151
    v_cvt_pk_bf16_f32 v84, v152, v153
    v_cvt_pk_bf16_f32 v85, v154, v155
    v_cvt_pk_bf16_f32 v106, v108, v109
    v_cvt_pk_bf16_f32 v118, v120, v121
    v_cvt_pk_bf16_f32 v108, v110, v111
    ds_read_b32 v111, v5 offset:896
    v_cvt_pk_bf16_f32 v120, v122, v123
    ds_read_b32 v123, v5 offset:896
    v_cvt_pk_bf16_f32 v128, v128, v129
    v_cvt_pk_bf16_f32 v129, v130, v131
    ds_read_b32 v131, v5 offset:896
    v_cvt_pk_bf16_f32 v130, v132, v133
    v_cvt_pk_bf16_f32 v132, v134, v135
    ds_read_b32 v135, v5 offset:896
    v_cvt_pk_bf16_f32 v109, v112, v113
    v_cvt_pk_bf16_f32 v110, v114, v115
    s_waitcnt lgkmcnt(10)
    v_mfma_f32_16x16x32_bf16 v[144:147], v[8:11], v[160:163], 0
    ds_read_b32 v115, v5 offset:896
    v_cvt_pk_bf16_f32 v121, v124, v125
    v_mfma_f32_16x16x32_bf16 v[148:151], v[20:23], v[160:163], 0
    v_cvt_pk_bf16_f32 v122, v126, v127
    v_cvt_pk_bf16_f32 v133, v136, v137
    v_mfma_f32_16x16x32_bf16 v[152:155], v[32:35], v[160:163], 0
    ds_read_b128 v[160:163], v5 offset:320
    v_cvt_pk_bf16_f32 v134, v138, v139
    s_waitcnt lgkmcnt(10)
    v_mfma_f32_16x16x32_bf16 v[144:147], v[12:15], v[164:167], v[144:147]
    v_mfma_f32_16x16x32_bf16 v[148:151], v[24:27], v[164:167], v[148:151]
    v_mfma_f32_16x16x32_bf16 v[152:155], v[36:39], v[164:167], v[152:155]
    ds_read_b32 v164, v4 offset:49160
    s_waitcnt lgkmcnt(9)
    v_mfma_f32_16x16x32_bf16 v[144:147], v[16:19], v[156:159], v[144:147]
    v_mfma_f32_16x16x32_bf16 v[148:151], v[28:31], v[156:159], v[148:151]
    v_mfma_f32_16x16x32_bf16 v[152:155], v[40:43], v[156:159], v[152:155]
    s_waitcnt vmcnt(0)
    v_lshlrev_b32 v66, 16, v53
    s_mov_b64 exec, s[38:39]
    s_nop 2
    v_cvt_pk_bf16_f32 v88, v144, v145
    v_cvt_pk_bf16_f32 v89, v146, v147
    v_cvt_pk_bf16_f32 v90, v148, v149
    v_cvt_pk_bf16_f32 v91, v150, v151
    v_cvt_pk_bf16_f32 v92, v152, v153
    v_cvt_pk_bf16_f32 v93, v154, v155
    s_mov_b64 exec, -1
    s_waitcnt lgkmcnt(1)
    v_mfma_f32_16x16x32_bf16 v[156:159], v[160:163], v[140:143], 0
    s_mov_b64 exec, s[40:41]
    v_cvt_pk_bf16_f32 v96, v144, v145
    v_cvt_pk_bf16_f32 v97, v146, v147
    v_cvt_pk_bf16_f32 v98, v148, v149
    v_cvt_pk_bf16_f32 v99, v150, v151
    v_cvt_pk_bf16_f32 v100, v152, v153
    v_cvt_pk_bf16_f32 v101, v154, v155
    s_mov_b64 exec, -1
    v_mfma_f32_16x16x32_bf16 v[144:147], v[160:163], v[108:111], 0
    v_mfma_f32_16x16x32_bf16 v[148:151], v[160:163], v[120:123], 0
    v_mfma_f32_16x16x32_bf16 v[152:155], v[160:163], v[132:135], 0
    s_nop 6
    v_mov_b32_dpp v144, v148 quad_perm:[0,1,2,3] row_mask:2 bank_mask:0xf
    ds_read_b128 v[148:151], v4 offset:25600
    s_nop 0
    v_mov_b32_dpp v144, v152 quad_perm:[0,1,2,3] row_mask:4 bank_mask:0xf
    ds_read_b128 v[152:155], v4 offset:26624
    s_nop 0
    v_mov_b32_dpp v144, v156 quad_perm:[0,1,2,3] row_mask:8 bank_mask:0xf
    ds_read_b32 v156, v4 offset:27648
    s_waitcnt lgkmcnt(3)
    v_add_f32 v144, v144, v164
    v_fmamk_f32 v144, v66, 0x3fb8aa3b, v144
    v_bfe_u32 v66, v4, 4, 4
    v_mul_u32_u24 v66, 0x62, v66
    v_add_u32 v66, s44, v66
    buffer_load_ushort v53, v66, s[20:23], 0 offen offset:96
    v_lshl_add_u32 v65, v65, 3, v66
    buffer_load_dwordx2 v[124:125], v65, s[20:23], 0 offen offset:0
    buffer_load_dwordx2 v[126:127], v65, s[20:23], 0 offen offset:32
    buffer_load_dwordx2 v[54:55], v65, s[20:23], 0 offen offset:64
    v_mov_b32 v67, v144
    v_bfe_u32 v65, v4, 8, 2
    s_nop 0
    v_max_f32_dpp v67, v67, v67 row_ror:8 row_mask:0xf bank_mask:0xf
    s_nop 1
    v_max_f32_dpp v67, v67, v67 row_ror:4 row_mask:0xf bank_mask:0xf
    s_nop 1
    v_max_f32_dpp v67, v67, v67 row_ror:2 row_mask:0xf bank_mask:0xf
    s_nop 1
    v_max_f32_dpp v67, v67, v67 row_ror:1 row_mask:0xf bank_mask:0xf
    v_mov_b32 v77, v67
    s_nop 1
    v_permlane32_swap_b32 v67, v77
    s_waitcnt lgkmcnt(2)
    v_mfma_f32_16x16x32_bf16 v[148:151], v[120:123], v[104:107], v[148:151]
    v_max_f32 v67, v67, v77
    v_mov_b32 v77, v67
    s_waitcnt lgkmcnt(1)
    v_mfma_f32_16x16x32_bf16 v[152:155], v[132:135], v[104:107], v[152:155]
    v_permlane16_swap_b32 v67, v77
    s_waitcnt lgkmcnt(0)
    v_mfma_f32_16x16x32_bf16 v[156:159], v[140:143], v[104:107], v[156:159]
    v_max_f32 v67, v67, v77
    v_sub_f32 v144, v144, v67
    v_exp_f32 v144, v144
    s_nop 0
    v_cvt_pk_bf16_f32 v144, v144, v144
    ds_write_b16 v7, v144 offset:0
    ds_read_b128 v[144:147], v4 offset:24576
    s_waitcnt lgkmcnt(1)
    ds_read_b128 v[136:139], v5 offset:768
    s_waitcnt lgkmcnt(1)
    v_mfma_f32_16x16x32_bf16 v[144:147], v[108:111], v[104:107], v[144:147]
    s_waitcnt lgkmcnt(0)
    ds_read_b128 v[112:115], v5 offset:832
    v_mfma_f32_16x16x32_bf16 v[160:163], v[80:83], v[136:139], 0
    v_mfma_f32_16x16x32_bf16 v[164:167], v[88:91], v[136:139], 0
    s_waitcnt lgkmcnt(0)
    v_mfma_f32_16x16x32_bf16 v[160:163], v[84:87], v[112:115], v[160:163]
    v_mfma_f32_16x16x32_bf16 v[164:167], v[92:95], v[112:115], v[164:167]
    s_nop 6
    ds_write_b128 v5, v[160:163] offset:1280
    s_waitcnt lgkmcnt(0)
    ds_write_b128 v5, v[164:167] offset:1344
    s_waitcnt vmcnt(2)
    v_lshlrev_b32 v66, 16, v124
    v_fmamk_f32 v144, v66, 0x3fb8aa3b, v144
    v_and_b32 v66, 0xffff0000, v124
    v_fmamk_f32 v145, v66, 0x3fb8aa3b, v145
    v_lshlrev_b32 v66, 16, v125
    v_fmamk_f32 v146, v66, 0x3fb8aa3b, v146
    v_and_b32 v66, 0xffff0000, v125
    v_fmamk_f32 v147, v66, 0x3fb8aa3b, v147
    s_waitcnt vmcnt(1)
    v_lshlrev_b32 v66, 16, v126
    v_fmamk_f32 v148, v66, 0x3fb8aa3b, v148
    v_and_b32 v66, 0xffff0000, v126
    v_fmamk_f32 v149, v66, 0x3fb8aa3b, v149
    v_lshlrev_b32 v66, 16, v127
    v_fmamk_f32 v150, v66, 0x3fb8aa3b, v150
    v_and_b32 v66, 0xffff0000, v127
    v_fmamk_f32 v151, v66, 0x3fb8aa3b, v151
    s_waitcnt vmcnt(0)
    v_lshlrev_b32 v66, 16, v54
    v_fmamk_f32 v152, v66, 0x3fb8aa3b, v152
    v_and_b32 v66, 0xffff0000, v54
    v_fmamk_f32 v153, v66, 0x3fb8aa3b, v153
    v_lshlrev_b32 v66, 16, v55
    v_fmamk_f32 v154, v66, 0x3fb8aa3b, v154
    v_and_b32 v66, 0xffff0000, v55
    v_fmamk_f32 v155, v66, 0x3fb8aa3b, v155
    v_lshlrev_b32 v66, 16, v53
    v_fmamk_f32 v156, v66, 0x3fb8aa3b, v156
    v_bfe_u32 v66, v4, 4, 4
    v_add_u32 v66, 16, v66
    v_mul_u32_u24 v66, 0x62, v66
    v_add_u32 v66, s44, v66
    buffer_load_ushort v53, v66, s[20:23], 0 offen offset:96
    v_lshl_add_u32 v65, v65, 3, v66
    buffer_load_dwordx2 v[124:125], v65, s[20:23], 0 offen offset:0
    buffer_load_dwordx2 v[126:127], v65, s[20:23], 0 offen offset:32
    buffer_load_dwordx2 v[54:55], v65, s[20:23], 0 offen offset:64
    v_max3_f32 v67, v144, v145, v146
    v_max3_f32 v67, v67, v147, v148
    v_max3_f32 v67, v67, v149, v150
    v_max3_f32 v67, v67, v151, v152
    v_max3_f32 v67, v67, v153, v154
    v_max3_f32 v67, v67, v155, v156
    v_mov_b32 v77, v67
    v_bfe_u32 v65, v4, 8, 2
    s_nop 0
    v_permlane32_swap_b32 v67, v77
    v_max_f32 v67, v67, v77
    v_mov_b32 v77, v67
    s_nop 1
    v_permlane16_swap_b32 v67, v77
    v_max_f32 v67, v67, v77
    v_sub_f32 v144, v144, v67
    v_sub_f32 v145, v145, v67
    v_sub_f32 v146, v146, v67
    v_sub_f32 v147, v147, v67
    v_exp_f32 v144, v144
    v_exp_f32 v145, v145
    v_exp_f32 v146, v146
    v_exp_f32 v147, v147
    v_cvt_pk_bf16_f32 v136, v144, v145
    v_cvt_pk_bf16_f32 v137, v146, v147
    ds_read_b128 v[144:147], v4 offset:28672
    v_sub_f32 v148, v148, v67
    v_sub_f32 v149, v149, v67
    v_sub_f32 v150, v150, v67
    v_sub_f32 v151, v151, v67
    v_exp_f32 v148, v148
    v_exp_f32 v149, v149
    v_exp_f32 v150, v150
    v_exp_f32 v151, v151
    v_cvt_pk_bf16_f32 v138, v148, v149
    v_cvt_pk_bf16_f32 v139, v150, v151
    ds_read_b128 v[148:151], v4 offset:29696
    v_sub_f32 v152, v152, v67
    v_mfma_f32_16x16x32_bf16 v[160:163], v[80:83], v[136:139], 0
    v_sub_f32 v153, v153, v67
    v_sub_f32 v154, v154, v67
    v_mfma_f32_16x16x32_bf16 v[164:167], v[88:91], v[136:139], 0
    v_sub_f32 v155, v155, v67
    v_exp_f32 v152, v152
    v_exp_f32 v153, v153
    v_exp_f32 v154, v154
    v_exp_f32 v155, v155
    v_cvt_pk_bf16_f32 v112, v152, v153
    v_cvt_pk_bf16_f32 v113, v154, v155
    ds_read_b128 v[152:155], v4 offset:30720
    s_waitcnt lgkmcnt(2)
    v_mfma_f32_16x16x32_bf16 v[144:147], v[108:111], v[116:119], v[144:147]
    v_sub_f32 v156, v156, v67
    v_exp_f32 v156, v156
    s_nop 0
    v_cvt_pk_bf16_f32 v114, v156, 0
    ds_read_b32 v156, v4 offset:31744
    s_nop 0
    v_mfma_f32_16x16x32_bf16 v[160:163], v[84:87], v[112:115], v[160:163]
    v_mfma_f32_16x16x32_bf16 v[164:167], v[92:95], v[112:115], v[164:167]
    s_waitcnt lgkmcnt(2)
    v_mfma_f32_16x16x32_bf16 v[148:151], v[120:123], v[116:119], v[148:151]
    s_nop 5
    v_rcp_f32 v166, v166
    s_nop 0
    v_mul_f32 v160, v160, v166
    v_mul_f32 v161, v161, v166
    v_mul_f32 v162, v162, v166
    v_mul_f32 v163, v163, v166
    v_mul_f32 v164, v164, v166
    v_mul_f32 v165, v165, v166
    v_cvt_pk_bf16_f32 v50, v160, v161
    s_waitcnt lgkmcnt(1)
    v_mfma_f32_16x16x32_bf16 v[152:155], v[132:135], v[116:119], v[152:155]
    v_cvt_pk_bf16_f32 v51, v162, v163
    v_cvt_pk_bf16_f32 v52, v164, v165
    s_waitcnt lgkmcnt(0)
    v_mfma_f32_16x16x32_bf16 v[156:159], v[140:143], v[116:119], v[156:159]
    s_waitcnt vmcnt(2)
    v_lshlrev_b32 v66, 16, v124
    v_fmamk_f32 v144, v66, 0x3fb8aa3b, v144
    v_and_b32 v66, 0xffff0000, v124
    v_fmamk_f32 v145, v66, 0x3fb8aa3b, v145
    v_lshlrev_b32 v66, 16, v125
    v_fmamk_f32 v146, v66, 0x3fb8aa3b, v146
    v_and_b32 v66, 0xffff0000, v125
    v_fmamk_f32 v147, v66, 0x3fb8aa3b, v147
    s_waitcnt vmcnt(1)
    v_lshlrev_b32 v66, 16, v126
    v_fmamk_f32 v148, v66, 0x3fb8aa3b, v148
    v_and_b32 v66, 0xffff0000, v126
    v_fmamk_f32 v149, v66, 0x3fb8aa3b, v149
    v_lshlrev_b32 v66, 16, v127
    v_fmamk_f32 v150, v66, 0x3fb8aa3b, v150
    v_and_b32 v66, 0xffff0000, v127
    v_fmamk_f32 v151, v66, 0x3fb8aa3b, v151
    s_waitcnt vmcnt(0)
    v_lshlrev_b32 v66, 16, v54
    v_fmamk_f32 v152, v66, 0x3fb8aa3b, v152
    v_and_b32 v66, 0xffff0000, v54
    v_fmamk_f32 v153, v66, 0x3fb8aa3b, v153
    v_lshlrev_b32 v66, 16, v55
    v_fmamk_f32 v154, v66, 0x3fb8aa3b, v154
    v_and_b32 v66, 0xffff0000, v55
    v_fmamk_f32 v155, v66, 0x3fb8aa3b, v155
    v_lshlrev_b32 v66, 16, v53
    v_fmamk_f32 v156, v66, 0x3fb8aa3b, v156
    v_bfe_u32 v66, v4, 4, 4
    v_add_u32 v66, 32, v66
    v_mul_u32_u24 v66, 0x62, v66
    v_add_u32 v66, s44, v66
    buffer_load_ushort v53, v66, s[20:23], 0 offen offset:96
    v_lshl_add_u32 v65, v65, 3, v66
    buffer_load_dwordx2 v[124:125], v65, s[20:23], 0 offen offset:0
    buffer_load_dwordx2 v[126:127], v65, s[20:23], 0 offen offset:32
    buffer_load_dwordx2 v[54:55], v65, s[20:23], 0 offen offset:64
    v_max3_f32 v67, v144, v145, v146
    v_max3_f32 v67, v67, v147, v148
    v_max3_f32 v67, v67, v149, v150
    v_max3_f32 v67, v67, v151, v152
    v_max3_f32 v67, v67, v153, v154
    v_max3_f32 v67, v67, v155, v156
    v_mov_b32 v77, v67
    s_nop 1
    v_permlane32_swap_b32 v67, v77
    v_max_f32 v67, v67, v77
    v_mov_b32 v77, v67
    s_nop 1
    v_permlane16_swap_b32 v67, v77
    v_max_f32 v67, v67, v77
    v_sub_f32 v144, v144, v67
    v_sub_f32 v145, v145, v67
    v_sub_f32 v146, v146, v67
    v_sub_f32 v147, v147, v67
    v_exp_f32 v144, v144
    v_exp_f32 v145, v145
    v_exp_f32 v146, v146
    v_exp_f32 v147, v147
    v_cvt_pk_bf16_f32 v136, v144, v145
    v_cvt_pk_bf16_f32 v137, v146, v147
    ds_read_b128 v[144:147], v4 offset:32768
    v_sub_f32 v148, v148, v67
    v_sub_f32 v149, v149, v67
    v_sub_f32 v150, v150, v67
    v_sub_f32 v151, v151, v67
    v_exp_f32 v148, v148
    v_exp_f32 v149, v149
    v_exp_f32 v150, v150
    v_exp_f32 v151, v151
    v_cvt_pk_bf16_f32 v138, v148, v149
    v_cvt_pk_bf16_f32 v139, v150, v151
    ds_read_b128 v[148:151], v4 offset:33792
    v_sub_f32 v152, v152, v67
    v_mfma_f32_16x16x32_bf16 v[160:163], v[80:83], v[136:139], 0
    v_sub_f32 v153, v153, v67
    v_sub_f32 v154, v154, v67
    v_mfma_f32_16x16x32_bf16 v[164:167], v[88:91], v[136:139], 0
    v_sub_f32 v155, v155, v67
    v_exp_f32 v152, v152
    v_exp_f32 v153, v153
    v_exp_f32 v154, v154
    v_exp_f32 v155, v155
    v_cvt_pk_bf16_f32 v112, v152, v153
    v_cvt_pk_bf16_f32 v113, v154, v155
    ds_read_b128 v[152:155], v4 offset:34816
    s_waitcnt lgkmcnt(2)
    v_mfma_f32_16x16x32_bf16 v[144:147], v[108:111], v[128:131], v[144:147]
    v_sub_f32 v156, v156, v67
    v_exp_f32 v156, v156
    s_nop 0
    v_cvt_pk_bf16_f32 v114, v156, 0
    ds_read_b32 v156, v4 offset:35840
    s_nop 0
    v_mfma_f32_16x16x32_bf16 v[160:163], v[84:87], v[112:115], v[160:163]
    v_mfma_f32_16x16x32_bf16 v[164:167], v[92:95], v[112:115], v[164:167]
    s_waitcnt lgkmcnt(2)
    v_mfma_f32_16x16x32_bf16 v[148:151], v[120:123], v[128:131], v[148:151]
    s_nop 5
    v_rcp_f32 v166, v166
    s_nop 0
    v_mul_f32 v160, v160, v166
    v_mul_f32 v161, v161, v166
    v_mul_f32 v162, v162, v166
    v_mul_f32 v163, v163, v166
    v_mul_f32 v164, v164, v166
    v_mul_f32 v165, v165, v166
    v_cvt_pk_bf16_f32 v62, v160, v161
    s_waitcnt lgkmcnt(1)
    v_mfma_f32_16x16x32_bf16 v[152:155], v[132:135], v[128:131], v[152:155]
    v_cvt_pk_bf16_f32 v63, v162, v163
    v_cvt_pk_bf16_f32 v64, v164, v165
    s_waitcnt lgkmcnt(0)
    v_mfma_f32_16x16x32_bf16 v[156:159], v[140:143], v[128:131], v[156:159]
    ds_read_b128 v[140:143], v4 offset:51200
    s_nop 6
    ds_read_b64_tr_b16 v[158:159], v3 offset:10048
    s_waitcnt vmcnt(2)
    v_lshlrev_b32 v66, 16, v124
    v_fmamk_f32 v144, v66, 0x3fb8aa3b, v144
    v_and_b32 v66, 0xffff0000, v124
    v_fmamk_f32 v145, v66, 0x3fb8aa3b, v145
    v_lshlrev_b32 v66, 16, v125
    v_fmamk_f32 v146, v66, 0x3fb8aa3b, v146
    v_and_b32 v66, 0xffff0000, v125
    v_fmamk_f32 v147, v66, 0x3fb8aa3b, v147
    s_waitcnt vmcnt(1)
    v_lshlrev_b32 v66, 16, v126
    v_fmamk_f32 v148, v66, 0x3fb8aa3b, v148
    v_and_b32 v66, 0xffff0000, v126
    v_fmamk_f32 v149, v66, 0x3fb8aa3b, v149
    v_lshlrev_b32 v66, 16, v127
    v_fmamk_f32 v150, v66, 0x3fb8aa3b, v150
    v_and_b32 v66, 0xffff0000, v127
    v_fmamk_f32 v151, v66, 0x3fb8aa3b, v151
    s_waitcnt vmcnt(0)
    v_lshlrev_b32 v66, 16, v54
    v_fmamk_f32 v152, v66, 0x3fb8aa3b, v152
    v_and_b32 v66, 0xffff0000, v54
    v_fmamk_f32 v153, v66, 0x3fb8aa3b, v153
    v_lshlrev_b32 v66, 16, v55
    v_fmamk_f32 v154, v66, 0x3fb8aa3b, v154
    v_max3_f32 v67, v144, v145, v146
    v_and_b32 v66, 0xffff0000, v55
    v_max3_f32 v67, v67, v147, v148
    v_fmamk_f32 v155, v66, 0x3fb8aa3b, v155
    v_max3_f32 v67, v67, v149, v150
    v_lshlrev_b32 v66, 16, v53
    v_max3_f32 v67, v67, v151, v152
    v_fmamk_f32 v156, v66, 0x3fb8aa3b, v156
    v_max3_f32 v67, v67, v153, v154
    v_max3_f32 v67, v67, v155, v156
    v_mov_b32 v77, v67
    s_nop 1
    v_permlane32_swap_b32 v67, v77
    v_max_f32 v67, v67, v77
    v_mov_b32 v77, v67
    s_nop 1
    v_permlane16_swap_b32 v67, v77
    v_max_f32 v67, v67, v77
    v_sub_f32 v144, v144, v67
    v_sub_f32 v145, v145, v67
    v_sub_f32 v146, v146, v67
    v_sub_f32 v147, v147, v67
    v_exp_f32 v144, v144
    v_exp_f32 v145, v145
    v_exp_f32 v146, v146
    v_exp_f32 v147, v147
    v_cvt_pk_bf16_f32 v136, v144, v145
    ds_read_b64_tr_b16 v[144:145], v3 offset:288
    v_cvt_pk_bf16_f32 v137, v146, v147
    ds_read_b64_tr_b16 v[146:147], v3 offset:10016
    v_sub_f32 v148, v148, v67
    v_sub_f32 v149, v149, v67
    v_sub_f32 v150, v150, v67
    v_sub_f32 v151, v151, v67
    v_exp_f32 v148, v148
    v_exp_f32 v149, v149
    v_exp_f32 v150, v150
    v_exp_f32 v151, v151
    v_sub_f32 v152, v152, v67
    v_sub_f32 v153, v153, v67
    v_sub_f32 v154, v154, v67
    v_sub_f32 v155, v155, v67
    v_cvt_pk_bf16_f32 v138, v148, v149
    ds_read_b64_tr_b16 v[148:149], v3 offset:19744
    v_cvt_pk_bf16_f32 v139, v150, v151
    ds_read_b64_tr_b16 v[150:151], v3 offset:29472
    v_exp_f32 v152, v152
    v_mfma_f32_16x16x32_bf16 v[160:163], v[80:83], v[136:139], 0
    v_exp_f32 v153, v153
    v_mfma_f32_16x16x32_bf16 v[164:167], v[88:91], v[136:139], 0
    v_exp_f32 v154, v154
    v_exp_f32 v155, v155
    v_sub_f32 v156, v156, v67
    v_cvt_pk_bf16_f32 v112, v152, v153
    s_waitcnt lgkmcnt(2)
    v_mfma_f32_16x16x32_bf16 v[104:107], v[144:147], v[8:11], 0
    ds_read_b64_tr_b16 v[152:153], v3 offset:39200
    v_cvt_pk_bf16_f32 v113, v154, v155
    v_mfma_f32_16x16x32_bf16 v[116:119], v[144:147], v[20:23], 0
    ds_read_b64_tr_b16 v[154:155], v3 offset:48928
    v_exp_f32 v156, v156
    v_mfma_f32_16x16x32_bf16 v[128:131], v[144:147], v[32:35], 0
    ds_read_b64_tr_b16 v[144:145], v3 offset:19776
    ds_read_b64_tr_b16 v[146:147], v3 offset:29504
    v_cvt_pk_bf16_f32 v114, v156, 0
    ds_read_b64_tr_b16 v[156:157], v3 offset:320
    s_nop 0
    v_mfma_f32_16x16x32_bf16 v[160:163], v[84:87], v[112:115], v[160:163]
    ds_read_u16 v86, v6 offset:736
    s_waitcnt lgkmcnt(6)
    v_mfma_f32_16x16x32_bf16 v[104:107], v[148:151], v[12:15], v[104:107]
    v_mfma_f32_16x16x32_bf16 v[116:119], v[148:151], v[24:27], v[116:119]
    v_mfma_f32_16x16x32_bf16 v[128:131], v[148:151], v[36:39], v[128:131]
    ds_read_b64_tr_b16 v[148:149], v3 offset:39232
    ds_read_b64_tr_b16 v[150:151], v3 offset:48960
    v_mfma_f32_16x16x32_bf16 v[164:167], v[92:95], v[112:115], v[164:167]
    s_waitcnt lgkmcnt(6)
    v_mfma_f32_16x16x32_bf16 v[104:107], v[152:155], v[16:19], v[104:107]
    s_nop 5
    v_rcp_f32 v166, v166
    v_mfma_f32_16x16x32_bf16 v[116:119], v[152:155], v[28:31], v[116:119]
    v_mul_f32 v160, v160, v166
    v_mul_f32 v161, v161, v166
    v_mfma_f32_16x16x32_bf16 v[128:131], v[152:155], v[40:43], v[128:131]
    ds_read_b64_tr_b16 v[152:153], v3 offset:352
    ds_read_b64_tr_b16 v[154:155], v3 offset:10080
    s_waitcnt lgkmcnt(5)
    v_mfma_f32_16x16x32_bf16 v[108:111], v[156:159], v[8:11], 0
    v_mul_f32 v162, v162, v166
    v_mul_f32 v163, v163, v166
    v_mfma_f32_16x16x32_bf16 v[120:123], v[156:159], v[20:23], 0
    v_cvt_pk_bf16_f32 v74, v160, v161
    v_cvt_pk_bf16_f32 v75, v162, v163
    v_mfma_f32_16x16x32_bf16 v[132:135], v[156:159], v[32:35], 0
    ds_read_b64_tr_b16 v[156:157], v3 offset:19808
    ds_read_b64_tr_b16 v[158:159], v3 offset:29536
    v_mfma_f32_16x16x32_bf16 v[108:111], v[144:147], v[12:15], v[108:111]
    v_fma_f32 v160, v104, v104, s36
    v_fma_f32 v162, v116, v116, s36
    v_mfma_f32_16x16x32_bf16 v[120:123], v[144:147], v[24:27], v[120:123]
    v_fmac_f32 v160, v105, v105
    v_fmac_f32 v162, v117, v117
    v_mfma_f32_16x16x32_bf16 v[132:135], v[144:147], v[36:39], v[132:135]
    ds_read_b64_tr_b16 v[144:145], v3 offset:39264
    ds_read_b64_tr_b16 v[146:147], v3 offset:48992
    s_waitcnt lgkmcnt(6)
    v_mfma_f32_16x16x32_bf16 v[108:111], v[148:151], v[16:19], v[108:111]
    v_mul_f32 v164, v164, v166
    v_mul_f32 v165, v165, v166
    v_mfma_f32_16x16x32_bf16 v[120:123], v[148:151], v[28:31], v[120:123]
    ds_read_b64_tr_b16 v[166:167], v3 offset:29728
    v_fmac_f32 v160, v106, v106
    v_mfma_f32_16x16x32_bf16 v[132:135], v[148:151], v[40:43], v[132:135]
    v_fmac_f32 v162, v118, v118
    s_nop 0
    v_fma_f32 v161, v110, v110, s36
    s_waitcnt lgkmcnt(5)
    v_mfma_f32_16x16x32_bf16 v[112:115], v[152:155], v[8:11], 0
    v_fmac_f32 v161, v111, v111
    v_fma_f32 v163, v122, v122, s36
    v_mfma_f32_16x16x32_bf16 v[124:127], v[152:155], v[20:23], 0
    v_fmac_f32 v163, v123, v123
    v_cvt_pk_bf16_f32 v76, v164, v165
    v_mfma_f32_16x16x32_bf16 v[136:139], v[152:155], v[32:35], 0
    v_fmac_f32 v160, v107, v107
    v_fmac_f32 v162, v119, v119
    s_waitcnt lgkmcnt(3)
    v_mfma_f32_16x16x32_bf16 v[112:115], v[156:159], v[12:15], v[112:115]
    v_fmac_f32 v160, v108, v108
    v_fmac_f32 v162, v120, v120
    v_mfma_f32_16x16x32_bf16 v[124:127], v[156:159], v[24:27], v[124:127]
    v_fma_f32 v164, v128, v128, s36
    v_fma_f32 v165, v134, v134, s36
    v_mfma_f32_16x16x32_bf16 v[136:139], v[156:159], v[36:39], v[136:139]
    ds_read_b128 v[156:159], v4 offset:50176
    v_fmac_f32 v160, v109, v109
    s_waitcnt lgkmcnt(2)
    v_mfma_f32_16x16x32_bf16 v[112:115], v[144:147], v[16:19], v[112:115]
    v_fmac_f32 v162, v121, v121
    v_fmac_f32 v164, v129, v129
    v_mfma_f32_16x16x32_bf16 v[124:127], v[144:147], v[28:31], v[124:127]
    v_fmac_f32 v165, v135, v135
    v_fmac_f32 v164, v130, v130
    v_mfma_f32_16x16x32_bf16 v[136:139], v[144:147], v[40:43], v[136:139]
    ds_read_b32 v147, v5 offset:896
    s_nop 0
    v_fmac_f32 v161, v112, v112
    v_fmac_f32 v161, v113, v113
    v_fmac_f32 v161, v114, v114
    v_fmac_f32 v161, v115, v115
    v_fmac_f32 v163, v124, v124
    v_fmac_f32 v163, v125, v125
    v_fmac_f32 v163, v126, v126
    v_fmac_f32 v163, v127, v127
    v_fmac_f32 v165, v136, v136
    v_cvt_pk_bf16_f32 v144, v160, v161
    ds_read_b64_tr_b16 v[160:161], v3 offset:544
    v_cvt_pk_bf16_f32 v145, v162, v163
    ds_read_b64_tr_b16 v[162:163], v3 offset:10272
    v_fmac_f32 v164, v131, v131
    v_fmac_f32 v165, v137, v137
    v_fmac_f32 v164, v132, v132
    v_fmac_f32 v165, v138, v138
    v_fmac_f32 v164, v133, v133
    v_fmac_f32 v165, v139, v139
    v_cvt_pk_bf16_f32 v146, v164, v165
    ds_read_b64_tr_b16 v[164:165], v3 offset:20000
    s_setprio 0
    s_waitcnt lgkmcnt(3)
    v_mfma_f32_16x16x32_bf16 v[148:151], v[156:159], v[144:147], 0
    ds_read_b64_tr_b16 v[156:157], v3 offset:39456
    ds_read_b64_tr_b16 v[158:159], v3 offset:49184
    v_mfma_f32_16x16x32_bf16 v[152:155], v[140:143], v[144:147], 0
    ds_read_b128 v[140:143], v5 offset:384
    s_nop 3
    v_rsq_f32 v148, v148
    s_waitcnt lgkmcnt(4)
    v_mfma_f32_16x16x32_bf16 v[144:147], v[8:11], v[160:163], 0
    v_rsq_f32 v152, v152
    v_rsq_f32 v153, v153
    v_mul_f32 v152, s35, v152
    v_mul_f32 v128, v128, v152
    s_waitcnt lgkmcnt(3)
    v_mfma_f32_16x16x32_bf16 v[144:147], v[12:15], v[164:167], v[144:147]
    v_mul_f32 v129, v129, v152
    v_mul_f32 v130, v130, v152
    v_mul_f32 v131, v131, v152
    v_mul_f32 v132, v132, v152
    v_mul_f32 v133, v133, v152
    v_mul_f32 v134, v134, v153
    v_mul_f32 v135, v135, v153
    v_mul_f32 v136, v136, v153
    v_mul_f32 v137, v137, v153
    v_mul_f32 v138, v138, v153
    v_mul_f32 v139, v139, v153
    v_mfma_f32_16x16x32_bf16 v[152:155], v[32:35], v[160:163], 0
    v_rsq_f32 v150, v150
    v_mfma_f32_16x16x32_bf16 v[152:155], v[36:39], v[164:167], v[152:155]
    v_mul_f32 v148, s35, v148
    v_rsq_f32 v149, v149
    s_waitcnt lgkmcnt(1)
    v_mfma_f32_16x16x32_bf16 v[152:155], v[40:43], v[156:159], v[152:155]
    v_bfe_u32 v43, v4, 4, 6
    v_min_u32 v43, 48, v43
    v_mfma_f32_16x16x32_bf16 v[144:147], v[16:19], v[156:159], v[144:147]
    v_lshl_add_u32 v43, v43, 1, s44
    buffer_load_ushort v38, v43, s[20:23], s57 offen offset:608
    v_mul_f32 v150, s35, v150
    v_rsq_f32 v151, v151
    v_mul_f32 v104, v104, v148
    v_mul_f32 v105, v105, v148
    v_mul_f32 v116, v116, v150
    v_mul_f32 v117, v117, v150
    v_mul_f32 v106, v106, v148
    v_mul_f32 v107, v107, v148
    v_cvt_pk_bf16_f32 v104, v104, v105
    v_mul_f32 v118, v118, v150
    v_mul_f32 v119, v119, v150
    v_cvt_pk_bf16_f32 v116, v116, v117
    v_mul_f32 v108, v108, v148
    v_mul_f32 v109, v109, v148
    v_mul_f32 v110, v110, v149
    v_mul_f32 v111, v111, v149
    v_mul_f32 v112, v112, v149
    v_mul_f32 v113, v113, v149
    v_mul_f32 v114, v114, v149
    v_mul_f32 v115, v115, v149
    v_cvt_pk_bf16_f32 v105, v106, v107
    ds_read_b32 v107, v5 offset:896
    v_mul_f32 v120, v120, v150
    v_mul_f32 v121, v121, v150
    v_mul_f32 v122, v122, v151
    v_mul_f32 v123, v123, v151
    v_mul_f32 v124, v124, v151
    v_mul_f32 v125, v125, v151
    v_mul_f32 v126, v126, v151
    v_mul_f32 v127, v127, v151
    v_mfma_f32_16x16x32_bf16 v[148:151], v[20:23], v[160:163], 0
    ds_read_b128 v[160:163], v5 offset:448
    v_cvt_pk_bf16_f32 v117, v118, v119
    v_mfma_f32_16x16x32_bf16 v[148:151], v[24:27], v[164:167], v[148:151]
    ds_read_b32 v164, v4 offset:49164
    ds_read_b32 v119, v5 offset:896
    v_mfma_f32_16x16x32_bf16 v[148:151], v[28:31], v[156:159], v[148:151]
    v_cvt_pk_bf16_f32 v106, v108, v109
    v_cvt_pk_bf16_f32 v118, v120, v121
    v_cvt_pk_bf16_f32 v108, v110, v111
    ds_read_b32 v111, v5 offset:896
    v_cvt_pk_bf16_f32 v120, v122, v123
    ds_read_b32 v123, v5 offset:896
    v_cvt_pk_bf16_f32 v128, v128, v129
    v_cvt_pk_bf16_f32 v129, v130, v131
    ds_read_b32 v131, v5 offset:896
    v_cvt_pk_bf16_f32 v130, v132, v133
    v_cvt_pk_bf16_f32 v132, v134, v135
    ds_read_b32 v135, v5 offset:896
    v_cvt_pk_bf16_f32 v109, v112, v113
    v_cvt_pk_bf16_f32 v110, v114, v115
    ds_read_b32 v115, v5 offset:896
    v_cvt_pk_bf16_f32 v121, v124, v125
    v_cvt_pk_bf16_f32 v122, v126, v127
    v_cvt_pk_bf16_f32 v80, v144, v145
    v_cvt_pk_bf16_f32 v81, v146, v147
    v_cvt_pk_bf16_f32 v82, v148, v149
    v_cvt_pk_bf16_f32 v83, v150, v151
    v_cvt_pk_bf16_f32 v133, v136, v137
    v_cvt_pk_bf16_f32 v134, v138, v139
    v_cvt_pk_bf16_f32 v84, v152, v153
    v_cvt_pk_bf16_f32 v85, v154, v155
    v_bfe_u32 v39, v4, 8, 2
L_poll1s:
    v_mov_b32 v42, 136228
    ds_read_b32 v42, v42 offset:0
    s_waitcnt lgkmcnt(0)
    v_readfirstlane_b32 s58, v42
    s_sub_u32 s65, s65, 1
    s_cbranch_scc1 L_poll1sx
    s_cmp_lt_u32 s58, 6
    s_cbranch_scc1 L_poll1s
L_poll1sx:
    v_mfma_f32_16x16x32_bf16 v[156:159], v[160:163], v[140:143], 0
    v_mfma_f32_16x16x32_bf16 v[144:147], v[160:163], v[108:111], 0
    v_mfma_f32_16x16x32_bf16 v[148:151], v[160:163], v[120:123], 0
    v_mfma_f32_16x16x32_bf16 v[152:155], v[160:163], v[132:135], 0
    s_nop 6
    v_mov_b32_dpp v144, v148 quad_perm:[0,1,2,3] row_mask:2 bank_mask:0xf
    ds_read_b128 v[148:151], v4 offset:37888
    s_nop 0
    v_mov_b32_dpp v144, v152 quad_perm:[0,1,2,3] row_mask:4 bank_mask:0xf
    ds_read_b128 v[152:155], v4 offset:38912
    s_nop 0
    v_mov_b32_dpp v144, v156 quad_perm:[0,1,2,3] row_mask:8 bank_mask:0xf
    ds_read_b32 v156, v4 offset:39936
    v_add_f32 v144, v144, v164
    s_waitcnt lgkmcnt(2)
    v_mfma_f32_16x16x32_bf16 v[148:151], v[120:123], v[104:107], v[148:151]
    s_waitcnt lgkmcnt(1)
    v_mfma_f32_16x16x32_bf16 v[152:155], v[132:135], v[104:107], v[152:155]
    s_waitcnt lgkmcnt(0)
    v_mfma_f32_16x16x32_bf16 v[156:159], v[140:143], v[104:107], v[156:159]
    s_waitcnt vmcnt(0)
    v_lshlrev_b32 v43, 16, v38
    v_fmamk_f32 v144, v43, 0x3fb8aa3b, v144
    v_bfe_u32 v43, v4, 4, 4
    v_mul_u32_u24 v43, 0x62, v43
    v_add_u32 v43, s44, v43
    buffer_load_ushort v38, v43, s[20:23], 0 offen offset:96
    v_lshl_add_u32 v39, v39, 3, v43
    buffer_load_dwordx2 v[32:33], v39, s[20:23], 0 offen offset:0
    buffer_load_dwordx2 v[34:35], v39, s[20:23], 0 offen offset:32
    buffer_load_dwordx2 v[36:37], v39, s[20:23], 0 offen offset:64
    v_mov_b32 v124, v144
    v_bfe_u32 v39, v4, 8, 2
    s_nop 0
    v_max_f32_dpp v124, v124, v124 row_ror:8 row_mask:0xf bank_mask:0xf
    s_nop 1
    v_max_f32_dpp v124, v124, v124 row_ror:4 row_mask:0xf bank_mask:0xf
    s_nop 1
    v_max_f32_dpp v124, v124, v124 row_ror:2 row_mask:0xf bank_mask:0xf
    s_nop 1
    v_max_f32_dpp v124, v124, v124 row_ror:1 row_mask:0xf bank_mask:0xf
    v_mov_b32 v125, v124
    s_nop 1
    v_permlane32_swap_b32 v124, v125
    v_max_f32 v124, v124, v125
    v_mov_b32 v125, v124
    s_nop 1
    v_permlane16_swap_b32 v124, v125
    v_max_f32 v124, v124, v125
    v_sub_f32 v144, v144, v124
    v_exp_f32 v144, v144
    s_nop 0
    v_cvt_pk_bf16_f32 v144, v144, v144
    ds_write_b16 v7, v144 offset:0
    ds_read_b128 v[144:147], v4 offset:36864
    s_waitcnt lgkmcnt(1)
    ds_read_b128 v[136:139], v5 offset:768
    s_waitcnt lgkmcnt(1)
    v_mfma_f32_16x16x32_bf16 v[144:147], v[108:111], v[104:107], v[144:147]
    s_waitcnt lgkmcnt(0)
    ds_read_b128 v[112:115], v5 offset:832
    v_mfma_f32_16x16x32_bf16 v[160:163], v[80:83], v[136:139], 0
    v_mfma_f32_16x16x32_bf16 v[164:167], v[96:99], v[136:139], 0
    s_waitcnt lgkmcnt(0)
    v_mfma_f32_16x16x32_bf16 v[160:163], v[84:87], v[112:115], v[160:163]
    v_mfma_f32_16x16x32_bf16 v[164:167], v[100:103], v[112:115], v[164:167]
    s_nop 6
    ds_write_b128 v5, v[160:163] offset:1408
    s_waitcnt lgkmcnt(0)
    ds_write_b128 v5, v[164:167] offset:1472
    v_mov_b32 v40, 136232
    v_mov_b32 v41, 1
    s_mov_b64 exec, 1
    ds_add_u32 v40, v41
    s_mov_b64 exec, -1
    v_subrev_u32 v40, 79872, v4
    v_lshrrev_b32 v41, 6, v40
    v_mul_u32_u24 v41, 224, v41
    v_bfe_u32 v40, v40, 4, 2
    v_lshl_add_u32 v41, v40, 3, v41
    v_add_u32 v3, 58368, v41
    s_waitcnt vmcnt(2)
    v_lshlrev_b32 v43, 16, v32
    v_fmamk_f32 v144, v43, 0x3fb8aa3b, v144
    v_and_b32 v43, 0xffff0000, v32
    v_fmamk_f32 v145, v43, 0x3fb8aa3b, v145
    v_lshlrev_b32 v43, 16, v33
    v_fmamk_f32 v146, v43, 0x3fb8aa3b, v146
    v_and_b32 v43, 0xffff0000, v33
    v_fmamk_f32 v147, v43, 0x3fb8aa3b, v147
    s_waitcnt vmcnt(1)
    v_lshlrev_b32 v43, 16, v34
    v_fmamk_f32 v148, v43, 0x3fb8aa3b, v148
    v_and_b32 v43, 0xffff0000, v34
    v_fmamk_f32 v149, v43, 0x3fb8aa3b, v149
    v_lshlrev_b32 v43, 16, v35
    v_fmamk_f32 v150, v43, 0x3fb8aa3b, v150
    v_and_b32 v43, 0xffff0000, v35
    v_fmamk_f32 v151, v43, 0x3fb8aa3b, v151
    s_waitcnt vmcnt(0)
    v_lshlrev_b32 v43, 16, v36
    v_fmamk_f32 v152, v43, 0x3fb8aa3b, v152
    v_and_b32 v43, 0xffff0000, v36
    v_fmamk_f32 v153, v43, 0x3fb8aa3b, v153
    v_lshlrev_b32 v43, 16, v37
    v_fmamk_f32 v154, v43, 0x3fb8aa3b, v154
    v_and_b32 v43, 0xffff0000, v37
    v_fmamk_f32 v155, v43, 0x3fb8aa3b, v155
    v_lshlrev_b32 v43, 16, v38
    v_fmamk_f32 v156, v43, 0x3fb8aa3b, v156
    v_bfe_u32 v43, v4, 4, 4
    v_add_u32 v43, 16, v43
    v_mul_u32_u24 v43, 0x62, v43
    v_add_u32 v43, s44, v43
    buffer_load_ushort v38, v43, s[20:23], 0 offen offset:96
    v_lshl_add_u32 v39, v39, 3, v43
    buffer_load_dwordx2 v[32:33], v39, s[20:23], 0 offen offset:0
    buffer_load_dwordx2 v[34:35], v39, s[20:23], 0 offen offset:32
    buffer_load_dwordx2 v[36:37], v39, s[20:23], 0 offen offset:64
    v_max3_f32 v124, v144, v145, v146
    v_max3_f32 v124, v124, v147, v148
    v_max3_f32 v124, v124, v149, v150
    v_max3_f32 v124, v124, v151, v152
    v_max3_f32 v124, v124, v153, v154
    v_max3_f32 v124, v124, v155, v156
    v_mov_b32 v125, v124
    v_bfe_u32 v39, v4, 8, 2
    s_nop 0
    v_permlane32_swap_b32 v124, v125
    v_max_f32 v124, v124, v125
    v_mov_b32 v125, v124
    s_nop 1
    v_permlane16_swap_b32 v124, v125
    v_max_f32 v124, v124, v125
    v_sub_f32 v144, v144, v124
    v_sub_f32 v145, v145, v124
    v_sub_f32 v146, v146, v124
    v_sub_f32 v147, v147, v124
    v_exp_f32 v144, v144
    v_exp_f32 v145, v145
    v_exp_f32 v146, v146
    v_exp_f32 v147, v147
    v_cvt_pk_bf16_f32 v136, v144, v145
    v_cvt_pk_bf16_f32 v137, v146, v147
    ds_read_b128 v[144:147], v4 offset:40960
    v_sub_f32 v148, v148, v124
    v_sub_f32 v149, v149, v124
    v_sub_f32 v150, v150, v124
    v_sub_f32 v151, v151, v124
    v_exp_f32 v148, v148
    v_exp_f32 v149, v149
    v_exp_f32 v150, v150
    v_exp_f32 v151, v151
    v_cvt_pk_bf16_f32 v138, v148, v149
    v_cvt_pk_bf16_f32 v139, v150, v151
    ds_read_b128 v[148:151], v4 offset:41984
    v_sub_f32 v152, v152, v124
    v_mfma_f32_16x16x32_bf16 v[160:163], v[80:83], v[136:139], 0
    v_sub_f32 v153, v153, v124
    v_sub_f32 v154, v154, v124
    v_mfma_f32_16x16x32_bf16 v[164:167], v[96:99], v[136:139], 0
    v_sub_f32 v155, v155, v124
    v_exp_f32 v152, v152
    v_exp_f32 v153, v153
    v_exp_f32 v154, v154
    v_exp_f32 v155, v155
    v_cvt_pk_bf16_f32 v112, v152, v153
    v_cvt_pk_bf16_f32 v113, v154, v155
    ds_read_b128 v[152:155], v4 offset:43008
    s_waitcnt lgkmcnt(2)
    v_mfma_f32_16x16x32_bf16 v[144:147], v[108:111], v[116:119], v[144:147]
    v_sub_f32 v156, v156, v124
    v_exp_f32 v156, v156
    s_nop 0
    v_cvt_pk_bf16_f32 v114, v156, 0
    ds_read_b32 v156, v4 offset:44032
    s_nop 0
    v_mfma_f32_16x16x32_bf16 v[160:163], v[84:87], v[112:115], v[160:163]
    v_mfma_f32_16x16x32_bf16 v[164:167], v[100:103], v[112:115], v[164:167]
    s_waitcnt lgkmcnt(2)
    v_mfma_f32_16x16x32_bf16 v[148:151], v[120:123], v[116:119], v[148:151]
    s_nop 5
    v_rcp_f32 v164, v164
    s_nop 0
    v_mul_f32 v160, v160, v164
    v_mul_f32 v161, v161, v164
    v_mul_f32 v162, v162, v164
    v_mul_f32 v163, v163, v164
    v_mul_f32 v166, v166, v164
    v_mul_f32 v167, v167, v164
    v_cvt_pk_bf16_f32 v53, v160, v161
    s_waitcnt lgkmcnt(1)
    v_mfma_f32_16x16x32_bf16 v[152:155], v[132:135], v[116:119], v[152:155]
    v_cvt_pk_bf16_f32 v54, v162, v163
    v_cvt_pk_bf16_f32 v55, v166, v167
    s_waitcnt lgkmcnt(0)
    v_mfma_f32_16x16x32_bf16 v[156:159], v[140:143], v[116:119], v[156:159]
    s_waitcnt vmcnt(2)
    v_lshlrev_b32 v43, 16, v32
    v_fmamk_f32 v144, v43, 0x3fb8aa3b, v144
    v_and_b32 v43, 0xffff0000, v32
    v_fmamk_f32 v145, v43, 0x3fb8aa3b, v145
    v_lshlrev_b32 v43, 16, v33
    v_fmamk_f32 v146, v43, 0x3fb8aa3b, v146
    v_and_b32 v43, 0xffff0000, v33
    v_fmamk_f32 v147, v43, 0x3fb8aa3b, v147
    s_waitcnt vmcnt(1)
    v_lshlrev_b32 v43, 16, v34
    v_fmamk_f32 v148, v43, 0x3fb8aa3b, v148
    v_and_b32 v43, 0xffff0000, v34
    v_fmamk_f32 v149, v43, 0x3fb8aa3b, v149
    v_lshlrev_b32 v43, 16, v35
    v_fmamk_f32 v150, v43, 0x3fb8aa3b, v150
    v_and_b32 v43, 0xffff0000, v35
    v_fmamk_f32 v151, v43, 0x3fb8aa3b, v151
    s_waitcnt vmcnt(0)
    v_lshlrev_b32 v43, 16, v36
    v_fmamk_f32 v152, v43, 0x3fb8aa3b, v152
    v_and_b32 v43, 0xffff0000, v36
    v_fmamk_f32 v153, v43, 0x3fb8aa3b, v153
    v_lshlrev_b32 v43, 16, v37
    v_fmamk_f32 v154, v43, 0x3fb8aa3b, v154
    v_and_b32 v43, 0xffff0000, v37
    v_fmamk_f32 v155, v43, 0x3fb8aa3b, v155
    v_lshlrev_b32 v43, 16, v38
    v_fmamk_f32 v156, v43, 0x3fb8aa3b, v156
    v_bfe_u32 v43, v4, 4, 4
    v_add_u32 v43, 32, v43
    v_mul_u32_u24 v43, 0x62, v43
    v_add_u32 v43, s44, v43
    buffer_load_ushort v38, v43, s[20:23], 0 offen offset:96
    v_lshl_add_u32 v39, v39, 3, v43
    buffer_load_dwordx2 v[32:33], v39, s[20:23], 0 offen offset:0
    buffer_load_dwordx2 v[34:35], v39, s[20:23], 0 offen offset:32
    buffer_load_dwordx2 v[36:37], v39, s[20:23], 0 offen offset:64
    v_max3_f32 v124, v144, v145, v146
    v_max3_f32 v124, v124, v147, v148
    v_max3_f32 v124, v124, v149, v150
    v_max3_f32 v124, v124, v151, v152
    v_max3_f32 v124, v124, v153, v154
    v_max3_f32 v124, v124, v155, v156
    v_mov_b32 v125, v124
    s_nop 1
    v_permlane32_swap_b32 v124, v125
    v_max_f32 v124, v124, v125
    v_mov_b32 v125, v124
    s_nop 1
    v_permlane16_swap_b32 v124, v125
    v_max_f32 v124, v124, v125
    v_sub_f32 v144, v144, v124
    v_sub_f32 v145, v145, v124
    v_sub_f32 v146, v146, v124
    v_sub_f32 v147, v147, v124
    v_exp_f32 v144, v144
    v_exp_f32 v145, v145
    v_exp_f32 v146, v146
    v_exp_f32 v147, v147
    v_cvt_pk_bf16_f32 v136, v144, v145
    v_cvt_pk_bf16_f32 v137, v146, v147
    ds_read_b128 v[144:147], v4 offset:45056
    v_sub_f32 v148, v148, v124
    v_sub_f32 v149, v149, v124
    v_sub_f32 v150, v150, v124
    v_sub_f32 v151, v151, v124
    v_exp_f32 v148, v148
    v_exp_f32 v149, v149
    v_exp_f32 v150, v150
    v_exp_f32 v151, v151
    v_cvt_pk_bf16_f32 v138, v148, v149
    v_cvt_pk_bf16_f32 v139, v150, v151
    ds_read_b128 v[148:151], v4 offset:46080
    v_sub_f32 v152, v152, v124
    v_mfma_f32_16x16x32_bf16 v[160:163], v[80:83], v[136:139], 0
    v_sub_f32 v153, v153, v124
    v_sub_f32 v154, v154, v124
    v_mfma_f32_16x16x32_bf16 v[164:167], v[96:99], v[136:139], 0
    v_sub_f32 v155, v155, v124
    v_exp_f32 v152, v152
    v_exp_f32 v153, v153
    v_exp_f32 v154, v154
    v_exp_f32 v155, v155
    v_cvt_pk_bf16_f32 v112, v152, v153
    v_cvt_pk_bf16_f32 v113, v154, v155
    ds_read_b128 v[152:155], v4 offset:47104
    s_waitcnt lgkmcnt(2)
    v_mfma_f32_16x16x32_bf16 v[144:147], v[108:111], v[128:131], v[144:147]
    v_sub_f32 v156, v156, v124
    v_exp_f32 v156, v156
    s_nop 0
    v_cvt_pk_bf16_f32 v114, v156, 0
    ds_read_b32 v156, v4 offset:48128
    s_nop 0
    v_mfma_f32_16x16x32_bf16 v[160:163], v[84:87], v[112:115], v[160:163]
    v_mfma_f32_16x16x32_bf16 v[164:167], v[100:103], v[112:115], v[164:167]
    s_waitcnt lgkmcnt(2)
    v_mfma_f32_16x16x32_bf16 v[148:151], v[120:123], v[128:131], v[148:151]
    s_nop 5
    v_rcp_f32 v164, v164
    s_nop 0
    v_mul_f32 v166, v166, v164
    v_mul_f32 v167, v167, v164
    v_mul_f32 v160, v160, v164
    v_mul_f32 v161, v161, v164
    v_mul_f32 v162, v162, v164
    v_mul_f32 v163, v163, v164
    v_cvt_pk_bf16_f32 v67, v166, v167
    s_waitcnt lgkmcnt(1)
    v_mfma_f32_16x16x32_bf16 v[152:155], v[132:135], v[128:131], v[152:155]
    v_cvt_pk_bf16_f32 v65, v160, v161
    v_cvt_pk_bf16_f32 v66, v162, v163
    s_waitcnt lgkmcnt(0)
    v_mfma_f32_16x16x32_bf16 v[156:159], v[140:143], v[128:131], v[156:159]
    ds_read_b32 v141, v5 offset:896
    ds_read_b32 v142, v5 offset:896
    s_nop 5
    ds_read_b64_tr_b16 v[158:159], v3 offset:17952
    s_waitcnt vmcnt(2)
    v_lshlrev_b32 v43, 16, v32
    v_fmamk_f32 v144, v43, 0x3fb8aa3b, v144
    v_and_b32 v43, 0xffff0000, v32
    v_fmamk_f32 v145, v43, 0x3fb8aa3b, v145
    v_lshlrev_b32 v43, 16, v33
    v_fmamk_f32 v146, v43, 0x3fb8aa3b, v146
    v_and_b32 v43, 0xffff0000, v33
    ds_read_b64_tr_b16 v[32:33], v3 offset:0
    v_fmamk_f32 v147, v43, 0x3fb8aa3b, v147
    s_waitcnt vmcnt(1)
    v_lshlrev_b32 v43, 16, v34
    v_fmamk_f32 v148, v43, 0x3fb8aa3b, v148
    v_and_b32 v43, 0xffff0000, v34
    v_fmamk_f32 v149, v43, 0x3fb8aa3b, v149
    v_lshlrev_b32 v43, 16, v35
    v_fmamk_f32 v150, v43, 0x3fb8aa3b, v150
    v_and_b32 v43, 0xffff0000, v35
    ds_read_b64_tr_b16 v[34:35], v3 offset:3584
    v_fmamk_f32 v151, v43, 0x3fb8aa3b, v151
    s_waitcnt vmcnt(0)
    v_lshlrev_b32 v43, 16, v36
    v_fmamk_f32 v152, v43, 0x3fb8aa3b, v152
    v_and_b32 v43, 0xffff0000, v36
    v_fmamk_f32 v153, v43, 0x3fb8aa3b, v153
    v_lshlrev_b32 v43, 16, v37
    v_fmamk_f32 v154, v43, 0x3fb8aa3b, v154
    v_max3_f32 v124, v144, v145, v146
    v_and_b32 v43, 0xffff0000, v37
    ds_read_b64_tr_b16 v[36:37], v3 offset:7168
    v_max3_f32 v124, v124, v147, v148
    v_fmamk_f32 v155, v43, 0x3fb8aa3b, v155
    v_max3_f32 v124, v124, v149, v150
    v_lshlrev_b32 v43, 16, v38
    ds_read_b64_tr_b16 v[38:39], v3 offset:10752
    v_max3_f32 v124, v124, v151, v152
    v_fmamk_f32 v156, v43, 0x3fb8aa3b, v156
    ds_read_b128 v[40:43], v4 offset:50176
    v_max3_f32 v124, v124, v153, v154
    v_max3_f32 v124, v124, v155, v156
    v_mov_b32 v125, v124
    s_nop 1
    v_permlane32_swap_b32 v124, v125
    v_max_f32 v124, v124, v125
    v_mov_b32 v125, v124
    s_nop 1
    v_permlane16_swap_b32 v124, v125
    v_max_f32 v124, v124, v125
    v_sub_f32 v148, v148, v124
    v_sub_f32 v149, v149, v124
    s_waitcnt lgkmcnt(3)
    v_mfma_f32_16x16x32_bf16 v[8:11], v[32:35], v[44:47], 0
    v_sub_f32 v150, v150, v124
    v_sub_f32 v151, v151, v124
    v_mfma_f32_16x16x32_bf16 v[104:107], v[32:35], v[56:59], 0
    v_exp_f32 v148, v148
    v_exp_f32 v149, v149
    v_exp_f32 v150, v150
    v_exp_f32 v151, v151
    v_sub_f32 v144, v144, v124
    s_waitcnt lgkmcnt(1)
    v_mfma_f32_16x16x32_bf16 v[8:11], v[36:39], v[48:51], v[8:11]
    v_sub_f32 v145, v145, v124
    v_sub_f32 v146, v146, v124
    v_mfma_f32_16x16x32_bf16 v[104:107], v[36:39], v[60:63], v[104:107]
    v_sub_f32 v147, v147, v124
    v_sub_f32 v152, v152, v124
    v_sub_f32 v153, v153, v124
    v_sub_f32 v154, v154, v124
    v_sub_f32 v155, v155, v124
    v_cvt_pk_bf16_f32 v138, v148, v149
    ds_read_b64_tr_b16 v[148:149], v3 offset:32
    v_cvt_pk_bf16_f32 v139, v150, v151
    ds_read_b64_tr_b16 v[150:151], v3 offset:3616
    v_exp_f32 v144, v144
    v_exp_f32 v145, v145
    v_exp_f32 v146, v146
    v_exp_f32 v147, v147
    v_exp_f32 v152, v152
    v_exp_f32 v153, v153
    v_exp_f32 v154, v154
    v_exp_f32 v155, v155
    v_sub_f32 v156, v156, v124
    v_cvt_pk_bf16_f32 v136, v144, v145
    ds_read_b64_tr_b16 v[144:145], v3 offset:14336
    v_cvt_pk_bf16_f32 v137, v146, v147
    ds_read_b64_tr_b16 v[146:147], v3 offset:17920
    v_cvt_pk_bf16_f32 v112, v152, v153
    v_mfma_f32_16x16x32_bf16 v[164:167], v[96:99], v[136:139], 0
    ds_read_b64_tr_b16 v[152:153], v3 offset:7200
    v_cvt_pk_bf16_f32 v113, v154, v155
    v_mfma_f32_16x16x32_bf16 v[160:163], v[80:83], v[136:139], 0
    ds_read_b64_tr_b16 v[154:155], v3 offset:10784
    v_exp_f32 v156, v156
    v_mfma_f32_16x16x32_bf16 v[80:83], v[32:35], v[68:71], 0
    ds_read_b64_tr_b16 v[32:33], v3 offset:64
    ds_read_b64_tr_b16 v[34:35], v3 offset:3648
    v_mfma_f32_16x16x32_bf16 v[80:83], v[36:39], v[72:75], v[80:83]
    ds_read_b64_tr_b16 v[36:37], v3 offset:7232
    ds_read_b64_tr_b16 v[38:39], v3 offset:10816
    s_waitcnt lgkmcnt(8)
    v_mfma_f32_16x16x32_bf16 v[12:15], v[148:151], v[44:47], 0
    v_cvt_pk_bf16_f32 v114, v156, 0
    ds_read_b64_tr_b16 v[156:157], v3 offset:14368
    v_mfma_f32_16x16x32_bf16 v[108:111], v[148:151], v[56:59], 0
    v_mfma_f32_16x16x32_bf16 v[164:167], v[100:103], v[112:115], v[164:167]
    v_mfma_f32_16x16x32_bf16 v[160:163], v[84:87], v[112:115], v[160:163]
    v_mfma_f32_16x16x32_bf16 v[84:87], v[148:151], v[68:71], 0
    ds_read_b64_tr_b16 v[148:149], v3 offset:96
    ds_read_b64_tr_b16 v[150:151], v3 offset:3680
    s_waitcnt lgkmcnt(9)
    v_mfma_f32_16x16x32_bf16 v[8:11], v[144:147], v[52:55], v[8:11]
    s_nop 1
    v_rcp_f32 v164, v164
    v_mfma_f32_16x16x32_bf16 v[104:107], v[144:147], v[64:67], v[104:107]
    v_mul_f32 v160, v160, v164
    v_mul_f32 v161, v161, v164
    s_waitcnt lgkmcnt(7)
    v_mfma_f32_16x16x32_bf16 v[12:15], v[152:155], v[48:51], v[12:15]
    v_mul_f32 v162, v162, v164
    v_mul_f32 v163, v163, v164
    v_mfma_f32_16x16x32_bf16 v[108:111], v[152:155], v[60:63], v[108:111]
    v_mul_f32 v166, v166, v164
    v_mul_f32 v167, v167, v164
    v_mfma_f32_16x16x32_bf16 v[84:87], v[152:155], v[72:75], v[84:87]
    ds_read_b64_tr_b16 v[152:153], v3 offset:7264
    ds_read_b64_tr_b16 v[154:155], v3 offset:10848
    s_waitcnt lgkmcnt(4)
    v_mfma_f32_16x16x32_bf16 v[12:15], v[156:159], v[52:55], v[12:15]
    v_cvt_pk_bf16_f32 v77, v160, v161
    v_cvt_pk_bf16_f32 v78, v162, v163
    v_mfma_f32_16x16x32_bf16 v[108:111], v[156:159], v[64:67], v[108:111]
    v_cvt_pk_bf16_f32 v79, v166, v167
    v_fma_f32 v160, v8, v8, s37
    v_mfma_f32_16x16x32_bf16 v[16:19], v[32:35], v[44:47], 0
    v_fmac_f32 v160, v9, v9
    v_fmac_f32 v160, v10, v10
    v_mfma_f32_16x16x32_bf16 v[80:83], v[144:147], v[76:79], v[80:83]
    ds_read_b64_tr_b16 v[144:145], v3 offset:14400
    ds_read_b64_tr_b16 v[146:147], v3 offset:17984
    v_mfma_f32_16x16x32_bf16 v[84:87], v[156:159], v[76:79], v[84:87]
    ds_read_b64_tr_b16 v[156:157], v3 offset:14432
    ds_read_b64_tr_b16 v[158:159], v3 offset:18016
    v_mfma_f32_16x16x32_bf16 v[112:115], v[32:35], v[56:59], 0
    v_fmac_f32 v160, v11, v11
    v_fma_f32 v161, v104, v104, s37
    v_mfma_f32_16x16x32_bf16 v[88:91], v[32:35], v[68:71], 0
    ds_read_b64_tr_b16 v[32:33], v3 offset:128
    ds_read_b64_tr_b16 v[34:35], v3 offset:3712
    v_mfma_f32_16x16x32_bf16 v[16:19], v[36:39], v[48:51], v[16:19]
    v_fma_f32 v162, v80, v80, s37
    v_fmac_f32 v160, v12, v12
    v_mfma_f32_16x16x32_bf16 v[112:115], v[36:39], v[60:63], v[112:115]
    v_fmac_f32 v161, v105, v105
    v_fmac_f32 v162, v81, v81
    v_mfma_f32_16x16x32_bf16 v[88:91], v[36:39], v[72:75], v[88:91]
    ds_read_b64_tr_b16 v[36:37], v3 offset:7296
    ds_read_b64_tr_b16 v[38:39], v3 offset:10880
    s_waitcnt lgkmcnt(10)
    v_mfma_f32_16x16x32_bf16 v[20:23], v[148:151], v[44:47], 0
    v_fmac_f32 v160, v13, v13
    v_fmac_f32 v161, v106, v106
    v_mfma_f32_16x16x32_bf16 v[116:119], v[148:151], v[56:59], 0
    v_fmac_f32 v162, v82, v82
    v_fmac_f32 v160, v14, v14
    v_mfma_f32_16x16x32_bf16 v[92:95], v[148:151], v[68:71], 0
    ds_read_b64_tr_b16 v[148:149], v3 offset:160
    ds_read_b64_tr_b16 v[150:151], v3 offset:3744
    s_waitcnt lgkmcnt(8)
    v_mfma_f32_16x16x32_bf16 v[16:19], v[144:147], v[52:55], v[16:19]
    v_fmac_f32 v161, v107, v107
    v_fmac_f32 v162, v83, v83
    v_mfma_f32_16x16x32_bf16 v[112:115], v[144:147], v[64:67], v[112:115]
    v_fmac_f32 v160, v15, v15
    v_fmac_f32 v161, v108, v108
    v_mfma_f32_16x16x32_bf16 v[88:91], v[144:147], v[76:79], v[88:91]
    ds_read_b64_tr_b16 v[144:145], v3 offset:14464
    ds_read_b64_tr_b16 v[146:147], v3 offset:18048
    v_mfma_f32_16x16x32_bf16 v[20:23], v[152:155], v[48:51], v[20:23]
    v_fmac_f32 v162, v84, v84
    v_fmac_f32 v160, v16, v16
    v_mfma_f32_16x16x32_bf16 v[116:119], v[152:155], v[60:63], v[116:119]
    v_fmac_f32 v161, v109, v109
    v_fmac_f32 v162, v85, v85
    v_mfma_f32_16x16x32_bf16 v[92:95], v[152:155], v[72:75], v[92:95]
    ds_read_b64_tr_b16 v[152:153], v3 offset:7328
    ds_read_b64_tr_b16 v[154:155], v3 offset:10912
    s_waitcnt lgkmcnt(10)
    v_mfma_f32_16x16x32_bf16 v[20:23], v[156:159], v[52:55], v[20:23]
    v_fmac_f32 v160, v17, v17
    v_fmac_f32 v161, v110, v110
    v_mfma_f32_16x16x32_bf16 v[116:119], v[156:159], v[64:67], v[116:119]
    v_fmac_f32 v162, v86, v86
    v_fmac_f32 v160, v18, v18
    v_mfma_f32_16x16x32_bf16 v[92:95], v[156:159], v[76:79], v[92:95]
    ds_read_b64_tr_b16 v[156:157], v3 offset:14496
    ds_read_b64_tr_b16 v[158:159], v3 offset:18080
    s_waitcnt lgkmcnt(10)
    v_mfma_f32_16x16x32_bf16 v[24:27], v[32:35], v[44:47], 0
    v_fmac_f32 v161, v111, v111
    v_fmac_f32 v162, v87, v87
    v_mfma_f32_16x16x32_bf16 v[120:123], v[32:35], v[56:59], 0
    v_fmac_f32 v160, v19, v19
    v_fmac_f32 v161, v112, v112
    v_mfma_f32_16x16x32_bf16 v[96:99], v[32:35], v[68:71], 0
    ds_read_b32 v33, v5 offset:896
    ds_read_b32 v34, v5 offset:896
    s_waitcnt lgkmcnt(10)
    v_mfma_f32_16x16x32_bf16 v[24:27], v[36:39], v[48:51], v[24:27]
    ds_read_b32 v35, v5 offset:896
    v_fmac_f32 v162, v88, v88
    s_waitcnt lgkmcnt(9)
    v_mfma_f32_16x16x32_bf16 v[28:31], v[148:151], v[44:47], 0
    v_fmac_f32 v160, v20, v20
    v_fmac_f32 v161, v113, v113
    v_mfma_f32_16x16x32_bf16 v[120:123], v[36:39], v[60:63], v[120:123]
    v_fmac_f32 v162, v89, v89
    v_fmac_f32 v160, v21, v21
    v_mfma_f32_16x16x32_bf16 v[96:99], v[36:39], v[72:75], v[96:99]
    v_fmac_f32 v161, v114, v114
    v_fmac_f32 v162, v90, v90
    v_mfma_f32_16x16x32_bf16 v[124:127], v[148:151], v[56:59], 0
    v_fmac_f32 v160, v22, v22
    v_fmac_f32 v161, v115, v115
    v_mfma_f32_16x16x32_bf16 v[100:103], v[148:151], v[68:71], 0
    v_fmac_f32 v162, v91, v91
    v_fmac_f32 v160, v23, v23
    s_waitcnt lgkmcnt(7)
    v_mfma_f32_16x16x32_bf16 v[24:27], v[144:147], v[52:55], v[24:27]
    v_fmac_f32 v161, v116, v116
    v_fmac_f32 v162, v92, v92
    s_waitcnt lgkmcnt(5)
    v_mfma_f32_16x16x32_bf16 v[28:31], v[152:155], v[48:51], v[28:31]
    v_fmac_f32 v161, v117, v117
    v_fmac_f32 v162, v93, v93
    v_mfma_f32_16x16x32_bf16 v[120:123], v[144:147], v[64:67], v[120:123]
    v_fmac_f32 v161, v118, v118
    v_fmac_f32 v160, v24, v24
    v_mfma_f32_16x16x32_bf16 v[96:99], v[144:147], v[76:79], v[96:99]
    v_fmac_f32 v160, v25, v25
    v_fmac_f32 v162, v94, v94
    v_mfma_f32_16x16x32_bf16 v[124:127], v[152:155], v[60:63], v[124:127]
    v_fmac_f32 v160, v26, v26
    v_fmac_f32 v161, v119, v119
    v_mfma_f32_16x16x32_bf16 v[100:103], v[152:155], v[72:75], v[100:103]
    v_fmac_f32 v162, v95, v95
    v_fmac_f32 v160, v27, v27
    s_waitcnt lgkmcnt(3)
    v_mfma_f32_16x16x32_bf16 v[28:31], v[156:159], v[52:55], v[28:31]
    v_fmac_f32 v161, v120, v120
    v_fmac_f32 v162, v96, v96
    v_mfma_f32_16x16x32_bf16 v[124:127], v[156:159], v[64:67], v[124:127]
    v_fmac_f32 v161, v121, v121
    v_fmac_f32 v162, v97, v97
    v_mfma_f32_16x16x32_bf16 v[100:103], v[156:159], v[76:79], v[100:103]
    v_fmac_f32 v161, v122, v122
    s_nop 0
    v_fmac_f32 v160, v28, v28
    v_fmac_f32 v160, v29, v29
    v_fmac_f32 v162, v98, v98
    v_fmac_f32 v160, v30, v30
    v_fmac_f32 v161, v123, v123
    v_fmac_f32 v162, v99, v99
    v_fmac_f32 v160, v31, v31
    v_fmac_f32 v161, v124, v124
    v_fmac_f32 v162, v100, v100
    v_fmac_f32 v161, v125, v125
    v_fmac_f32 v162, v101, v101
    v_cvt_pk_bf16_f32 v32, v160, v160
    v_fmac_f32 v161, v126, v126
    v_fmac_f32 v162, v102, v102
    s_waitcnt lgkmcnt(0)
    v_mfma_f32_16x16x32_bf16 v[36:39], v[40:43], v[32:35], 0
    v_fmac_f32 v161, v127, v127
    v_fmac_f32 v162, v103, v103
    v_cvt_pk_bf16_f32 v140, v161, v162
    s_nop 1
    v_mfma_f32_16x16x32_bf16 v[164:167], v[40:43], v[140:143], 0
    s_nop 1
    v_rsq_f32 v36, v36
    s_nop 0
    v_mul_f32 v36, 0x411cc471, v36
    v_mul_f32 v8, v8, v36
    v_mul_f32 v9, v9, v36
    v_mul_f32 v10, v10, v36
    v_rsq_f32 v164, v164
    v_mul_f32 v11, v11, v36
    v_mul_f32 v16, v16, v36
    v_mul_f32 v17, v17, v36
    v_cvt_pk_bf16_f32 v8, v8, v9
    v_mul_f32 v12, v12, v36
    v_mul_f32 v13, v13, v36
    v_mul_f32 v14, v14, v36
    v_mul_f32 v15, v15, v36
    v_mul_f32 v18, v18, v36
    v_mul_f32 v19, v19, v36
    v_mul_f32 v24, v24, v36
    v_mul_f32 v25, v25, v36
    v_cvt_pk_bf16_f32 v9, v10, v11
    v_cvt_pk_bf16_f32 v16, v16, v17
    v_mul_f32 v164, 0x411cc471, v164
    v_rsq_f32 v165, v165
    v_mul_f32 v20, v20, v36
    v_mul_f32 v21, v21, v36
    v_mul_f32 v22, v22, v36
    v_mul_f32 v23, v23, v36
    v_mul_f32 v26, v26, v36
    v_mul_f32 v27, v27, v36
    v_cvt_pk_bf16_f32 v10, v12, v13
    v_cvt_pk_bf16_f32 v11, v14, v15
    v_cvt_pk_bf16_f32 v17, v18, v19
    v_cvt_pk_bf16_f32 v24, v24, v25
    v_mul_f32 v104, v104, v164
    v_mul_f32 v105, v105, v164
    v_mul_f32 v28, v28, v36
    v_mul_f32 v29, v29, v36
    v_mul_f32 v30, v30, v36
    v_mul_f32 v31, v31, v36
    buffer_store_dwordx4 v[8:11], v0, s[8:11], 0 offen offset:0 sc1
    v_cvt_pk_bf16_f32 v18, v20, v21
    v_cvt_pk_bf16_f32 v19, v22, v23
    v_cvt_pk_bf16_f32 v25, v26, v27
    v_mul_f32 v106, v106, v164
    v_mul_f32 v107, v107, v164
    v_mul_f32 v112, v112, v164
    v_mul_f32 v113, v113, v164
    v_cvt_pk_bf16_f32 v104, v104, v105
    buffer_store_dwordx4 v[16:19], v0, s[8:11], 0 offen offset:64 sc1
    v_cvt_pk_bf16_f32 v26, v28, v29
    v_cvt_pk_bf16_f32 v27, v30, v31
    v_mul_f32 v108, v108, v164
    v_mul_f32 v109, v109, v164
    v_mul_f32 v110, v110, v164
    v_mul_f32 v111, v111, v164
    v_mul_f32 v114, v114, v164
    v_mul_f32 v115, v115, v164
    v_mul_f32 v120, v120, v164
    v_mul_f32 v121, v121, v164
    v_cvt_pk_bf16_f32 v105, v106, v107
    v_cvt_pk_bf16_f32 v112, v112, v113
    v_mul_f32 v165, 0x411cc471, v165
    buffer_store_dwordx4 v[24:27], v0, s[8:11], 0 offen offset:128 sc1
    v_mul_f32 v116, v116, v164
    v_mul_f32 v117, v117, v164
    v_mul_f32 v118, v118, v164
    v_mul_f32 v119, v119, v164
    v_mul_f32 v122, v122, v164
    v_mul_f32 v123, v123, v164
    v_cvt_pk_bf16_f32 v106, v108, v109
    v_cvt_pk_bf16_f32 v107, v110, v111
    v_cvt_pk_bf16_f32 v113, v114, v115
    v_cvt_pk_bf16_f32 v120, v120, v121
    v_mul_f32 v80, v80, v165
    v_mul_f32 v81, v81, v165
    v_mul_f32 v124, v124, v164
    v_mul_f32 v125, v125, v164
    v_mul_f32 v126, v126, v164
    v_mul_f32 v127, v127, v164
    buffer_store_dwordx4 v[104:107], v1, s[8:11], 0 offen offset:0 sc1
    v_cvt_pk_bf16_f32 v114, v116, v117
    v_cvt_pk_bf16_f32 v115, v118, v119
    v_cvt_pk_bf16_f32 v121, v122, v123
    v_mul_f32 v82, v82, v165
    v_mul_f32 v83, v83, v165
    v_mul_f32 v88, v88, v165
    v_mul_f32 v89, v89, v165
    v_cvt_pk_bf16_f32 v80, v80, v81
    buffer_store_dwordx4 v[112:115], v1, s[8:11], 0 offen offset:64 sc1
    v_cvt_pk_bf16_f32 v122, v124, v125
    v_cvt_pk_bf16_f32 v123, v126, v127
    v_mul_f32 v84, v84, v165
    v_mul_f32 v85, v85, v165
    v_mul_f32 v86, v86, v165
    v_mul_f32 v87, v87, v165
    v_mul_f32 v90, v90, v165
    v_mul_f32 v91, v91, v165
    v_mul_f32 v96, v96, v165
    v_mul_f32 v97, v97, v165
    v_cvt_pk_bf16_f32 v81, v82, v83
    v_cvt_pk_bf16_f32 v88, v88, v89
    buffer_store_dwordx4 v[120:123], v1, s[8:11], 0 offen offset:128 sc1
    v_mul_f32 v92, v92, v165
    v_mul_f32 v93, v93, v165
    v_mul_f32 v94, v94, v165
    v_mul_f32 v95, v95, v165
    v_mul_f32 v98, v98, v165
    v_mul_f32 v99, v99, v165
    v_cvt_pk_bf16_f32 v82, v84, v85
    v_cvt_pk_bf16_f32 v83, v86, v87
    v_cvt_pk_bf16_f32 v89, v90, v91
    v_cvt_pk_bf16_f32 v96, v96, v97
    v_mul_f32 v100, v100, v165
    v_mul_f32 v101, v101, v165
    v_mul_f32 v102, v102, v165
    v_mul_f32 v103, v103, v165
    buffer_store_dwordx4 v[80:83], v2, s[8:11], 0 offen offset:0 sc1
    v_cvt_pk_bf16_f32 v90, v92, v93
    v_cvt_pk_bf16_f32 v91, v94, v95
    v_cvt_pk_bf16_f32 v97, v98, v99
    buffer_store_dwordx4 v[88:91], v2, s[8:11], 0 offen offset:64 sc1
    v_cvt_pk_bf16_f32 v98, v100, v101
    v_cvt_pk_bf16_f32 v99, v102, v103
    buffer_store_dwordx4 v[96:99], v2, s[8:11], 0 offen offset:128 sc1
    s_cmp_eq_u32 s3, 0
    s_cbranch_scc1 L_jo
    s_endpgm
L_end:
    s_endpgm
.section .rodata,"a"
.p2align 6
.amdhsa_kernel standalone__window_attn_swin_v2__vision_kernel
  .amdhsa_next_free_vgpr 168
  .amdhsa_next_free_sgpr 102
  .amdhsa_accum_offset 168
  .amdhsa_group_segment_fixed_size 0
  .amdhsa_kernarg_size 96
  .amdhsa_user_sgpr_count 2
  .amdhsa_user_sgpr_kernarg_segment_ptr 1
  .amdhsa_system_sgpr_workgroup_id_x 1
.end_amdhsa_kernel
.p2align 6
wtab:
    .short 0, 4, 32, 8, 12, 40, 16, 20, 48, 24, 28, 56, 96, 100, 128, 104
    .short 108, 136, 112, 116, 144, 120, 124, 152, 192, 196, 224, 200, 204, 232, 208, 212
    .short 240, 216, 220, 248, 288, 292, 320, 296, 300, 328, 304, 308, 336, 312, 316, 344
    .short 36, 64, 68, 44, 72, 76, 52, 80, 84, 60, 88, 92, 132, 160, 164, 140
    .short 168, 172, 148, 176, 180, 156, 184, 188, 228, 256, 260, 236, 264, 268, 244, 272
    .short 276, 252, 280, 284, 324, 352, 356, 332, 360, 364, 340, 368, 372, 348, 376, 380
    .short 384, 388, 416, 392, 396, 424, 400, 404, 432, 408, 412, 440, 448, 452, 420, 456
    .short 460, 428, 464, 468, 436, 472, 476, 444, 480, 484, 512, 488, 492, 520, 496, 500
    .short 528, 504, 508, 536, 544, 548, 516, 552, 556, 524, 560, 564, 532, 568, 572, 540
    .short 608, 612, 640, 616, 620, 648, 624, 628, 656, 632, 636, 664, 704, 708, 736, 712
    .short 716, 744, 720, 724, 752, 728, 732, 760, 800, 804, 832, 808, 812, 840, 816, 820
    .short 848, 824, 828, 856, 896, 900, 928, 904, 908, 936, 912, 916, 944, 920, 924, 952
    .short 644, 672, 676, 652, 680, 684, 660, 688, 692, 668, 696, 700, 740, 768, 772, 748
    .short 776, 780, 756, 784, 788, 764, 792, 796, 836, 864, 868, 844, 872, 876, 852, 880
    .short 884, 860, 888, 892, 932, 960, 964, 940, 968, 972, 948, 976, 980, 956, 984, 988
    .short 992, 996, 1024, 1000, 1004, 1032, 1008, 1012, 1040, 1016, 1020, 1048, 1056, 1060, 1028, 1064
    .short 1068, 1036, 1072, 1076, 1044, 1080, 1084, 1052, 1088, 1092, 1120, 1096, 1100, 1128, 1104, 1108
    .short 1136, 1112, 1116, 1144, 1152, 1156, 1124, 1160, 1164, 1132, 1168, 1172, 1140, 1176, 1180, 1148
    .short 1216, 1220, 1248, 1224, 1228, 1256, 1232, 1236, 1264, 1240, 1244, 1272, 1312, 1316, 1344, 1320
    .short 1324, 1352, 1328, 1332, 1360, 1336, 1340, 1368, 1408, 1412, 1440, 1416, 1420, 1448, 1424, 1428
    .short 1456, 1432, 1436, 1464, 1504, 1508, 1536, 1512, 1516, 1544, 1520, 1524, 1552, 1528, 1532, 1560
    .short 1252, 1280, 1284, 1260, 1288, 1292, 1268, 1296, 1300, 1276, 1304, 1308, 1348, 1376, 1380, 1356
    .short 1384, 1388, 1364, 1392, 1396, 1372, 1400, 1404, 1444, 1472, 1476, 1452, 1480, 1484, 1460, 1488
    .short 1492, 1468, 1496, 1500, 1540, 1568, 1572, 1548, 1576, 1580, 1556, 1584, 1588, 1564, 1592, 1596
    .short 1600, 1604, 1632, 1608, 1612, 1640, 1616, 1620, 1648, 1624, 1628, 1656, 1664, 1668, 1636, 1672
    .short 1676, 1644, 1680, 1684, 1652, 1688, 1692, 1660, 1696, 1700, 1728, 1704, 1708, 1736, 1712, 1716
    .short 1744, 1720, 1724, 1752, 1760, 1764, 1732, 1768, 1772, 1740, 1776, 1780, 1748, 1784, 1788, 1756
    .short 1824, 1828, 1856, 1832, 1836, 1864, 1840, 1844, 1872, 1848, 1852, 1880, 1920, 1924, 1952, 1928
    .short 1932, 1960, 1936, 1940, 1968, 1944, 1948, 1976, 2016, 2020, 2048, 2024, 2028, 2056, 2032, 2036
    .short 2064, 2040, 2044, 2072, 2112, 2116, 2144, 2120, 2124, 2152, 2128, 2132, 2160, 2136, 2140, 2168
    .short 1860, 1888, 1892, 1868, 1896, 1900, 1876, 1904, 1908, 1884, 1912, 1916, 1956, 1984, 1988, 1964
    .short 1992, 1996, 1972, 2000, 2004, 1980, 2008, 2012, 2052, 2080, 2084, 2060, 2088, 2092, 2068, 2096
    .short 2100, 2076, 2104, 2108, 2148, 2176, 2180, 2156, 2184, 2188, 2164, 2192, 2196, 2172, 2200, 2204
    .short 2208, 2212, 2240, 2216, 2220, 2248, 2224, 2228, 2256, 2232, 2236, 2264, 2272, 2276, 2244, 2280
    .short 2284, 2252, 2288, 2292, 2260, 2296, 2300, 2268, 2304, 2308, 2336, 2312, 2316, 2344, 2320, 2324
    .short 2352, 2328, 2332, 2360, 2368, 2372, 2340, 2376, 2380, 2348, 2384, 2388, 2356, 2392, 2396, 2364
    .short 9728, 9732, 9760, 9736, 9740, 9768, 9744, 9748, 9776, 9752, 9756, 9784, 9824, 9828, 9856, 9832
    .short 9836, 9864, 9840, 9844, 9872, 9848, 9852, 9880, 9920, 9924, 9952, 9928, 9932, 9960, 9936, 9940
    .short 9968, 9944, 9948, 9976, 10016, 10020, 10048, 10024, 10028, 10056, 10032, 10036, 10064, 10040, 10044, 10072
    .short 9764, 9792, 9796, 9772, 9800, 9804, 9780, 9808, 9812, 9788, 9816, 9820, 9860, 9888, 9892, 9868
    .short 9896, 9900, 9876, 9904, 9908, 9884, 9912, 9916, 9956, 9984, 9988, 9964, 9992, 9996, 9972, 10000
    .short 10004, 9980, 10008, 10012, 10052, 10080, 10084, 10060, 10088, 10092, 10068, 10096, 10100, 10076, 10104, 10108
    .short 10112, 10116, 10144, 10120, 10124, 10152, 10128, 10132, 10160, 10136, 10140, 10168, 10176, 10180, 10148, 10184
    .short 10188, 10156, 10192, 10196, 10164, 10200, 10204, 10172, 10208, 10212, 10240, 10216, 10220, 10248, 10224, 10228
    .short 10256, 10232, 10236, 10264, 10272, 10276, 10244, 10280, 10284, 10252, 10288, 10292, 10260, 10296, 10300, 10268
    .short 10336, 10340, 10368, 10344, 10348, 10376, 10352, 10356, 10384, 10360, 10364, 10392, 10432, 10436, 10464, 10440
    .short 10444, 10472, 10448, 10452, 10480, 10456, 10460, 10488, 10528, 10532, 10560, 10536, 10540, 10568, 10544, 10548
    .short 10576, 10552, 10556, 10584, 10624, 10628, 10656, 10632, 10636, 10664, 10640, 10644, 10672, 10648, 10652, 10680
    .short 10372, 10400, 10404, 10380, 10408, 10412, 10388, 10416, 10420, 10396, 10424, 10428, 10468, 10496, 10500, 10476
    .short 10504, 10508, 10484, 10512, 10516, 10492, 10520, 10524, 10564, 10592, 10596, 10572, 10600, 10604, 10580, 10608
    .short 10612, 10588, 10616, 10620, 10660, 10688, 10692, 10668, 10696, 10700, 10676, 10704, 10708, 10684, 10712, 10716
    .short 10720, 10724, 10752, 10728, 10732, 10760, 10736, 10740, 10768, 10744, 10748, 10776, 10784, 10788, 10756, 10792
    .short 10796, 10764, 10800, 10804, 10772, 10808, 10812, 10780, 10816, 10820, 10848, 10824, 10828, 10856, 10832, 10836
    .short 10864, 10840, 10844, 10872, 10880, 10884, 10852, 10888, 10892, 10860, 10896, 10900, 10868, 10904, 10908, 10876
    .short 10944, 10948, 10976, 10952, 10956, 10984, 10960, 10964, 10992, 10968, 10972, 11000, 11040, 11044, 11072, 11048
    .short 11052, 11080, 11056, 11060, 11088, 11064, 11068, 11096, 11136, 11140, 11168, 11144, 11148, 11176, 11152, 11156
    .short 11184, 11160, 11164, 11192, 11232, 11236, 11264, 11240, 11244, 11272, 11248, 11252, 11280, 11256, 11260, 11288
    .short 10980, 11008, 11012, 10988, 11016, 11020, 10996, 11024, 11028, 11004, 11032, 11036, 11076, 11104, 11108, 11084
    .short 11112, 11116, 11092, 11120, 11124, 11100, 11128, 11132, 11172, 11200, 11204, 11180, 11208, 11212, 11188, 11216
    .short 11220, 11196, 11224, 11228, 11268, 11296, 11300, 11276, 11304, 11308, 11284, 11312, 11316, 11292, 11320, 11324
    .short 11328, 11332, 11360, 11336, 11340, 11368, 11344, 11348, 11376, 11352, 11356, 11384, 11392, 11396, 11364, 11400
    .short 11404, 11372, 11408, 11412, 11380, 11416, 11420, 11388, 11424, 11428, 11456, 11432, 11436, 11464, 11440, 11444
    .short 11472, 11448, 11452, 11480, 11488, 11492, 11460, 11496, 11500, 11468, 11504, 11508, 11476, 11512, 11516, 11484
    .short 11552, 11556, 11584, 11560, 11564, 11592, 11568, 11572, 11600, 11576, 11580, 11608, 11648, 11652, 11680, 11656
    .short 11660, 11688, 11664, 11668, 11696, 11672, 11676, 11704, 11744, 11748, 11776, 11752, 11756, 11784, 11760, 11764
    .short 11792, 11768, 11772, 11800, 11840, 11844, 11872, 11848, 11852, 11880, 11856, 11860, 11888, 11864, 11868, 11896
    .short 11588, 11616, 11620, 11596, 11624, 11628, 11604, 11632, 11636, 11612, 11640, 11644, 11684, 11712, 11716, 11692
    .short 11720, 11724, 11700, 11728, 11732, 11708, 11736, 11740, 11780, 11808, 11812, 11788, 11816, 11820, 11796, 11824
    .short 11828, 11804, 11832, 11836, 11876, 11904, 11908, 11884, 11912, 11916, 11892, 11920, 11924, 11900, 11928, 11932
    .short 11936, 11940, 11968, 11944, 11948, 11976, 11952, 11956, 11984, 11960, 11964, 11992, 12000, 12004, 11972, 12008
    .short 12012, 11980, 12016, 12020, 11988, 12024, 12028, 11996, 12032, 12036, 12064, 12040, 12044, 12072, 12048, 12052
    .short 12080, 12056, 12060, 12088, 12096, 12100, 12068, 12104, 12108, 12076, 12112, 12116, 12084, 12120, 12124, 12092
    .short 2432, 2436, 2464, 2440, 2444, 2472, 2448, 2452, 2480, 2456, 2460, 2488, 2528, 2532, 2560, 2536
    .short 2540, 2568, 2544, 2548, 2576, 2552, 2556, 2584, 2624, 2628, 2656, 2632, 2636, 2664, 2640, 2644
    .short 2672, 2648, 2652, 2680, 2720, 2724, 2752, 2728, 2732, 2760, 2736, 2740, 2768, 2744, 2748, 2776
    .short 2468, 2496, 2500, 2476, 2504, 2508, 2484, 2512, 2516, 2492, 2520, 2524, 2564, 2592, 2596, 2572
    .short 2600, 2604, 2580, 2608, 2612, 2588, 2616, 2620, 2660, 2688, 2692, 2668, 2696, 2700, 2676, 2704
    .short 2708, 2684, 2712, 2716, 2756, 2784, 2788, 2764, 2792, 2796, 2772, 2800, 2804, 2780, 2808, 2812
    .short 2816, 2820, 2848, 2824, 2828, 2856, 2832, 2836, 2864, 2840, 2844, 2872, 2880, 2884, 2852, 2888
    .short 2892, 2860, 2896, 2900, 2868, 2904, 2908, 2876, 2912, 2916, 2944, 2920, 2924, 2952, 2928, 2932
    .short 2960, 2936, 2940, 2968, 2976, 2980, 2948, 2984, 2988, 2956, 2992, 2996, 2964, 3000, 3004, 2972
    .short 3040, 3044, 3072, 3048, 3052, 3080, 3056, 3060, 3088, 3064, 3068, 3096, 3136, 3140, 3168, 3144
    .short 3148, 3176, 3152, 3156, 3184, 3160, 3164, 3192, 3232, 3236, 3264, 3240, 3244, 3272, 3248, 3252
    .short 3280, 3256, 3260, 3288, 3328, 3332, 3360, 3336, 3340, 3368, 3344, 3348, 3376, 3352, 3356, 3384
    .short 3076, 3104, 3108, 3084, 3112, 3116, 3092, 3120, 3124, 3100, 3128, 3132, 3172, 3200, 3204, 3180
    .short 3208, 3212, 3188, 3216, 3220, 3196, 3224, 3228, 3268, 3296, 3300, 3276, 3304, 3308, 3284, 3312
    .short 3316, 3292, 3320, 3324, 3364, 3392, 3396, 3372, 3400, 3404, 3380, 3408, 3412, 3388, 3416, 3420
    .short 3424, 3428, 3456, 3432, 3436, 3464, 3440, 3444, 3472, 3448, 3452, 3480, 3488, 3492, 3460, 3496
    .short 3500, 3468, 3504, 3508, 3476, 3512, 3516, 3484, 3520, 3524, 3552, 3528, 3532, 3560, 3536, 3540
    .short 3568, 3544, 3548, 3576, 3584, 3588, 3556, 3592, 3596, 3564, 3600, 3604, 3572, 3608, 3612, 3580
    .short 3648, 3652, 3680, 3656, 3660, 3688, 3664, 3668, 3696, 3672, 3676, 3704, 3744, 3748, 3776, 3752
    .short 3756, 3784, 3760, 3764, 3792, 3768, 3772, 3800, 3840, 3844, 3872, 3848, 3852, 3880, 3856, 3860
    .short 3888, 3864, 3868, 3896, 3936, 3940, 3968, 3944, 3948, 3976, 3952, 3956, 3984, 3960, 3964, 3992
    .short 3684, 3712, 3716, 3692, 3720, 3724, 3700, 3728, 3732, 3708, 3736, 3740, 3780, 3808, 3812, 3788
    .short 3816, 3820, 3796, 3824, 3828, 3804, 3832, 3836, 3876, 3904, 3908, 3884, 3912, 3916, 3892, 3920
    .short 3924, 3900, 3928, 3932, 3972, 4000, 4004, 3980, 4008, 4012, 3988, 4016, 4020, 3996, 4024, 4028
    .short 4032, 4036, 4064, 4040, 4044, 4072, 4048, 4052, 4080, 4056, 4060, 4088, 4096, 4100, 4068, 4104
    .short 4108, 4076, 4112, 4116, 4084, 4120, 4124, 4092, 4128, 4132, 4160, 4136, 4140, 4168, 4144, 4148
    .short 4176, 4152, 4156, 4184, 4192, 4196, 4164, 4200, 4204, 4172, 4208, 4212, 4180, 4216, 4220, 4188
    .short 4256, 4260, 4288, 4264, 4268, 4296, 4272, 4276, 4304, 4280, 4284, 4312, 4352, 4356, 4384, 4360
    .short 4364, 4392, 4368, 4372, 4400, 4376, 4380, 4408, 4448, 4452, 4480, 4456, 4460, 4488, 4464, 4468
    .short 4496, 4472, 4476, 4504, 4544, 4548, 4576, 4552, 4556, 4584, 4560, 4564, 4592, 4568, 4572, 4600
    .short 4292, 4320, 4324, 4300, 4328, 4332, 4308, 4336, 4340, 4316, 4344, 4348, 4388, 4416, 4420, 4396
    .short 4424, 4428, 4404, 4432, 4436, 4412, 4440, 4444, 4484, 4512, 4516, 4492, 4520, 4524, 4500, 4528
    .short 4532, 4508, 4536, 4540, 4580, 4608, 4612, 4588, 4616, 4620, 4596, 4624, 4628, 4604, 4632, 4636
    .short 4640, 4644, 4672, 4648, 4652, 4680, 4656, 4660, 4688, 4664, 4668, 4696, 4704, 4708, 4676, 4712
    .short 4716, 4684, 4720, 4724, 4692, 4728, 4732, 4700, 4736, 4740, 4768, 4744, 4748, 4776, 4752, 4756
    .short 4784, 4760, 4764, 4792, 4800, 4804, 4772, 4808, 4812, 4780, 4816, 4820, 4788, 4824, 4828, 4796
    .short 12160, 12164, 12192, 12168, 12172, 12200, 12176, 12180, 12208, 12184, 12188, 12216, 12256, 12260, 12288, 12264
    .short 12268, 12296, 12272, 12276, 12304, 12280, 12284, 12312, 12352, 12356, 12384, 12360, 12364, 12392, 12368, 12372
    .short 12400, 12376, 12380, 12408, 12448, 12452, 12480, 12456, 12460, 12488, 12464, 12468, 12496, 12472, 12476, 12504
    .short 12196, 12224, 12228, 12204, 12232, 12236, 12212, 12240, 12244, 12220, 12248, 12252, 12292, 12320, 12324, 12300
    .short 12328, 12332, 12308, 12336, 12340, 12316, 12344, 12348, 12388, 12416, 12420, 12396, 12424, 12428, 12404, 12432
    .short 12436, 12412, 12440, 12444, 12484, 12512, 12516, 12492, 12520, 12524, 12500, 12528, 12532, 12508, 12536, 12540
    .short 12544, 12548, 12576, 12552, 12556, 12584, 12560, 12564, 12592, 12568, 12572, 12600, 12608, 12612, 12580, 12616
    .short 12620, 12588, 12624, 12628, 12596, 12632, 12636, 12604, 12640, 12644, 12672, 12648, 12652, 12680, 12656, 12660
    .short 12688, 12664, 12668, 12696, 12704, 12708, 12676, 12712, 12716, 12684, 12720, 12724, 12692, 12728, 12732, 12700
    .short 12768, 12772, 12800, 12776, 12780, 12808, 12784, 12788, 12816, 12792, 12796, 12824, 12864, 12868, 12896, 12872
    .short 12876, 12904, 12880, 12884, 12912, 12888, 12892, 12920, 12960, 12964, 12992, 12968, 12972, 13000, 12976, 12980
    .short 13008, 12984, 12988, 13016, 13056, 13060, 13088, 13064, 13068, 13096, 13072, 13076, 13104, 13080, 13084, 13112
    .short 12804, 12832, 12836, 12812, 12840, 12844, 12820, 12848, 12852, 12828, 12856, 12860, 12900, 12928, 12932, 12908
    .short 12936, 12940, 12916, 12944, 12948, 12924, 12952, 12956, 12996, 13024, 13028, 13004, 13032, 13036, 13012, 13040
    .short 13044, 13020, 13048, 13052, 13092, 13120, 13124, 13100, 13128, 13132, 13108, 13136, 13140, 13116, 13144, 13148
    .short 13152, 13156, 13184, 13160, 13164, 13192, 13168, 13172, 13200, 13176, 13180, 13208, 13216, 13220, 13188, 13224
    .short 13228, 13196, 13232, 13236, 13204, 13240, 13244, 13212, 13248, 13252, 13280, 13256, 13260, 13288, 13264, 13268
    .short 13296, 13272, 13276, 13304, 13312, 13316, 13284, 13320, 13324, 13292, 13328, 13332, 13300, 13336, 13340, 13308
    .short 13376, 13380, 13408, 13384, 13388, 13416, 13392, 13396, 13424, 13400, 13404, 13432, 13472, 13476, 13504, 13480
    .short 13484, 13512, 13488, 13492, 13520, 13496, 13500, 13528, 13568, 13572, 13600, 13576, 13580, 13608, 13584, 13588
    .short 13616, 13592, 13596, 13624, 13664, 13668, 13696, 13672, 13676, 13704, 13680, 13684, 13712, 13688, 13692, 13720
    .short 13412, 13440, 13444, 13420, 13448, 13452, 13428, 13456, 13460, 13436, 13464, 13468, 13508, 13536, 13540, 13516
    .short 13544, 13548, 13524, 13552, 13556, 13532, 13560, 13564, 13604, 13632, 13636, 13612, 13640, 13644, 13620, 13648
    .short 13652, 13628, 13656, 13660, 13700, 13728, 13732, 13708, 13736, 13740, 13716, 13744, 13748, 13724, 13752, 13756
    .short 13760, 13764, 13792, 13768, 13772, 13800, 13776, 13780, 13808, 13784, 13788, 13816, 13824, 13828, 13796, 13832
    .short 13836, 13804, 13840, 13844, 13812, 13848, 13852, 13820, 13856, 13860, 13888, 13864, 13868, 13896, 13872, 13876
    .short 13904, 13880, 13884, 13912, 13920, 13924, 13892, 13928, 13932, 13900, 13936, 13940, 13908, 13944, 13948, 13916
    .short 13984, 13988, 14016, 13992, 13996, 14024, 14000, 14004, 14032, 14008, 14012, 14040, 14080, 14084, 14112, 14088
    .short 14092, 14120, 14096, 14100, 14128, 14104, 14108, 14136, 14176, 14180, 14208, 14184, 14188, 14216, 14192, 14196
    .short 14224, 14200, 14204, 14232, 14272, 14276, 14304, 14280, 14284, 14312, 14288, 14292, 14320, 14296, 14300, 14328
    .short 14020, 14048, 14052, 14028, 14056, 14060, 14036, 14064, 14068, 14044, 14072, 14076, 14116, 14144, 14148, 14124
    .short 14152, 14156, 14132, 14160, 14164, 14140, 14168, 14172, 14212, 14240, 14244, 14220, 14248, 14252, 14228, 14256
    .short 14260, 14236, 14264, 14268, 14308, 14336, 14340, 14316, 14344, 14348, 14324, 14352, 14356, 14332, 14360, 14364
    .short 14368, 14372, 14400, 14376, 14380, 14408, 14384, 14388, 14416, 14392, 14396, 14424, 14432, 14436, 14404, 14440
    .short 14444, 14412, 14448, 14452, 14420, 14456, 14460, 14428, 14464, 14468, 14496, 14472, 14476, 14504, 14480, 14484
    .short 14512, 14488, 14492, 14520, 14528, 14532, 14500, 14536, 14540, 14508, 14544, 14548, 14516, 14552, 14556, 14524
    .short 0, 8, 16, 0, 24, 64, 72, 0, 80, 88, 128, 0, 136, 144, 152, 0
    .short 224, 232, 240, 0, 248, 288, 296, 0, 304, 312, 352, 0, 360, 368, 376, 0
    .short 448, 456, 464, 0, 472, 512, 520, 0, 528, 536, 576, 0, 584, 592, 600, 0
    .short 672, 680, 688, 0, 696, 736, 744, 0, 752, 760, 800, 0, 808, 816, 824, 0
    .short 3584, 3592, 3600, 0, 3608, 3648, 3656, 0, 3664, 3672, 3712, 0, 3720, 3728, 3736, 0
    .short 3808, 3816, 3824, 0, 3832, 3872, 3880, 0, 3888, 3896, 3936, 0, 3944, 3952, 3960, 0
    .short 896, 904, 912, 0, 920, 960, 968, 0, 976, 984, 1024, 0, 1032, 1040, 1048, 0
    .short 1120, 1128, 1136, 0, 1144, 1184, 1192, 0, 1200, 1208, 1248, 0, 1256, 1264, 1272, 0
    .short 1344, 1352, 1360, 0, 1368, 1408, 1416, 0, 1424, 1432, 1472, 0, 1480, 1488, 1496, 0
    .short 1568, 1576, 1584, 0, 1592, 1632, 1640, 0, 1648, 1656, 1696, 0, 1704, 1712, 1720, 0
    .short 4480, 4488, 4496, 0, 4504, 4544, 4552, 0, 4560, 4568, 4608, 0, 4616, 4624, 4632, 0
    .short 4704, 4712, 4720, 0, 4728, 4768, 4776, 0, 4784, 4792, 4832, 0, 4840, 4848, 4856, 0
    .short 1792, 1800, 1808, 0, 1816, 1856, 1864, 0, 1872, 1880, 1920, 0, 1928, 1936, 1944, 0
    .short 2016, 2024, 2032, 0, 2040, 2080, 2088, 0, 2096, 2104, 2144, 0, 2152, 2160, 2168, 0
    .short 2240, 2248, 2256, 0, 2264, 2304, 2312, 0, 2320, 2328, 2368, 0, 2376, 2384, 2392, 0
    .short 2464, 2472, 2480, 0, 2488, 2528, 2536, 0, 2544, 2552, 2592, 0, 2600, 2608, 2616, 0
    .short 5376, 5384, 5392, 0, 5400, 5440, 5448, 0, 5456, 5464, 5504, 0, 5512, 5520, 5528, 0
    .short 5600, 5608, 5616, 0, 5624, 5664, 5672, 0, 5680, 5688, 5728, 0, 5736, 5744, 5752, 0
    .short 2688, 2696, 2704, 0, 2712, 2752, 2760, 0, 2768, 2776, 2816, 0, 2824, 2832, 2840, 0
    .short 2912, 2920, 2928, 0, 2936, 2976, 2984, 0, 2992, 3000, 3040, 0, 3048, 3056, 3064, 0
    .short 3136, 3144, 3152, 0, 3160, 3200, 3208, 0, 3216, 3224, 3264, 0, 3272, 3280, 3288, 0
    .short 3360, 3368, 3376, 0, 3384, 3424, 3432, 0, 3440, 3448, 3488, 0, 3496, 3504, 3512, 0
    .short 6272, 6280, 6288, 0, 6296, 6336, 6344, 0, 6352, 6360, 6400, 0, 6408, 6416, 6424, 0
    .short 6496, 6504, 6512, 0, 6520, 6560, 6568, 0, 6576, 6584, 6624, 0, 6632, 6640, 6648, 0
    .short 4032, 4040, 4048, 0, 4056, 4096, 4104, 0, 4112, 4120, 4160, 0, 4168, 4176, 4184, 0
    .short 4256, 4264, 4272, 0, 4280, 4320, 4328, 0, 4336, 4344, 4384, 0, 4392, 4400, 4408, 0
    .short 7168, 7176, 7184, 0, 7192, 7232, 7240, 0, 7248, 7256, 7296, 0, 7304, 7312, 7320, 0
    .short 7392, 7400, 7408, 0, 7416, 7456, 7464, 0, 7472, 7480, 7520, 0, 7528, 7536, 7544, 0
    .short 7616, 7624, 7632, 0, 7640, 7680, 7688, 0, 7696, 7704, 7744, 0, 7752, 7760, 7768, 0
    .short 7840, 7848, 7856, 0, 7864, 7904, 7912, 0, 7920, 7928, 7968, 0, 7976, 7984, 7992, 0
    .short 4928, 4936, 4944, 0, 4952, 4992, 5000, 0, 5008, 5016, 5056, 0, 5064, 5072, 5080, 0
    .short 5152, 5160, 5168, 0, 5176, 5216, 5224, 0, 5232, 5240, 5280, 0, 5288, 5296, 5304, 0
    .short 8064, 8072, 8080, 0, 8088, 8128, 8136, 0, 8144, 8152, 8192, 0, 8200, 8208, 8216, 0
    .short 8288, 8296, 8304, 0, 8312, 8352, 8360, 0, 8368, 8376, 8416, 0, 8424, 8432, 8440, 0
    .short 8512, 8520, 8528, 0, 8536, 8576, 8584, 0, 8592, 8600, 8640, 0, 8648, 8656, 8664, 0
    .short 8736, 8744, 8752, 0, 8760, 8800, 8808, 0, 8816, 8824, 8864, 0, 8872, 8880, 8888, 0
    .short 5824, 5832, 5840, 0, 5848, 5888, 5896, 0, 5904, 5912, 5952, 0, 5960, 5968, 5976, 0
    .short 6048, 6056, 6064, 0, 6072, 6112, 6120, 0, 6128, 6136, 6176, 0, 6184, 6192, 6200, 0
    .short 8960, 8968, 8976, 0, 8984, 9024, 9032, 0, 9040, 9048, 9088, 0, 9096, 9104, 9112, 0
    .short 9184, 9192, 9200, 0, 9208, 9248, 9256, 0, 9264, 9272, 9312, 0, 9320, 9328, 9336, 0
    .short 9408, 9416, 9424, 0, 9432, 9472, 9480, 0, 9488, 9496, 9536, 0, 9544, 9552, 9560, 0
    .short 9632, 9640, 9648, 0, 9656, 9696, 9704, 0, 9712, 9720, 9760, 0, 9768, 9776, 9784, 0
    .short 6720, 6728, 6736, 0, 6744, 6784, 6792, 0, 6800, 6808, 6848, 0, 6856, 6864, 6872, 0
    .short 6944, 6952, 6960, 0, 6968, 7008, 7016, 0, 7024, 7032, 7072, 0, 7080, 7088, 7096, 0
    .short 9856, 9864, 9872, 0, 9880, 9920, 9928, 0, 9936, 9944, 9984, 0, 9992, 10000, 10008, 0
    .short 10080, 10088, 10096, 0, 10104, 10144, 10152, 0, 10160, 10168, 10208, 0, 10216, 10224, 10232, 0
    .short 10304, 10312, 10320, 0, 10328, 10368, 10376, 0, 10384, 10392, 10432, 0, 10440, 10448, 10456, 0
    .short 10528, 10536, 10544, 0, 10552, 10592, 10600, 0, 10608, 10616, 10656, 0, 10664, 10672, 10680, 0
    .short 10752, 10760, 10768, 0, 10776, 10816, 10824, 0, 10832, 10840, 10880, 0, 10888, 10896, 10904, 0
    .short 10976, 10984, 10992, 0, 11000, 11040, 11048, 0, 11056, 11064, 11104, 0, 11112, 11120, 11128, 0
    .short 11200, 11208, 11216, 0, 11224, 11264, 11272, 0, 11280, 11288, 11328, 0, 11336, 11344, 11352, 0
    .short 11424, 11432, 11440, 0, 11448, 11488, 11496, 0, 11504, 11512, 11552, 0, 11560, 11568, 11576, 0
    .short 14336, 14344, 14352, 0, 14360, 14400, 14408, 0, 14416, 14424, 14464, 0, 14472, 14480, 14488, 0
    .short 14560, 14568, 14576, 0, 14584, 14624, 14632, 0, 14640, 14648, 14688, 0, 14696, 14704, 14712, 0
    .short 11648, 11656, 11664, 0, 11672, 11712, 11720, 0, 11728, 11736, 11776, 0, 11784, 11792, 11800, 0
    .short 11872, 11880, 11888, 0, 11896, 11936, 11944, 0, 11952, 11960, 12000, 0, 12008, 12016, 12024, 0
    .short 12096, 12104, 12112, 0, 12120, 12160, 12168, 0, 12176, 12184, 12224, 0, 12232, 12240, 12248, 0
    .short 12320, 12328, 12336, 0, 12344, 12384, 12392, 0, 12400, 12408, 12448, 0, 12456, 12464, 12472, 0
    .short 15232, 15240, 15248, 0, 15256, 15296, 15304, 0, 15312, 15320, 15360, 0, 15368, 15376, 15384, 0
    .short 15456, 15464, 15472, 0, 15480, 15520, 15528, 0, 15536, 15544, 15584, 0, 15592, 15600, 15608, 0
    .short 12544, 12552, 12560, 0, 12568, 12608, 12616, 0, 12624, 12632, 12672, 0, 12680, 12688, 12696, 0
    .short 12768, 12776, 12784, 0, 12792, 12832, 12840, 0, 12848, 12856, 12896, 0, 12904, 12912, 12920, 0
    .short 12992, 13000, 13008, 0, 13016, 13056, 13064, 0, 13072, 13080, 13120, 0, 13128, 13136, 13144, 0
    .short 13216, 13224, 13232, 0, 13240, 13280, 13288, 0, 13296, 13304, 13344, 0, 13352, 13360, 13368, 0
    .short 16128, 16136, 16144, 0, 16152, 16192, 16200, 0, 16208, 16216, 16256, 0, 16264, 16272, 16280, 0
    .short 16352, 16360, 16368, 0, 16376, 16416, 16424, 0, 16432, 16440, 16480, 0, 16488, 16496, 16504, 0
    .short 13440, 13448, 13456, 0, 13464, 13504, 13512, 0, 13520, 13528, 13568, 0, 13576, 13584, 13592, 0
    .short 13664, 13672, 13680, 0, 13688, 13728, 13736, 0, 13744, 13752, 13792, 0, 13800, 13808, 13816, 0
    .short 13888, 13896, 13904, 0, 13912, 13952, 13960, 0, 13968, 13976, 14016, 0, 14024, 14032, 14040, 0
    .short 14112, 14120, 14128, 0, 14136, 14176, 14184, 0, 14192, 14200, 14240, 0, 14248, 14256, 14264, 0
    .short 17024, 17032, 17040, 0, 17048, 17088, 17096, 0, 17104, 17112, 17152, 0, 17160, 17168, 17176, 0
    .short 17248, 17256, 17264, 0, 17272, 17312, 17320, 0, 17328, 17336, 17376, 0, 17384, 17392, 17400, 0
    .short 14784, 14792, 14800, 0, 14808, 14848, 14856, 0, 14864, 14872, 14912, 0, 14920, 14928, 14936, 0
    .short 15008, 15016, 15024, 0, 15032, 15072, 15080, 0, 15088, 15096, 15136, 0, 15144, 15152, 15160, 0
    .short 17920, 17928, 17936, 0, 17944, 17984, 17992, 0, 18000, 18008, 18048, 0, 18056, 18064, 18072, 0
    .short 18144, 18152, 18160, 0, 18168, 18208, 18216, 0, 18224, 18232, 18272, 0, 18280, 18288, 18296, 0
    .short 18368, 18376, 18384, 0, 18392, 18432, 18440, 0, 18448, 18456, 18496, 0, 18504, 18512, 18520, 0
    .short 18592, 18600, 18608, 0, 18616, 18656, 18664, 0, 18672, 18680, 18720, 0, 18728, 18736, 18744, 0
    .short 15680, 15688, 15696, 0, 15704, 15744, 15752, 0, 15760, 15768, 15808, 0, 15816, 15824, 15832, 0
    .short 15904, 15912, 15920, 0, 15928, 15968, 15976, 0, 15984, 15992, 16032, 0, 16040, 16048, 16056, 0
    .short 18816, 18824, 18832, 0, 18840, 18880, 18888, 0, 18896, 18904, 18944, 0, 18952, 18960, 18968, 0
    .short 19040, 19048, 19056, 0, 19064, 19104, 19112, 0, 19120, 19128, 19168, 0, 19176, 19184, 19192, 0
    .short 19264, 19272, 19280, 0, 19288, 19328, 19336, 0, 19344, 19352, 19392, 0, 19400, 19408, 19416, 0
    .short 19488, 19496, 19504, 0, 19512, 19552, 19560, 0, 19568, 19576, 19616, 0, 19624, 19632, 19640, 0
    .short 16576, 16584, 16592, 0, 16600, 16640, 16648, 0, 16656, 16664, 16704, 0, 16712, 16720, 16728, 0
    .short 16800, 16808, 16816, 0, 16824, 16864, 16872, 0, 16880, 16888, 16928, 0, 16936, 16944, 16952, 0
    .short 19712, 19720, 19728, 0, 19736, 19776, 19784, 0, 19792, 19800, 19840, 0, 19848, 19856, 19864, 0
    .short 19936, 19944, 19952, 0, 19960, 20000, 20008, 0, 20016, 20024, 20064, 0, 20072, 20080, 20088, 0
    .short 20160, 20168, 20176, 0, 20184, 20224, 20232, 0, 20240, 20248, 20288, 0, 20296, 20304, 20312, 0
    .short 20384, 20392, 20400, 0, 20408, 20448, 20456, 0, 20464, 20472, 20512, 0, 20520, 20528, 20536, 0
    .short 17472, 17480, 17488, 0, 17496, 17536, 17544, 0, 17552, 17560, 17600, 0, 17608, 17616, 17624, 0
    .short 17696, 17704, 17712, 0, 17720, 17760, 17768, 0, 17776, 17784, 17824, 0, 17832, 17840, 17848, 0
    .short 20608, 20616, 20624, 0, 20632, 20672, 20680, 0, 20688, 20696, 20736, 0, 20744, 20752, 20760, 0
    .short 20832, 20840, 20848, 0, 20856, 20896, 20904, 0, 20912, 20920, 20960, 0, 20968, 20976, 20984, 0
    .short 21056, 21064, 21072, 0, 21080, 21120, 21128, 0, 21136, 21144, 21184, 0, 21192, 21200, 21208, 0
    .short 21280, 21288, 21296, 0, 21304, 21344, 21352, 0, 21360, 21368, 21408, 0, 21416, 21424, 21432, 0
    .short 0, 0, 14464, 2, 28928, 4, 0, 0, 768, 0, 0, 0, 0, 0, 0, 0
    .short 192, 0, 14656, 2, 29120, 4, 8, 0, 770, 0, 196, 0, 0, 0, 0, 0
    .short 384, 0, 14848, 2, 29312, 4, 16, 0, 772, 0, 392, 0, 0, 0, 0, 0
    .short 576, 0, 15040, 2, 35200, 5, 24, 0, 774, 0, 588, 0, 0, 0, 0, 0
    .short 768, 0, 15232, 2, 35392, 5, 608, 0, 784, 0, 784, 0, 0, 0, 0, 0
    .short 960, 0, 21120, 3, 35584, 5, 616, 0, 786, 0, 980, 0, 0, 0, 0, 0
    .short 1152, 0, 21312, 3, 35776, 5, 624, 0, 788, 0, 1176, 0, 0, 0, 0, 0
    .short 7040, 1, 21504, 3, 35968, 5, 632, 0, 790, 0, 1372, 0, 0, 0, 0, 0
    .short 7232, 1, 21696, 3, 36160, 5, 1216, 0, 800, 0, 1568, 0, 0, 0, 0, 0
    .short 7424, 1, 21888, 3, 36352, 5, 1224, 0, 802, 0, 1764, 0, 0, 0, 0, 0
    .short 7616, 1, 22080, 3, 42240, 6, 1232, 0, 804, 0, 1960, 0, 0, 0, 0, 0
    .short 7808, 1, 22272, 3, 42432, 6, 1240, 0, 806, 0, 2156, 0, 0, 0, 0, 0
    .short 8000, 1, 28160, 4, 42624, 6, 1824, 0, 816, 0, 2352, 0, 0, 0, 0, 0
    .short 8192, 1, 28352, 4, 42816, 6, 1832, 0, 818, 0, 2548, 0, 0, 0, 0, 0
    .short 14080, 2, 28544, 4, 43008, 6, 1840, 0, 820, 0, 2744, 0, 0, 0, 0, 0
    .short 14272, 2, 28736, 4, 43200, 6, 1848, 0, 822, 0, 2940, 0, 0, 0, 0, 0
    .short 16, 0, 14480, 2, 28944, 4, 2432, 0, 776, 0, 16, 0, 0, 0, 0, 0
    .short 208, 0, 14672, 2, 29136, 4, 2440, 0, 778, 0, 212, 0, 0, 0, 0, 0
    .short 400, 0, 14864, 2, 29328, 4, 2448, 0, 780, 0, 408, 0, 0, 0, 0, 0
    .short 592, 0, 15056, 2, 35216, 5, 2456, 0, 782, 0, 604, 0, 0, 0, 0, 0
    .short 784, 0, 15248, 2, 35408, 5, 3040, 0, 792, 0, 800, 0, 0, 0, 0, 0
    .short 976, 0, 21136, 3, 35600, 5, 3048, 0, 794, 0, 996, 0, 0, 0, 0, 0
    .short 1168, 0, 21328, 3, 35792, 5, 3056, 0, 796, 0, 1192, 0, 0, 0, 0, 0
    .short 7056, 1, 21520, 3, 35984, 5, 3064, 0, 798, 0, 1388, 0, 0, 0, 0, 0
    .short 7248, 1, 21712, 3, 36176, 5, 3648, 0, 808, 0, 1584, 0, 0, 0, 0, 0
    .short 7440, 1, 21904, 3, 36368, 5, 3656, 0, 810, 0, 1780, 0, 0, 0, 0, 0
    .short 7632, 1, 22096, 3, 42256, 6, 3664, 0, 812, 0, 1976, 0, 0, 0, 0, 0
    .short 7824, 1, 22288, 3, 42448, 6, 3672, 0, 814, 0, 2172, 0, 0, 0, 0, 0
    .short 8016, 1, 28176, 4, 42640, 6, 4256, 0, 824, 0, 2368, 0, 0, 0, 0, 0
    .short 8208, 1, 28368, 4, 42832, 6, 4264, 0, 826, 0, 2564, 0, 0, 0, 0, 0
    .short 14096, 2, 28560, 4, 43024, 6, 4272, 0, 828, 0, 2760, 0, 0, 0, 0, 0
    .short 14288, 2, 28752, 4, 43216, 6, 4280, 0, 830, 0, 2956, 0, 0, 0, 0, 0
    .short 32, 0, 14496, 2, 28960, 4, 4864, 0, 832, 0, 32, 0, 0, 0, 0, 0
    .short 224, 0, 14688, 2, 29152, 4, 4872, 0, 834, 0, 228, 0, 0, 0, 0, 0
    .short 416, 0, 14880, 2, 29344, 4, 4880, 0, 836, 0, 424, 0, 0, 0, 0, 0
    .short 608, 0, 15072, 2, 35232, 5, 4888, 0, 838, 0, 620, 0, 0, 0, 0, 0
    .short 800, 0, 15264, 2, 35424, 5, 5472, 0, 848, 0, 816, 0, 0, 0, 0, 0
    .short 992, 0, 21152, 3, 35616, 5, 5480, 0, 850, 0, 1012, 0, 0, 0, 0, 0
    .short 1184, 0, 21344, 3, 35808, 5, 5488, 0, 852, 0, 1208, 0, 0, 0, 0, 0
    .short 7072, 1, 21536, 3, 36000, 5, 5496, 0, 854, 0, 1404, 0, 0, 0, 0, 0
    .short 7264, 1, 21728, 3, 36192, 5, 6080, 0, 864, 0, 1600, 0, 0, 0, 0, 0
    .short 7456, 1, 21920, 3, 36384, 5, 6088, 0, 866, 0, 1796, 0, 0, 0, 0, 0
    .short 7648, 1, 22112, 3, 42272, 6, 6096, 0, 868, 0, 1992, 0, 0, 0, 0, 0
    .short 7840, 1, 22304, 3, 42464, 6, 6104, 0, 870, 0, 2188, 0, 0, 0, 0, 0
    .short 8032, 1, 28192, 4, 42656, 6, 6688, 0, 880, 0, 2384, 0, 0, 0, 0, 0
    .short 8224, 1, 28384, 4, 42848, 6, 6696, 0, 882, 0, 2580, 0, 0, 0, 0, 0
    .short 14112, 2, 28576, 4, 43040, 6, 6704, 0, 884, 0, 2776, 0, 0, 0, 0, 0
    .short 14304, 2, 28768, 4, 43232, 6, 6712, 0, 886, 0, 2972, 0, 0, 0, 0, 0
    .short 48, 0, 14512, 2, 28976, 4, 7296, 0, 840, 0, 48, 0, 0, 0, 0, 0
    .short 240, 0, 14704, 2, 29168, 4, 7304, 0, 842, 0, 244, 0, 0, 0, 0, 0
    .short 432, 0, 14896, 2, 29360, 4, 7312, 0, 844, 0, 440, 0, 0, 0, 0, 0
    .short 624, 0, 15088, 2, 35248, 5, 7320, 0, 846, 0, 636, 0, 0, 0, 0, 0
    .short 816, 0, 15280, 2, 35440, 5, 7904, 0, 856, 0, 832, 0, 0, 0, 0, 0
    .short 1008, 0, 21168, 3, 35632, 5, 7912, 0, 858, 0, 1028, 0, 0, 0, 0, 0
    .short 1200, 0, 21360, 3, 35824, 5, 7920, 0, 860, 0, 1224, 0, 0, 0, 0, 0
    .short 7088, 1, 21552, 3, 36016, 5, 7928, 0, 862, 0, 1420, 0, 0, 0, 0, 0
    .short 7280, 1, 21744, 3, 36208, 5, 8512, 0, 872, 0, 1616, 0, 0, 0, 0, 0
    .short 7472, 1, 21936, 3, 36400, 5, 8520, 0, 874, 0, 1812, 0, 0, 0, 0, 0
    .short 7664, 1, 22128, 3, 42288, 6, 8528, 0, 876, 0, 2008, 0, 0, 0, 0, 0
    .short 7856, 1, 22320, 3, 42480, 6, 8536, 0, 878, 0, 2204, 0, 0, 0, 0, 0
    .short 8048, 1, 28208, 4, 42672, 6, 9120, 0, 888, 0, 2400, 0, 0, 0, 0, 0
    .short 8240, 1, 28400, 4, 42864, 6, 9128, 0, 890, 0, 2596, 0, 0, 0, 0, 0
    .short 14128, 2, 28592, 4, 43056, 6, 9136, 0, 892, 0, 2792, 0, 0, 0, 0, 0
    .short 14320, 2, 28784, 4, 43248, 6, 9144, 0, 894, 0, 2988, 0, 0, 0, 0, 0
```
